```python
import torch

def _softmax(x, axis=-1):
    return torch.softmax(x, dim=axis)
def _gelu(x):
    return torch.nn.functional.gelu(x, approximate="tanh")
def _silu(x):
    return torch.nn.functional.silu(x)
def _sigmoid(x):
    return torch.sigmoid(x)
def _layernorm(x, axis=-1, eps=1e-5):
    m = x.mean(dim=axis, keepdim=True)
    v = x.var(dim=axis, keepdim=True, unbiased=False)
    return (x - m) / torch.sqrt(v + eps)
def _scatter_add(tgt, idx, src, axis=0):
    return tgt.clone().index_add_(axis, idx, src)
def _segment_sum(src, seg, n):
    out = torch.zeros((n,) + src.shape[1:], dtype=src.dtype)
    return out.index_add_(0, seg, src)
def _pad(x, pw):
    flat = tuple(v for pair in reversed(pw) for v in pair)
    return torch.nn.functional.pad(x, flat)

kernel_name = 'sequential_preLN__sliding_block__dense_activation_relu__prompt'

def setup_inputs():

    _w = (lambda a: (lambda t: t.to(torch.bfloat16) if t.is_floating_point() else t)(torch.as_tensor(a)))
    def _A_setup():
        B, S, D = 1, 2048, 1024
        return {
            "x": _w((lambda *s: torch.randn(*s, dtype=torch.bfloat16) * 0.05)(B, S, D)),
            "wqkv": _w((lambda *s: torch.randn(*s, dtype=torch.bfloat16) * 0.05)(D, 3 * D)),
            "wo": _w((lambda *s: torch.randn(*s, dtype=torch.bfloat16) * 0.05)(D, D)),
        }
    _A_in = _A_setup()

    def _B_setup():
        B, S, D, Dff = 1, 2048, 1024, 3584
        return {
            "x": _w((lambda *s: torch.randn(*s, dtype=torch.bfloat16) * 0.05)(B, S, D)),
            "w1": _w((lambda *s: torch.randn(*s, dtype=torch.bfloat16) * 0.05)(D, Dff)),
            "w2": _w((lambda *s: torch.randn(*s, dtype=torch.bfloat16) * 0.05)(Dff, D)),
        }
    _B_in = _B_setup()

    return {
        "A_x": _A_in["x"],
        "A_wqkv": _A_in["wqkv"],
        "A_wo": _A_in["wo"],
        "B_x": _B_in["x"],
        "B_w1": _B_in["w1"],
        "B_w2": _B_in["w2"],
    }

def reference(A_x, A_wqkv, A_wo, B_x, B_w1, B_w2):
    def _A_ref(x, wqkv, wo):
        B, S, D = x.shape
        H = 32; Dh = D // H; W = 256
        qkv = (lambda x, *d: x.permute(*d))((x @ wqkv).reshape(B, S, 3, H, Dh), 2, 0, 3, 1, 4)
        q, k, v = qkv[0], qkv[1], qkv[2]
        scores = torch.einsum("bhqd,bhkd->bhqk", q, k) * (Dh ** -0.5)
        idx = torch.arange(S)
        mask = (idx[:, None] - idx[None, :] >= 0) & (idx[:, None] - idx[None, :] < W)
        scores = torch.where(mask[None, None], scores, -1e9)
        p = _softmax(scores, axis=-1)
        o = torch.einsum("bhqk,bhkd->bhqd", p, v)
        return (lambda x, *d: x.permute(*d))(o, 0, 2, 1, 3).reshape(B, S, D) @ wo

    def _B_ref(x, w1, w2):
        h = torch.einsum("bsd,df->bsf", x, w1)
        zero = torch.zeros_like(h)
        h = torch.maximum(h, zero)
        return torch.einsum("bsf,fd->bsd", h, w2)

    x = A_x
    h = x + _A_ref(_layernorm(x, axis=-1), A_wqkv, A_wo)
    h2 = h + _B_ref(_layernorm(h, axis=-1), B_w1, B_w2)
    return h2
```

```asm
; @launch grid=(256,1,1) block=(512,1,1) lds=163840
.amdgcn_target "amdgcn-amd-amdhsa--gfx950"
.text
.globl sequential_preLN__sliding_block__dense_activation_relu__prompt_kernel
.p2align 8
.type sequential_preLN__sliding_block__dense_activation_relu__prompt_kernel,@function
sequential_preLN__sliding_block__dense_activation_relu__prompt_kernel:
  s_cmp_ge_u32 s2, 256
  s_cbranch_scc1 L_end
  s_getpc_b64 s[96:97]
L_pc:
  v_lshlrev_b32 v2, 7, v0
  s_mov_b32 s3, L_end-L_pc
  v_min_u32 v2, s3, v2
  global_load_dword v254, v2, s[96:97]
  s_load_dwordx16 s[44:59], s[0:1], 0
  s_load_dwordx2 s[60:61], s[0:1], 64
  s_and_b32 s31, s2, 7
  s_lshr_b32 s39, s2, 3
  s_and_b32 s28, s31, 1
  s_lshr_b32 s29, s31, 1
  s_lshl_b32 s28, s28, 3
  s_lshl_b32 s29, s29, 2
  s_lshr_b32 s31, s39, 2
  s_and_b32 s39, s39, 3
  s_add_u32 s28, s28, s31
  s_add_u32 s29, s29, s39
  v_and_b32 v1, 63, v0
  v_lshrrev_b32 v2, 6, v0
  s_nop 0
  v_readfirstlane_b32 s30, v2
  v_lshlrev_b32 v10, 4, v1
  v_mov_b32 v11, 0
  s_nop 1
  s_and_b32 s70, s30, 3
  s_lshr_b32 s42, s70, 1
  s_and_b32 s43, s70, 1
  s_cmp_ge_u32 s30, 4
  s_cbranch_scc1 L_loader
  s_setprio 2
  s_waitcnt lgkmcnt(0)
  s_mov_b32 s4, s44
  s_mov_b32 s5, s45
  s_mov_b32 s6, 4194304
  s_mov_b32 s7, 0x20000
  s_mov_b32 s16, s58
  s_mov_b32 s17, s59
  s_mov_b32 s18, 256
  s_mov_b32 s19, 0x20000
  s_or_b32 s31, s2, s70
  s_cmp_lg_u32 s31, 0
  s_cbranch_scc1 L_notok
  s_memrealtime s[88:89]
  s_waitcnt lgkmcnt(0)
  s_or_b32 s88, s88, 1
  v_mov_b32 v2, s88
  v_cmp_eq_u32 vcc, 0, v1
  s_and_saveexec_b64 s[62:63], vcc
  buffer_store_dword v2, v11, s[16:19], 0 offen sc1
  s_mov_b64 exec, s[62:63]
L_notok:
  s_lshl_b32 s31, s28, 7
  s_lshl_b32 s39, s29, 3
  s_add_u32 s31, s31, s39
  s_lshl_b32 s39, s70, 1
  s_add_u32 s71, s31, s39
  s_lshl_b32 s31, s71, 11
  buffer_load_dwordx4 v[100:103], v10, s[4:7], s31 offen offset:0
  buffer_load_dwordx4 v[104:107], v10, s[4:7], s31 offen offset:1024
  buffer_load_dwordx4 v[108:111], v10, s[4:7], s31 offen offset:2048
  buffer_load_dwordx4 v[112:115], v10, s[4:7], s31 offen offset:3072
  s_mov_b32 s12, s60
  s_mov_b32 s13, s61
  s_mov_b32 s14, 58720256
  s_mov_b32 s15, 0x20000
  s_lshl_b32 s68, s42, 2
  s_lshl_b32 s69, s68, 4
  v_and_b32 v12, 15, v1
  v_add_u32 v12, s69, v12
  v_lshlrev_b32 v12, 7, v12
  v_lshrrev_b32 v7, 4, v1
  s_lshl_b32 s68, s42, 2
  s_lshl_b32 s69, s68, 4
  v_and_b32 v6, 15, v1
  v_add_u32 v6, s69, v6
  v_lshrrev_b32 v6, 1, v6
  v_and_b32 v6, 7, v6
  v_xor_b32 v7, v7, v6
  v_lshlrev_b32 v7, 4, v7
  v_add_u32 v12, v12, v7
  s_lshl_b32 s68, s42, 2
  s_lshl_b32 s69, s68, 4
  v_and_b32 v13, 15, v1
  v_add_u32 v13, s69, v13
  v_lshlrev_b32 v13, 7, v13
  v_lshrrev_b32 v7, 4, v1
  v_add_u32 v7, 4, v7
  s_lshl_b32 s68, s42, 2
  s_lshl_b32 s69, s68, 4
  v_and_b32 v6, 15, v1
  v_add_u32 v6, s69, v6
  v_lshrrev_b32 v6, 1, v6
  v_and_b32 v6, 7, v6
  v_xor_b32 v7, v7, v6
  v_lshlrev_b32 v7, 4, v7
  v_add_u32 v13, v13, v7
  v_lshrrev_b32 v16, 4, v1
  v_lshlrev_b32 v16, 3, v16
  v_lshrrev_b32 v7, 2, v1
  v_and_b32 v7, 3, v7
  v_add_u32 v16, v16, v7
  v_mul_u32_u24 v16, 0x180, v16
  s_lshl_b32 s68, s43, 5
  s_lshr_b32 s69, s68, 3
  v_lshrrev_b32 v7, 1, v1
  v_and_b32 v7, 1, v7
  v_add_u32 v7, s69, v7
  v_lshrrev_b32 v6, 4, v1
  v_lshlrev_b32 v6, 3, v6
  v_lshrrev_b32 v5, 2, v1
  v_and_b32 v5, 3, v5
  v_add_u32 v6, v6, v5
  v_lshrrev_b32 v6, 1, v6
  v_and_b32 v6, 1, v6
  v_lshrrev_b32 v5, 4, v1
  v_lshlrev_b32 v5, 3, v5
  v_lshrrev_b32 v4, 2, v1
  v_and_b32 v4, 3, v4
  v_add_u32 v5, v5, v4
  v_lshrrev_b32 v5, 3, v5
  v_and_b32 v5, 1, v5
  v_lshlrev_b32 v5, 1, v5
  v_or_b32 v6, v6, v5
  v_lshlrev_b32 v6, 1, v6
  v_xor_b32 v7, v7, v6
  v_lshlrev_b32 v7, 4, v7
  v_add_u32 v16, v16, v7
  v_and_b32 v7, 1, v1
  v_lshlrev_b32 v7, 3, v7
  v_add_u32 v16, v16, v7
  v_add_u32 v16, 0x4000, v16
  v_lshrrev_b32 v17, 4, v1
  v_lshlrev_b32 v17, 3, v17
  v_lshrrev_b32 v7, 2, v1
  v_and_b32 v7, 3, v7
  v_add_u32 v17, v17, v7
  v_mul_u32_u24 v17, 0x180, v17
  s_lshl_b32 s67, s43, 5
  s_add_u32 s68, s67, 16
  s_lshr_b32 s69, s68, 3
  v_lshrrev_b32 v7, 1, v1
  v_and_b32 v7, 1, v7
  v_add_u32 v7, s69, v7
  v_lshrrev_b32 v6, 4, v1
  v_lshlrev_b32 v6, 3, v6
  v_lshrrev_b32 v5, 2, v1
  v_and_b32 v5, 3, v5
  v_add_u32 v6, v6, v5
  v_lshrrev_b32 v6, 1, v6
  v_and_b32 v6, 1, v6
  v_lshrrev_b32 v5, 4, v1
  v_lshlrev_b32 v5, 3, v5
  v_lshrrev_b32 v4, 2, v1
  v_and_b32 v4, 3, v4
  v_add_u32 v5, v5, v4
  v_lshrrev_b32 v5, 3, v5
  v_and_b32 v5, 1, v5
  v_lshlrev_b32 v5, 1, v5
  v_or_b32 v6, v6, v5
  v_lshlrev_b32 v6, 1, v6
  v_xor_b32 v7, v7, v6
  v_lshlrev_b32 v7, 4, v7
  v_add_u32 v17, v17, v7
  v_and_b32 v7, 1, v1
  v_lshlrev_b32 v7, 3, v7
  v_add_u32 v17, v17, v7
  v_add_u32 v17, 0x4000, v17
  s_nop 0
  s_waitcnt vmcnt(0)
  v_lshlrev_b32 v116, 16, v100
  v_and_b32 v117, 0xffff0000, v100
  v_lshlrev_b32 v118, 16, v101
  v_and_b32 v119, 0xffff0000, v101
  v_lshlrev_b32 v120, 16, v102
  v_and_b32 v121, 0xffff0000, v102
  v_lshlrev_b32 v122, 16, v103
  v_and_b32 v123, 0xffff0000, v103
  v_lshlrev_b32 v124, 16, v104
  v_and_b32 v125, 0xffff0000, v104
  v_lshlrev_b32 v126, 16, v105
  v_and_b32 v127, 0xffff0000, v105
  v_lshlrev_b32 v128, 16, v106
  v_and_b32 v129, 0xffff0000, v106
  v_lshlrev_b32 v130, 16, v107
  v_and_b32 v131, 0xffff0000, v107
  v_lshlrev_b32 v132, 16, v108
  v_and_b32 v133, 0xffff0000, v108
  v_lshlrev_b32 v134, 16, v109
  v_and_b32 v135, 0xffff0000, v109
  v_lshlrev_b32 v136, 16, v110
  v_and_b32 v137, 0xffff0000, v110
  v_lshlrev_b32 v138, 16, v111
  v_and_b32 v139, 0xffff0000, v111
  v_lshlrev_b32 v140, 16, v112
  v_and_b32 v141, 0xffff0000, v112
  v_lshlrev_b32 v142, 16, v113
  v_and_b32 v143, 0xffff0000, v113
  v_lshlrev_b32 v144, 16, v114
  v_and_b32 v145, 0xffff0000, v114
  v_lshlrev_b32 v146, 16, v115
  v_and_b32 v147, 0xffff0000, v115
  v_add_f32 v148, v116, v117
  v_add_f32 v150, v118, v119
  v_add_f32 v149, v132, v133
  v_add_f32 v151, v134, v135
  v_add_f32 v148, v148, v120
  v_add_f32 v150, v150, v121
  v_add_f32 v149, v149, v136
  v_add_f32 v151, v151, v137
  v_add_f32 v148, v148, v122
  v_add_f32 v150, v150, v123
  v_add_f32 v149, v149, v138
  v_add_f32 v151, v151, v139
  v_add_f32 v148, v148, v124
  v_add_f32 v150, v150, v125
  v_add_f32 v149, v149, v140
  v_add_f32 v151, v151, v141
  v_add_f32 v148, v148, v126
  v_add_f32 v150, v150, v127
  v_add_f32 v149, v149, v142
  v_add_f32 v151, v151, v143
  v_add_f32 v148, v148, v128
  v_add_f32 v150, v150, v129
  v_add_f32 v149, v149, v144
  v_add_f32 v151, v151, v145
  v_add_f32 v148, v148, v130
  v_add_f32 v150, v150, v131
  v_add_f32 v149, v149, v146
  v_add_f32 v151, v151, v147
  v_add_f32 v148, v148, v150
  v_add_f32 v149, v149, v151
  s_nop 0
  s_nop 0
  v_add_f32_dpp v148, v148, v148 quad_perm:[1,0,3,2] row_mask:0xf bank_mask:0xf
  v_add_f32_dpp v149, v149, v149 quad_perm:[1,0,3,2] row_mask:0xf bank_mask:0xf
  s_nop 0
  v_add_f32_dpp v148, v148, v148 quad_perm:[2,3,0,1] row_mask:0xf bank_mask:0xf
  v_add_f32_dpp v149, v149, v149 quad_perm:[2,3,0,1] row_mask:0xf bank_mask:0xf
  s_nop 0
  v_add_f32_dpp v148, v148, v148 row_half_mirror row_mask:0xf bank_mask:0xf
  v_add_f32_dpp v149, v149, v149 row_half_mirror row_mask:0xf bank_mask:0xf
  s_nop 0
  v_add_f32_dpp v148, v148, v148 row_mirror row_mask:0xf bank_mask:0xf
  v_add_f32_dpp v149, v149, v149 row_mirror row_mask:0xf bank_mask:0xf
  v_mov_b32 v152, v148
  v_mov_b32 v153, v149
  s_nop 0
  v_permlane16_swap_b32 v152, v148
  v_permlane16_swap_b32 v153, v149
  s_nop 0
  v_add_f32 v148, v148, v152
  v_add_f32 v149, v149, v153
  v_mov_b32 v152, v148
  v_mov_b32 v153, v149
  s_nop 0
  v_permlane32_swap_b32 v152, v148
  v_permlane32_swap_b32 v153, v149
  s_nop 0
  v_add_f32 v148, v148, v152
  v_add_f32 v149, v149, v153
  v_mul_f32 v148, 0x3a800000, v148
  v_mul_f32 v149, 0x3a800000, v149
  v_sub_f32 v116, v116, v148
  v_sub_f32 v132, v132, v149
  v_sub_f32 v117, v117, v148
  v_sub_f32 v133, v133, v149
  v_sub_f32 v118, v118, v148
  v_sub_f32 v134, v134, v149
  v_sub_f32 v119, v119, v148
  v_sub_f32 v135, v135, v149
  v_sub_f32 v120, v120, v148
  v_sub_f32 v136, v136, v149
  v_sub_f32 v121, v121, v148
  v_sub_f32 v137, v137, v149
  v_sub_f32 v122, v122, v148
  v_sub_f32 v138, v138, v149
  v_sub_f32 v123, v123, v148
  v_sub_f32 v139, v139, v149
  v_sub_f32 v124, v124, v148
  v_sub_f32 v140, v140, v149
  v_sub_f32 v125, v125, v148
  v_sub_f32 v141, v141, v149
  v_sub_f32 v126, v126, v148
  v_sub_f32 v142, v142, v149
  v_sub_f32 v127, v127, v148
  v_sub_f32 v143, v143, v149
  v_sub_f32 v128, v128, v148
  v_sub_f32 v144, v144, v149
  v_sub_f32 v129, v129, v148
  v_sub_f32 v145, v145, v149
  v_sub_f32 v130, v130, v148
  v_sub_f32 v146, v146, v149
  v_sub_f32 v131, v131, v148
  v_sub_f32 v147, v147, v149
  v_mul_f32 v150, v116, v116
  v_mul_f32 v151, v132, v132
  v_fmac_f32 v150, v117, v117
  v_fmac_f32 v151, v133, v133
  v_fmac_f32 v150, v118, v118
  v_fmac_f32 v151, v134, v134
  v_fmac_f32 v150, v119, v119
  v_fmac_f32 v151, v135, v135
  v_fmac_f32 v150, v120, v120
  v_fmac_f32 v151, v136, v136
  v_fmac_f32 v150, v121, v121
  v_fmac_f32 v151, v137, v137
  v_fmac_f32 v150, v122, v122
  v_fmac_f32 v151, v138, v138
  v_fmac_f32 v150, v123, v123
  v_fmac_f32 v151, v139, v139
  v_fmac_f32 v150, v124, v124
  v_fmac_f32 v151, v140, v140
  v_fmac_f32 v150, v125, v125
  v_fmac_f32 v151, v141, v141
  v_fmac_f32 v150, v126, v126
  v_fmac_f32 v151, v142, v142
  v_fmac_f32 v150, v127, v127
  v_fmac_f32 v151, v143, v143
  v_fmac_f32 v150, v128, v128
  v_fmac_f32 v151, v144, v144
  v_fmac_f32 v150, v129, v129
  v_fmac_f32 v151, v145, v145
  v_fmac_f32 v150, v130, v130
  v_fmac_f32 v151, v146, v146
  v_fmac_f32 v150, v131, v131
  v_fmac_f32 v151, v147, v147
  s_nop 0
  s_nop 0
  v_add_f32_dpp v150, v150, v150 quad_perm:[1,0,3,2] row_mask:0xf bank_mask:0xf
  v_add_f32_dpp v151, v151, v151 quad_perm:[1,0,3,2] row_mask:0xf bank_mask:0xf
  s_nop 0
  v_add_f32_dpp v150, v150, v150 quad_perm:[2,3,0,1] row_mask:0xf bank_mask:0xf
  v_add_f32_dpp v151, v151, v151 quad_perm:[2,3,0,1] row_mask:0xf bank_mask:0xf
  s_nop 0
  v_add_f32_dpp v150, v150, v150 row_half_mirror row_mask:0xf bank_mask:0xf
  v_add_f32_dpp v151, v151, v151 row_half_mirror row_mask:0xf bank_mask:0xf
  s_nop 0
  v_add_f32_dpp v150, v150, v150 row_mirror row_mask:0xf bank_mask:0xf
  v_add_f32_dpp v151, v151, v151 row_mirror row_mask:0xf bank_mask:0xf
  v_mov_b32 v152, v150
  v_mov_b32 v153, v151
  s_nop 0
  v_permlane16_swap_b32 v152, v150
  v_permlane16_swap_b32 v153, v151
  s_nop 0
  v_add_f32 v150, v150, v152
  v_add_f32 v151, v151, v153
  v_mov_b32 v152, v150
  v_mov_b32 v153, v151
  s_nop 0
  v_permlane32_swap_b32 v152, v150
  v_permlane32_swap_b32 v153, v151
  s_nop 0
  v_add_f32 v150, v150, v152
  v_add_f32 v151, v151, v153
  v_mul_f32 v150, 0x3a800000, v150
  v_add_f32 v150, 0x3727c5ac, v150
  v_mul_f32 v151, 0x3a800000, v151
  v_add_f32 v151, 0x3727c5ac, v151
  v_rsq_f32 v150, v150
  v_rsq_f32 v151, v151
  v_mov_b32 v116, v148
  v_mov_b32 v118, v149
  v_mov_b32 v117, v150
  v_mov_b32 v119, v151
  s_lshl_b32 s31, s71, 3
  s_add_u32 s31, s31, 37748736
  v_cmp_eq_u32 vcc, 0, v1
  s_and_saveexec_b64 s[62:63], vcc
  buffer_store_dwordx4 v[116:119], v11, s[12:15], s31 offen sc1
  s_mov_b64 exec, s[62:63]
  s_lshl_b32 s31, s2, 2
  s_add_u32 s31, s31, s70
  s_lshl_b32 s39, s31, 4
  v_and_b32 v197, 15, v1
  v_add_u32 v197, s39, v197
  v_lshlrev_b32 v197, 7, v197
  s_mul_i32 s39, s31, 56
  v_min_u32 v198, 55, v1
  v_add_u32 v198, s39, v198
  v_lshlrev_b32 v198, 7, v198
  s_and_b32 s31, s2, 56
  s_lshr_b32 s31, s31, 3
  s_add_u32 s71, s31, 3
  s_mov_b32 s34, 0
  v_add_u32 v14, s34, v12
  v_add_u32 v15, s34, v13
  v_add_u32 v18, s34, v16
  v_add_u32 v19, s34, v17
  s_waitcnt lgkmcnt(0)
  s_setprio 0
  s_barrier
  ds_read_b128 v[20:23], v14 offset:0
  ds_read_b64_tr_b16 v[52:53], v18 offset:0
  ds_read_b64_tr_b16 v[54:55], v18 offset:1536
  ds_read_b128 v[24:27], v14 offset:2048
  ds_read_b128 v[28:31], v14 offset:4096
  ds_read_b128 v[32:35], v14 offset:6144
  ds_read_b64_tr_b16 v[56:57], v19 offset:0
  ds_read_b64_tr_b16 v[58:59], v19 offset:1536
  ds_read_b64_tr_b16 v[60:61], v18 offset:128
  ds_read_b64_tr_b16 v[62:63], v18 offset:1664
  ds_read_b64_tr_b16 v[64:65], v19 offset:128
  ds_read_b64_tr_b16 v[66:67], v19 offset:1664
  ds_read_b64_tr_b16 v[68:69], v18 offset:256
  ds_read_b64_tr_b16 v[70:71], v18 offset:1792
  ds_read_b64_tr_b16 v[72:73], v19 offset:256
  ds_read_b64_tr_b16 v[74:75], v19 offset:1792
  s_waitcnt lgkmcnt(13)
  v_mfma_f32_16x16x32_bf16 v[100:103], v[52:55], v[20:23], 0
  ds_read_b128 v[36:39], v15 offset:0
  s_waitcnt lgkmcnt(13)
  v_mfma_f32_16x16x32_bf16 v[124:127], v[52:55], v[24:27], 0
  ds_read_b64_tr_b16 v[76:77], v18 offset:12288
  s_waitcnt lgkmcnt(13)
  v_mfma_f32_16x16x32_bf16 v[148:151], v[52:55], v[28:31], 0
  ds_read_b64_tr_b16 v[78:79], v18 offset:13824
  s_waitcnt lgkmcnt(13)
  v_mfma_f32_16x16x32_bf16 v[172:175], v[52:55], v[32:35], 0
  ds_read_b128 v[40:43], v15 offset:2048
  s_waitcnt lgkmcnt(12)
  v_mfma_f32_16x16x32_bf16 v[176:179], v[56:59], v[32:35], 0
  ds_read_b128 v[44:47], v15 offset:4096
  v_mfma_f32_16x16x32_bf16 v[152:155], v[56:59], v[28:31], 0
  ds_read_b128 v[48:51], v15 offset:6144
  v_mfma_f32_16x16x32_bf16 v[128:131], v[56:59], v[24:27], 0
  ds_read_b64_tr_b16 v[80:81], v19 offset:12288
  v_mfma_f32_16x16x32_bf16 v[104:107], v[56:59], v[20:23], 0
  ds_read_b64_tr_b16 v[82:83], v19 offset:13824
  s_waitcnt lgkmcnt(14)
  v_mfma_f32_16x16x32_bf16 v[108:111], v[60:63], v[20:23], 0
  v_mfma_f32_16x16x32_bf16 v[132:135], v[60:63], v[24:27], 0
  ds_read_b64_tr_b16 v[84:85], v18 offset:12416
  v_mfma_f32_16x16x32_bf16 v[156:159], v[60:63], v[28:31], 0
  ds_read_b64_tr_b16 v[86:87], v18 offset:13952
  v_mfma_f32_16x16x32_bf16 v[180:183], v[60:63], v[32:35], 0
  ds_read_b64_tr_b16 v[88:89], v19 offset:12416
  s_waitcnt lgkmcnt(15)
  v_mfma_f32_16x16x32_bf16 v[184:187], v[64:67], v[32:35], 0
  ds_read_b64_tr_b16 v[90:91], v19 offset:13952
  v_mfma_f32_16x16x32_bf16 v[160:163], v[64:67], v[28:31], 0
  ds_read_b64_tr_b16 v[92:93], v18 offset:12544
  v_mfma_f32_16x16x32_bf16 v[136:139], v[64:67], v[24:27], 0
  ds_read_b64_tr_b16 v[94:95], v18 offset:14080
  v_mfma_f32_16x16x32_bf16 v[112:115], v[64:67], v[20:23], 0
  ds_read_b64_tr_b16 v[96:97], v19 offset:12544
  s_waitcnt lgkmcnt(15)
  v_mfma_f32_16x16x32_bf16 v[116:119], v[20:23], v[68:71], 0
  ds_read_b64_tr_b16 v[98:99], v19 offset:14080
  v_mfma_f32_16x16x32_bf16 v[140:143], v[24:27], v[68:71], 0
  v_mfma_f32_16x16x32_bf16 v[164:167], v[28:31], v[68:71], 0
  v_mfma_f32_16x16x32_bf16 v[188:191], v[32:35], v[68:71], 0
  v_mfma_f32_16x16x32_bf16 v[192:195], v[32:35], v[72:75], 0
  v_mfma_f32_16x16x32_bf16 v[168:171], v[28:31], v[72:75], 0
  v_mfma_f32_16x16x32_bf16 v[144:147], v[24:27], v[72:75], 0
  v_mfma_f32_16x16x32_bf16 v[120:123], v[20:23], v[72:75], 0
  s_add_u32 s34, s34, 40960
  s_cmp_eq_u32 s34, 122880
  s_cselect_b32 s34, 0, s34
  v_add_u32 v14, s34, v12
  v_add_u32 v15, s34, v13
  v_add_u32 v18, s34, v16
  v_add_u32 v19, s34, v17
  s_waitcnt lgkmcnt(0)
  s_barrier
  v_mfma_f32_16x16x32_bf16 v[100:103], v[76:79], v[36:39], v[100:103]
  ds_read_b128 v[20:23], v14 offset:0
  v_mfma_f32_16x16x32_bf16 v[124:127], v[76:79], v[40:43], v[124:127]
  ds_read_b64_tr_b16 v[52:53], v18 offset:0
  v_mfma_f32_16x16x32_bf16 v[148:151], v[76:79], v[44:47], v[148:151]
  ds_read_b64_tr_b16 v[54:55], v18 offset:1536
  v_mfma_f32_16x16x32_bf16 v[172:175], v[76:79], v[48:51], v[172:175]
  ds_read_b128 v[24:27], v14 offset:2048
  v_mfma_f32_16x16x32_bf16 v[176:179], v[80:83], v[48:51], v[176:179]
  ds_read_b128 v[28:31], v14 offset:4096
  v_mfma_f32_16x16x32_bf16 v[152:155], v[80:83], v[44:47], v[152:155]
  ds_read_b128 v[32:35], v14 offset:6144
  v_mfma_f32_16x16x32_bf16 v[128:131], v[80:83], v[40:43], v[128:131]
  ds_read_b64_tr_b16 v[56:57], v19 offset:0
  v_mfma_f32_16x16x32_bf16 v[104:107], v[80:83], v[36:39], v[104:107]
  ds_read_b64_tr_b16 v[58:59], v19 offset:1536
  v_mfma_f32_16x16x32_bf16 v[108:111], v[84:87], v[36:39], v[108:111]
  v_mfma_f32_16x16x32_bf16 v[132:135], v[84:87], v[40:43], v[132:135]
  ds_read_b64_tr_b16 v[60:61], v18 offset:128
  v_mfma_f32_16x16x32_bf16 v[156:159], v[84:87], v[44:47], v[156:159]
  ds_read_b64_tr_b16 v[62:63], v18 offset:1664
  v_mfma_f32_16x16x32_bf16 v[180:183], v[84:87], v[48:51], v[180:183]
  ds_read_b64_tr_b16 v[64:65], v19 offset:128
  v_mfma_f32_16x16x32_bf16 v[184:187], v[88:91], v[48:51], v[184:187]
  ds_read_b64_tr_b16 v[66:67], v19 offset:1664
  v_mfma_f32_16x16x32_bf16 v[160:163], v[88:91], v[44:47], v[160:163]
  ds_read_b64_tr_b16 v[68:69], v18 offset:256
  v_mfma_f32_16x16x32_bf16 v[136:139], v[88:91], v[40:43], v[136:139]
  ds_read_b64_tr_b16 v[70:71], v18 offset:1792
  v_mfma_f32_16x16x32_bf16 v[112:115], v[88:91], v[36:39], v[112:115]
  ds_read_b64_tr_b16 v[72:73], v19 offset:256
  v_mfma_f32_16x16x32_bf16 v[116:119], v[36:39], v[92:95], v[116:119]
  ds_read_b64_tr_b16 v[74:75], v19 offset:1792
  v_mfma_f32_16x16x32_bf16 v[140:143], v[40:43], v[92:95], v[140:143]
  v_mfma_f32_16x16x32_bf16 v[164:167], v[44:47], v[92:95], v[164:167]
  v_mfma_f32_16x16x32_bf16 v[188:191], v[48:51], v[92:95], v[188:191]
  v_mfma_f32_16x16x32_bf16 v[192:195], v[48:51], v[96:99], v[192:195]
  v_mfma_f32_16x16x32_bf16 v[168:171], v[44:47], v[96:99], v[168:171]
  v_mfma_f32_16x16x32_bf16 v[144:147], v[40:43], v[96:99], v[144:147]
  v_mfma_f32_16x16x32_bf16 v[120:123], v[36:39], v[96:99], v[120:123]
  s_waitcnt lgkmcnt(13)
  v_mfma_f32_16x16x32_bf16 v[100:103], v[52:55], v[20:23], v[100:103]
  ds_read_b128 v[36:39], v15 offset:0
  s_waitcnt lgkmcnt(13)
  v_mfma_f32_16x16x32_bf16 v[124:127], v[52:55], v[24:27], v[124:127]
  ds_read_b64_tr_b16 v[76:77], v18 offset:12288
  s_waitcnt lgkmcnt(13)
  v_mfma_f32_16x16x32_bf16 v[148:151], v[52:55], v[28:31], v[148:151]
  ds_read_b64_tr_b16 v[78:79], v18 offset:13824
  s_waitcnt lgkmcnt(13)
  v_mfma_f32_16x16x32_bf16 v[172:175], v[52:55], v[32:35], v[172:175]
  ds_read_b128 v[40:43], v15 offset:2048
  s_waitcnt lgkmcnt(12)
  v_mfma_f32_16x16x32_bf16 v[176:179], v[56:59], v[32:35], v[176:179]
  ds_read_b128 v[44:47], v15 offset:4096
  v_mfma_f32_16x16x32_bf16 v[152:155], v[56:59], v[28:31], v[152:155]
  ds_read_b128 v[48:51], v15 offset:6144
  v_mfma_f32_16x16x32_bf16 v[128:131], v[56:59], v[24:27], v[128:131]
  ds_read_b64_tr_b16 v[80:81], v19 offset:12288
  v_mfma_f32_16x16x32_bf16 v[104:107], v[56:59], v[20:23], v[104:107]
  ds_read_b64_tr_b16 v[82:83], v19 offset:13824
  s_waitcnt lgkmcnt(14)
  v_mfma_f32_16x16x32_bf16 v[108:111], v[60:63], v[20:23], v[108:111]
  v_mfma_f32_16x16x32_bf16 v[132:135], v[60:63], v[24:27], v[132:135]
  ds_read_b64_tr_b16 v[84:85], v18 offset:12416
  v_mfma_f32_16x16x32_bf16 v[156:159], v[60:63], v[28:31], v[156:159]
  ds_read_b64_tr_b16 v[86:87], v18 offset:13952
  v_mfma_f32_16x16x32_bf16 v[180:183], v[60:63], v[32:35], v[180:183]
  ds_read_b64_tr_b16 v[88:89], v19 offset:12416
  s_waitcnt lgkmcnt(15)
  v_mfma_f32_16x16x32_bf16 v[184:187], v[64:67], v[32:35], v[184:187]
  ds_read_b64_tr_b16 v[90:91], v19 offset:13952
  v_mfma_f32_16x16x32_bf16 v[160:163], v[64:67], v[28:31], v[160:163]
  ds_read_b64_tr_b16 v[92:93], v18 offset:12544
  v_mfma_f32_16x16x32_bf16 v[136:139], v[64:67], v[24:27], v[136:139]
  ds_read_b64_tr_b16 v[94:95], v18 offset:14080
  v_mfma_f32_16x16x32_bf16 v[112:115], v[64:67], v[20:23], v[112:115]
  ds_read_b64_tr_b16 v[96:97], v19 offset:12544
  s_waitcnt lgkmcnt(15)
  v_mfma_f32_16x16x32_bf16 v[116:119], v[20:23], v[68:71], v[116:119]
  ds_read_b64_tr_b16 v[98:99], v19 offset:14080
  v_mfma_f32_16x16x32_bf16 v[140:143], v[24:27], v[68:71], v[140:143]
  v_mfma_f32_16x16x32_bf16 v[164:167], v[28:31], v[68:71], v[164:167]
  s_add_u32 s34, s34, 40960
  s_cmp_eq_u32 s34, 122880
  s_cselect_b32 s34, 0, s34
  v_mfma_f32_16x16x32_bf16 v[188:191], v[32:35], v[68:71], v[188:191]
  v_add_u32 v14, s34, v12
  v_mfma_f32_16x16x32_bf16 v[192:195], v[32:35], v[72:75], v[192:195]
  v_add_u32 v15, s34, v13
  v_mfma_f32_16x16x32_bf16 v[168:171], v[28:31], v[72:75], v[168:171]
  v_add_u32 v18, s34, v16
  v_mfma_f32_16x16x32_bf16 v[144:147], v[24:27], v[72:75], v[144:147]
  v_add_u32 v19, s34, v17
  v_mfma_f32_16x16x32_bf16 v[120:123], v[20:23], v[72:75], v[120:123]
  s_waitcnt lgkmcnt(0)
  s_waitcnt vmcnt(0)
  s_barrier
  s_mov_b32 s36, 13
  s_branch L_loop_q
L_top_q:
  s_barrier
L_loop_q:
  v_mfma_f32_16x16x32_bf16 v[100:103], v[76:79], v[36:39], v[100:103]
  ds_read_b128 v[20:23], v14 offset:0
  v_mfma_f32_16x16x32_bf16 v[124:127], v[76:79], v[40:43], v[124:127]
  ds_read_b64_tr_b16 v[52:53], v18 offset:0
  v_mfma_f32_16x16x32_bf16 v[148:151], v[76:79], v[44:47], v[148:151]
  ds_read_b64_tr_b16 v[54:55], v18 offset:1536
  v_mfma_f32_16x16x32_bf16 v[172:175], v[76:79], v[48:51], v[172:175]
  ds_read_b128 v[24:27], v14 offset:2048
  v_mfma_f32_16x16x32_bf16 v[176:179], v[80:83], v[48:51], v[176:179]
  ds_read_b128 v[28:31], v14 offset:4096
  v_mfma_f32_16x16x32_bf16 v[152:155], v[80:83], v[44:47], v[152:155]
  ds_read_b128 v[32:35], v14 offset:6144
  v_mfma_f32_16x16x32_bf16 v[128:131], v[80:83], v[40:43], v[128:131]
  ds_read_b64_tr_b16 v[56:57], v19 offset:0
  v_mfma_f32_16x16x32_bf16 v[104:107], v[80:83], v[36:39], v[104:107]
  ds_read_b64_tr_b16 v[58:59], v19 offset:1536
  s_cmp_eq_u32 s36, s71
  s_cbranch_scc1 L_hk_q_s71
L_hkb_q_s71:
  v_mfma_f32_16x16x32_bf16 v[108:111], v[84:87], v[36:39], v[108:111]
  v_mfma_f32_16x16x32_bf16 v[132:135], v[84:87], v[40:43], v[132:135]
  ds_read_b64_tr_b16 v[60:61], v18 offset:128
  v_mfma_f32_16x16x32_bf16 v[156:159], v[84:87], v[44:47], v[156:159]
  ds_read_b64_tr_b16 v[62:63], v18 offset:1664
  v_mfma_f32_16x16x32_bf16 v[180:183], v[84:87], v[48:51], v[180:183]
  ds_read_b64_tr_b16 v[64:65], v19 offset:128
  v_mfma_f32_16x16x32_bf16 v[184:187], v[88:91], v[48:51], v[184:187]
  ds_read_b64_tr_b16 v[66:67], v19 offset:1664
  v_mfma_f32_16x16x32_bf16 v[160:163], v[88:91], v[44:47], v[160:163]
  ds_read_b64_tr_b16 v[68:69], v18 offset:256
  v_mfma_f32_16x16x32_bf16 v[136:139], v[88:91], v[40:43], v[136:139]
  ds_read_b64_tr_b16 v[70:71], v18 offset:1792
  v_mfma_f32_16x16x32_bf16 v[112:115], v[88:91], v[36:39], v[112:115]
  ds_read_b64_tr_b16 v[72:73], v19 offset:256
  v_mfma_f32_16x16x32_bf16 v[116:119], v[36:39], v[92:95], v[116:119]
  ds_read_b64_tr_b16 v[74:75], v19 offset:1792
  v_mfma_f32_16x16x32_bf16 v[140:143], v[40:43], v[92:95], v[140:143]
  v_mfma_f32_16x16x32_bf16 v[164:167], v[44:47], v[92:95], v[164:167]
  v_mfma_f32_16x16x32_bf16 v[188:191], v[48:51], v[92:95], v[188:191]
  v_mfma_f32_16x16x32_bf16 v[192:195], v[48:51], v[96:99], v[192:195]
  v_mfma_f32_16x16x32_bf16 v[168:171], v[44:47], v[96:99], v[168:171]
  v_mfma_f32_16x16x32_bf16 v[144:147], v[40:43], v[96:99], v[144:147]
  v_mfma_f32_16x16x32_bf16 v[120:123], v[36:39], v[96:99], v[120:123]
  s_waitcnt lgkmcnt(13)
  v_mfma_f32_16x16x32_bf16 v[100:103], v[52:55], v[20:23], v[100:103]
  ds_read_b128 v[36:39], v15 offset:0
  s_waitcnt lgkmcnt(13)
  v_mfma_f32_16x16x32_bf16 v[124:127], v[52:55], v[24:27], v[124:127]
  ds_read_b64_tr_b16 v[76:77], v18 offset:12288
  s_waitcnt lgkmcnt(13)
  v_mfma_f32_16x16x32_bf16 v[148:151], v[52:55], v[28:31], v[148:151]
  ds_read_b64_tr_b16 v[78:79], v18 offset:13824
  s_waitcnt lgkmcnt(13)
  v_mfma_f32_16x16x32_bf16 v[172:175], v[52:55], v[32:35], v[172:175]
  ds_read_b128 v[40:43], v15 offset:2048
  s_waitcnt lgkmcnt(12)
  v_mfma_f32_16x16x32_bf16 v[176:179], v[56:59], v[32:35], v[176:179]
  ds_read_b128 v[44:47], v15 offset:4096
  v_mfma_f32_16x16x32_bf16 v[152:155], v[56:59], v[28:31], v[152:155]
  ds_read_b128 v[48:51], v15 offset:6144
  v_mfma_f32_16x16x32_bf16 v[128:131], v[56:59], v[24:27], v[128:131]
  ds_read_b64_tr_b16 v[80:81], v19 offset:12288
  v_mfma_f32_16x16x32_bf16 v[104:107], v[56:59], v[20:23], v[104:107]
  ds_read_b64_tr_b16 v[82:83], v19 offset:13824
  s_waitcnt lgkmcnt(14)
  v_mfma_f32_16x16x32_bf16 v[108:111], v[60:63], v[20:23], v[108:111]
  v_mfma_f32_16x16x32_bf16 v[132:135], v[60:63], v[24:27], v[132:135]
  ds_read_b64_tr_b16 v[84:85], v18 offset:12416
  v_mfma_f32_16x16x32_bf16 v[156:159], v[60:63], v[28:31], v[156:159]
  ds_read_b64_tr_b16 v[86:87], v18 offset:13952
  v_mfma_f32_16x16x32_bf16 v[180:183], v[60:63], v[32:35], v[180:183]
  ds_read_b64_tr_b16 v[88:89], v19 offset:12416
  s_waitcnt lgkmcnt(15)
  v_mfma_f32_16x16x32_bf16 v[184:187], v[64:67], v[32:35], v[184:187]
  ds_read_b64_tr_b16 v[90:91], v19 offset:13952
  v_mfma_f32_16x16x32_bf16 v[160:163], v[64:67], v[28:31], v[160:163]
  ds_read_b64_tr_b16 v[92:93], v18 offset:12544
  v_mfma_f32_16x16x32_bf16 v[136:139], v[64:67], v[24:27], v[136:139]
  ds_read_b64_tr_b16 v[94:95], v18 offset:14080
  v_mfma_f32_16x16x32_bf16 v[112:115], v[64:67], v[20:23], v[112:115]
  ds_read_b64_tr_b16 v[96:97], v19 offset:12544
  s_waitcnt lgkmcnt(15)
  v_mfma_f32_16x16x32_bf16 v[116:119], v[20:23], v[68:71], v[116:119]
  ds_read_b64_tr_b16 v[98:99], v19 offset:14080
  v_mfma_f32_16x16x32_bf16 v[140:143], v[24:27], v[68:71], v[140:143]
  v_mfma_f32_16x16x32_bf16 v[164:167], v[28:31], v[68:71], v[164:167]
  s_add_u32 s34, s34, 40960
  s_cmp_eq_u32 s34, 122880
  s_cselect_b32 s34, 0, s34
  v_add_u32 v14, s34, v12
  v_mfma_f32_16x16x32_bf16 v[188:191], v[32:35], v[68:71], v[188:191]
  v_add_u32 v15, s34, v13
  v_mfma_f32_16x16x32_bf16 v[192:195], v[32:35], v[72:75], v[192:195]
  v_add_u32 v18, s34, v16
  v_mfma_f32_16x16x32_bf16 v[168:171], v[28:31], v[72:75], v[168:171]
  v_add_u32 v19, s34, v17
  v_mfma_f32_16x16x32_bf16 v[144:147], v[24:27], v[72:75], v[144:147]
  s_sub_u32 s36, s36, 1
  s_cmp_lg_u32 s36, 0
  v_mfma_f32_16x16x32_bf16 v[120:123], v[20:23], v[72:75], v[120:123]
  s_waitcnt lgkmcnt(0)
  s_cbranch_scc1 L_top_q
  s_barrier
  v_mfma_f32_16x16x32_bf16 v[100:103], v[76:79], v[36:39], v[100:103]
  ds_read_b128 v[20:23], v14 offset:0
  v_mfma_f32_16x16x32_bf16 v[124:127], v[76:79], v[40:43], v[124:127]
  ds_read_b64_tr_b16 v[52:53], v18 offset:0
  v_mfma_f32_16x16x32_bf16 v[148:151], v[76:79], v[44:47], v[148:151]
  ds_read_b64_tr_b16 v[54:55], v18 offset:1536
  v_mfma_f32_16x16x32_bf16 v[172:175], v[76:79], v[48:51], v[172:175]
  ds_read_b128 v[24:27], v14 offset:2048
  v_mfma_f32_16x16x32_bf16 v[176:179], v[80:83], v[48:51], v[176:179]
  ds_read_b128 v[28:31], v14 offset:4096
  v_mfma_f32_16x16x32_bf16 v[152:155], v[80:83], v[44:47], v[152:155]
  ds_read_b128 v[32:35], v14 offset:6144
  v_mfma_f32_16x16x32_bf16 v[128:131], v[80:83], v[40:43], v[128:131]
  ds_read_b64_tr_b16 v[56:57], v19 offset:0
  v_mfma_f32_16x16x32_bf16 v[104:107], v[80:83], v[36:39], v[104:107]
  ds_read_b64_tr_b16 v[58:59], v19 offset:1536
  v_mfma_f32_16x16x32_bf16 v[108:111], v[84:87], v[36:39], v[108:111]
  v_mfma_f32_16x16x32_bf16 v[132:135], v[84:87], v[40:43], v[132:135]
  ds_read_b64_tr_b16 v[60:61], v18 offset:128
  v_mfma_f32_16x16x32_bf16 v[156:159], v[84:87], v[44:47], v[156:159]
  ds_read_b64_tr_b16 v[62:63], v18 offset:1664
  v_mfma_f32_16x16x32_bf16 v[180:183], v[84:87], v[48:51], v[180:183]
  ds_read_b64_tr_b16 v[64:65], v19 offset:128
  v_mfma_f32_16x16x32_bf16 v[184:187], v[88:91], v[48:51], v[184:187]
  ds_read_b64_tr_b16 v[66:67], v19 offset:1664
  v_mfma_f32_16x16x32_bf16 v[160:163], v[88:91], v[44:47], v[160:163]
  ds_read_b64_tr_b16 v[68:69], v18 offset:256
  v_mfma_f32_16x16x32_bf16 v[136:139], v[88:91], v[40:43], v[136:139]
  ds_read_b64_tr_b16 v[70:71], v18 offset:1792
  v_mfma_f32_16x16x32_bf16 v[112:115], v[88:91], v[36:39], v[112:115]
  ds_read_b64_tr_b16 v[72:73], v19 offset:256
  v_mfma_f32_16x16x32_bf16 v[116:119], v[36:39], v[92:95], v[116:119]
  ds_read_b64_tr_b16 v[74:75], v19 offset:1792
  v_mfma_f32_16x16x32_bf16 v[140:143], v[40:43], v[92:95], v[140:143]
  v_mfma_f32_16x16x32_bf16 v[164:167], v[44:47], v[92:95], v[164:167]
  v_mfma_f32_16x16x32_bf16 v[188:191], v[48:51], v[92:95], v[188:191]
  v_mfma_f32_16x16x32_bf16 v[192:195], v[48:51], v[96:99], v[192:195]
  v_mfma_f32_16x16x32_bf16 v[168:171], v[44:47], v[96:99], v[168:171]
  v_mfma_f32_16x16x32_bf16 v[144:147], v[40:43], v[96:99], v[144:147]
  v_mfma_f32_16x16x32_bf16 v[120:123], v[36:39], v[96:99], v[120:123]
  s_waitcnt lgkmcnt(13)
  v_mfma_f32_16x16x32_bf16 v[100:103], v[52:55], v[20:23], v[100:103]
  ds_read_b128 v[36:39], v15 offset:0
  s_waitcnt lgkmcnt(13)
  v_mfma_f32_16x16x32_bf16 v[124:127], v[52:55], v[24:27], v[124:127]
  ds_read_b64_tr_b16 v[76:77], v18 offset:12288
  s_waitcnt lgkmcnt(13)
  v_mfma_f32_16x16x32_bf16 v[148:151], v[52:55], v[28:31], v[148:151]
  ds_read_b64_tr_b16 v[78:79], v18 offset:13824
  s_waitcnt lgkmcnt(13)
  v_mfma_f32_16x16x32_bf16 v[172:175], v[52:55], v[32:35], v[172:175]
  ds_read_b128 v[40:43], v15 offset:2048
  s_waitcnt lgkmcnt(12)
  v_mfma_f32_16x16x32_bf16 v[176:179], v[56:59], v[32:35], v[176:179]
  ds_read_b128 v[44:47], v15 offset:4096
  v_mfma_f32_16x16x32_bf16 v[152:155], v[56:59], v[28:31], v[152:155]
  ds_read_b128 v[48:51], v15 offset:6144
  v_mfma_f32_16x16x32_bf16 v[128:131], v[56:59], v[24:27], v[128:131]
  ds_read_b64_tr_b16 v[80:81], v19 offset:12288
  v_mfma_f32_16x16x32_bf16 v[104:107], v[56:59], v[20:23], v[104:107]
  ds_read_b64_tr_b16 v[82:83], v19 offset:13824
  s_waitcnt lgkmcnt(14)
  v_mfma_f32_16x16x32_bf16 v[108:111], v[60:63], v[20:23], v[108:111]
  v_mfma_f32_16x16x32_bf16 v[132:135], v[60:63], v[24:27], v[132:135]
  ds_read_b64_tr_b16 v[84:85], v18 offset:12416
  v_mfma_f32_16x16x32_bf16 v[156:159], v[60:63], v[28:31], v[156:159]
  ds_read_b64_tr_b16 v[86:87], v18 offset:13952
  v_mfma_f32_16x16x32_bf16 v[180:183], v[60:63], v[32:35], v[180:183]
  ds_read_b64_tr_b16 v[88:89], v19 offset:12416
  s_waitcnt lgkmcnt(15)
  v_mfma_f32_16x16x32_bf16 v[184:187], v[64:67], v[32:35], v[184:187]
  ds_read_b64_tr_b16 v[90:91], v19 offset:13952
  v_mfma_f32_16x16x32_bf16 v[160:163], v[64:67], v[28:31], v[160:163]
  ds_read_b64_tr_b16 v[92:93], v18 offset:12544
  v_mfma_f32_16x16x32_bf16 v[136:139], v[64:67], v[24:27], v[136:139]
  ds_read_b64_tr_b16 v[94:95], v18 offset:14080
  v_mfma_f32_16x16x32_bf16 v[112:115], v[64:67], v[20:23], v[112:115]
  ds_read_b64_tr_b16 v[96:97], v19 offset:12544
  s_waitcnt lgkmcnt(15)
  v_mfma_f32_16x16x32_bf16 v[116:119], v[20:23], v[68:71], v[116:119]
  ds_read_b64_tr_b16 v[98:99], v19 offset:14080
  v_mfma_f32_16x16x32_bf16 v[140:143], v[24:27], v[68:71], v[140:143]
  v_mfma_f32_16x16x32_bf16 v[164:167], v[28:31], v[68:71], v[164:167]
  s_add_u32 s34, s34, 40960
  s_cmp_eq_u32 s34, 122880
  s_cselect_b32 s34, 0, s34
  v_mfma_f32_16x16x32_bf16 v[188:191], v[32:35], v[68:71], v[188:191]
  v_add_u32 v14, s34, v12
  v_mfma_f32_16x16x32_bf16 v[192:195], v[32:35], v[72:75], v[192:195]
  v_add_u32 v15, s34, v13
  v_mfma_f32_16x16x32_bf16 v[168:171], v[28:31], v[72:75], v[168:171]
  v_add_u32 v18, s34, v16
  v_mfma_f32_16x16x32_bf16 v[144:147], v[24:27], v[72:75], v[144:147]
  v_add_u32 v19, s34, v17
  v_mfma_f32_16x16x32_bf16 v[120:123], v[20:23], v[72:75], v[120:123]
  s_waitcnt lgkmcnt(0)
  s_barrier
  v_mfma_f32_16x16x32_bf16 v[100:103], v[76:79], v[36:39], v[100:103]
  v_mov_b32 v30, 163744
  ds_read_b32 v30, v30
  v_mfma_f32_16x16x32_bf16 v[124:127], v[76:79], v[40:43], v[124:127]
  s_lshl_b32 s69, s42, 6
  v_and_b32 v28, 15, v1
  v_mfma_f32_16x16x32_bf16 v[148:151], v[76:79], v[44:47], v[148:151]
  v_add_u32 v28, s69, v28
  v_mfma_f32_16x16x32_bf16 v[172:175], v[76:79], v[48:51], v[172:175]
  v_lshlrev_b32 v28, 2, v28
  v_add_u32 v28, 0x27000, v28
  v_mfma_f32_16x16x32_bf16 v[176:179], v[80:83], v[48:51], v[176:179]
  ds_read_b32 v20, v28 offset:0
  v_mfma_f32_16x16x32_bf16 v[152:155], v[80:83], v[44:47], v[152:155]
  ds_read_b32 v24, v28 offset:512
  ds_read_b32 v21, v28 offset:64
  v_mfma_f32_16x16x32_bf16 v[128:131], v[80:83], v[40:43], v[128:131]
  ds_read_b32 v25, v28 offset:576
  v_mfma_f32_16x16x32_bf16 v[104:107], v[80:83], v[36:39], v[104:107]
  ds_read_b32 v22, v28 offset:128
  ds_read_b32 v26, v28 offset:640
  v_mfma_f32_16x16x32_bf16 v[108:111], v[84:87], v[36:39], v[108:111]
  ds_read_b32 v23, v28 offset:192
  v_mfma_f32_16x16x32_bf16 v[132:135], v[84:87], v[40:43], v[132:135]
  ds_read_b32 v27, v28 offset:704
  s_lshl_b32 s69, s43, 5
  v_mfma_f32_16x16x32_bf16 v[156:159], v[84:87], v[44:47], v[156:159]
  v_lshrrev_b32 v29, 4, v1
  v_mfma_f32_16x16x32_bf16 v[180:183], v[84:87], v[48:51], v[180:183]
  v_lshlrev_b32 v29, 2, v29
  v_add_u32 v29, s69, v29
  v_mfma_f32_16x16x32_bf16 v[184:187], v[88:91], v[48:51], v[184:187]
  v_lshlrev_b32 v29, 2, v29
  v_add_u32 v29, 0x27400, v29
  v_mfma_f32_16x16x32_bf16 v[160:163], v[88:91], v[44:47], v[160:163]
  ds_read_b128 v[52:55], v29 offset:256
  v_mfma_f32_16x16x32_bf16 v[136:139], v[88:91], v[40:43], v[136:139]
  ds_read_b128 v[56:59], v29 offset:320
  ds_read_b128 v[60:63], v29 offset:0
  v_mfma_f32_16x16x32_bf16 v[112:115], v[88:91], v[36:39], v[112:115]
  ds_read_b128 v[64:67], v29 offset:64
  v_mfma_f32_16x16x32_bf16 v[116:119], v[36:39], v[92:95], v[116:119]
  s_mul_i32 s69, s43, 0xc000
  v_lshlrev_b32 v31, 4, v1
  v_mfma_f32_16x16x32_bf16 v[140:143], v[40:43], v[92:95], v[140:143]
  v_add_u32 v31, s69, v31
  v_mfma_f32_16x16x32_bf16 v[164:167], v[44:47], v[92:95], v[164:167]
  s_lshl_b32 s31, s28, 4
  s_add_u32 s31, s31, s29
  v_mfma_f32_16x16x32_bf16 v[188:191], v[48:51], v[92:95], v[188:191]
  s_lshl_b32 s31, s31, 15
  v_mfma_f32_16x16x32_bf16 v[192:195], v[48:51], v[96:99], v[192:195]
  s_lshl_b32 s39, s43, 14
  s_add_u32 s31, s31, s39
  v_mfma_f32_16x16x32_bf16 v[168:171], v[44:47], v[96:99], v[168:171]
  s_add_u32 s71, s31, 4194304
  v_mfma_f32_16x16x32_bf16 v[144:147], v[40:43], v[96:99], v[144:147]
  v_mfma_f32_16x16x32_bf16 v[120:123], v[36:39], v[96:99], v[120:123]
  s_setprio 3
  s_nop 6
  s_waitcnt lgkmcnt(2)
  v_readfirstlane_b32 s1, v30
  s_lshl_b32 s40, s42, 12
  v_add_u32 v30, s40, v31
  s_add_u32 s41, s71, s40
  v_pk_fma_f32 v[108:109], v[20:21], v[52:53], v[108:109] op_sel:[0,0,0] op_sel_hi:[0,1,1] neg_lo:[1,0,0] neg_hi:[1,0,0]
  v_pk_fma_f32 v[110:111], v[20:21], v[54:55], v[110:111] op_sel:[0,0,0] op_sel_hi:[0,1,1] neg_lo:[1,0,0] neg_hi:[1,0,0]
  v_pk_mul_f32 v[108:109], v[24:25], v[108:109] op_sel:[0,0] op_sel_hi:[0,1]
  v_pk_mul_f32 v[110:111], v[24:25], v[110:111] op_sel:[0,0] op_sel_hi:[0,1]
  v_pk_fma_f32 v[112:113], v[20:21], v[56:57], v[112:113] op_sel:[0,0,0] op_sel_hi:[0,1,1] neg_lo:[1,0,0] neg_hi:[1,0,0]
  v_pk_fma_f32 v[114:115], v[20:21], v[58:59], v[114:115] op_sel:[0,0,0] op_sel_hi:[0,1,1] neg_lo:[1,0,0] neg_hi:[1,0,0]
  v_pk_mul_f32 v[112:113], v[24:25], v[112:113] op_sel:[0,0] op_sel_hi:[0,1]
  v_pk_mul_f32 v[114:115], v[24:25], v[114:115] op_sel:[0,0] op_sel_hi:[0,1]
  v_cvt_pk_bf16_f32 v36, v108, v109
  v_cvt_pk_bf16_f32 v37, v110, v111
  v_cvt_pk_bf16_f32 v38, v112, v113
  v_cvt_pk_bf16_f32 v39, v114, v115
  buffer_store_dwordx4 v[36:39], v10, s[12:15], s41 offen offset:0 sc1
  ds_write_b128 v30, v[36:39] offset:16384
  v_pk_fma_f32 v[132:133], v[20:21], v[52:53], v[132:133] op_sel:[1,0,0] op_sel_hi:[1,1,1] neg_lo:[1,0,0] neg_hi:[1,0,0]
  v_pk_fma_f32 v[134:135], v[20:21], v[54:55], v[134:135] op_sel:[1,0,0] op_sel_hi:[1,1,1] neg_lo:[1,0,0] neg_hi:[1,0,0]
  v_pk_mul_f32 v[132:133], v[24:25], v[132:133] op_sel:[1,0] op_sel_hi:[1,1]
  v_pk_mul_f32 v[134:135], v[24:25], v[134:135] op_sel:[1,0] op_sel_hi:[1,1]
  v_pk_fma_f32 v[136:137], v[20:21], v[56:57], v[136:137] op_sel:[1,0,0] op_sel_hi:[1,1,1] neg_lo:[1,0,0] neg_hi:[1,0,0]
  v_pk_fma_f32 v[138:139], v[20:21], v[58:59], v[138:139] op_sel:[1,0,0] op_sel_hi:[1,1,1] neg_lo:[1,0,0] neg_hi:[1,0,0]
  v_pk_mul_f32 v[136:137], v[24:25], v[136:137] op_sel:[1,0] op_sel_hi:[1,1]
  v_pk_mul_f32 v[138:139], v[24:25], v[138:139] op_sel:[1,0] op_sel_hi:[1,1]
  v_cvt_pk_bf16_f32 v40, v132, v133
  v_cvt_pk_bf16_f32 v41, v134, v135
  v_cvt_pk_bf16_f32 v42, v136, v137
  v_cvt_pk_bf16_f32 v43, v138, v139
  buffer_store_dwordx4 v[40:43], v10, s[12:15], s41 offen offset:1024 sc1
  ds_write_b128 v30, v[40:43] offset:17408
  v_pk_fma_f32 v[156:157], v[22:23], v[52:53], v[156:157] op_sel:[0,0,0] op_sel_hi:[0,1,1] neg_lo:[1,0,0] neg_hi:[1,0,0]
  v_pk_fma_f32 v[158:159], v[22:23], v[54:55], v[158:159] op_sel:[0,0,0] op_sel_hi:[0,1,1] neg_lo:[1,0,0] neg_hi:[1,0,0]
  v_pk_mul_f32 v[156:157], v[26:27], v[156:157] op_sel:[0,0] op_sel_hi:[0,1]
  v_pk_mul_f32 v[158:159], v[26:27], v[158:159] op_sel:[0,0] op_sel_hi:[0,1]
  v_pk_fma_f32 v[160:161], v[22:23], v[56:57], v[160:161] op_sel:[0,0,0] op_sel_hi:[0,1,1] neg_lo:[1,0,0] neg_hi:[1,0,0]
  v_pk_fma_f32 v[162:163], v[22:23], v[58:59], v[162:163] op_sel:[0,0,0] op_sel_hi:[0,1,1] neg_lo:[1,0,0] neg_hi:[1,0,0]
  v_pk_mul_f32 v[160:161], v[26:27], v[160:161] op_sel:[0,0] op_sel_hi:[0,1]
  v_pk_mul_f32 v[162:163], v[26:27], v[162:163] op_sel:[0,0] op_sel_hi:[0,1]
  v_cvt_pk_bf16_f32 v36, v156, v157
  v_cvt_pk_bf16_f32 v37, v158, v159
  v_cvt_pk_bf16_f32 v38, v160, v161
  v_cvt_pk_bf16_f32 v39, v162, v163
  buffer_store_dwordx4 v[36:39], v10, s[12:15], s41 offen offset:2048 sc1
  ds_write_b128 v30, v[36:39] offset:18432
  v_pk_fma_f32 v[180:181], v[22:23], v[52:53], v[180:181] op_sel:[1,0,0] op_sel_hi:[1,1,1] neg_lo:[1,0,0] neg_hi:[1,0,0]
  v_pk_fma_f32 v[182:183], v[22:23], v[54:55], v[182:183] op_sel:[1,0,0] op_sel_hi:[1,1,1] neg_lo:[1,0,0] neg_hi:[1,0,0]
  v_pk_mul_f32 v[180:181], v[26:27], v[180:181] op_sel:[1,0] op_sel_hi:[1,1]
  v_pk_mul_f32 v[182:183], v[26:27], v[182:183] op_sel:[1,0] op_sel_hi:[1,1]
  v_pk_fma_f32 v[184:185], v[22:23], v[56:57], v[184:185] op_sel:[1,0,0] op_sel_hi:[1,1,1] neg_lo:[1,0,0] neg_hi:[1,0,0]
  v_pk_fma_f32 v[186:187], v[22:23], v[58:59], v[186:187] op_sel:[1,0,0] op_sel_hi:[1,1,1] neg_lo:[1,0,0] neg_hi:[1,0,0]
  v_pk_mul_f32 v[184:185], v[26:27], v[184:185] op_sel:[1,0] op_sel_hi:[1,1]
  v_pk_mul_f32 v[186:187], v[26:27], v[186:187] op_sel:[1,0] op_sel_hi:[1,1]
  v_cvt_pk_bf16_f32 v40, v180, v181
  v_cvt_pk_bf16_f32 v41, v182, v183
  v_cvt_pk_bf16_f32 v42, v184, v185
  v_cvt_pk_bf16_f32 v43, v186, v187
  buffer_store_dwordx4 v[40:43], v10, s[12:15], s41 offen offset:3072 sc1
  ds_write_b128 v30, v[40:43] offset:19456
  s_lshl_b32 s69, s43, 5
  v_and_b32 v28, 15, v1
  v_add_u32 v28, s69, v28
  v_lshlrev_b32 v28, 2, v28
  v_add_u32 v28, 0x27400, v28
  v_add_u32 v28, 0x200, v28
  ds_read_b32 v32, v28
  ds_read_b32 v33, v28 offset:64
  s_lshl_b32 s69, s42, 6
  v_lshrrev_b32 v29, 4, v1
  v_lshlrev_b32 v29, 2, v29
  v_add_u32 v29, s69, v29
  v_lshlrev_b32 v29, 2, v29
  v_add_u32 v29, 0x27000, v29
  ds_read_b128 v[68:71], v29 offset:0
  ds_read_b128 v[84:87], v29 offset:512
  ds_read_b128 v[72:75], v29 offset:64
  ds_read_b128 v[88:91], v29 offset:576
  ds_read_b128 v[76:79], v29 offset:128
  ds_read_b128 v[92:95], v29 offset:640
  ds_read_b128 v[80:83], v29 offset:192
  ds_read_b128 v[96:99], v29 offset:704
  s_lshl_b32 s40, s42, 12
  s_add_u32 s41, s71, s40
  s_add_u32 s41, s41, 8192
  s_waitcnt lgkmcnt(4)
  v_pk_fma_f32 v[116:117], v[68:69], v[32:33], v[116:117] op_sel:[0,0,0] op_sel_hi:[1,0,1] neg_lo:[1,0,0] neg_hi:[1,0,0]
  v_pk_fma_f32 v[118:119], v[70:71], v[32:33], v[118:119] op_sel:[0,0,0] op_sel_hi:[1,0,1] neg_lo:[1,0,0] neg_hi:[1,0,0]
  v_pk_mul_f32 v[116:117], v[84:85], v[116:117]
  v_pk_mul_f32 v[118:119], v[86:87], v[118:119]
  v_pk_fma_f32 v[140:141], v[72:73], v[32:33], v[140:141] op_sel:[0,0,0] op_sel_hi:[1,0,1] neg_lo:[1,0,0] neg_hi:[1,0,0]
  v_pk_fma_f32 v[142:143], v[74:75], v[32:33], v[142:143] op_sel:[0,0,0] op_sel_hi:[1,0,1] neg_lo:[1,0,0] neg_hi:[1,0,0]
  v_pk_mul_f32 v[140:141], v[88:89], v[140:141]
  v_pk_mul_f32 v[142:143], v[90:91], v[142:143]
  v_cvt_pk_bf16_f32 v36, v116, v117
  v_cvt_pk_bf16_f32 v37, v118, v119
  v_cvt_pk_bf16_f32 v38, v140, v141
  v_cvt_pk_bf16_f32 v39, v142, v143
  buffer_store_dwordx4 v[36:39], v10, s[12:15], s41 offen offset:0 sc1
  ds_write_b128 v30, v[36:39] offset:40960
  v_pk_fma_f32 v[120:121], v[68:69], v[32:33], v[120:121] op_sel:[0,1,0] op_sel_hi:[1,1,1] neg_lo:[1,0,0] neg_hi:[1,0,0]
  v_pk_fma_f32 v[122:123], v[70:71], v[32:33], v[122:123] op_sel:[0,1,0] op_sel_hi:[1,1,1] neg_lo:[1,0,0] neg_hi:[1,0,0]
  v_pk_mul_f32 v[120:121], v[84:85], v[120:121]
  v_pk_mul_f32 v[122:123], v[86:87], v[122:123]
  v_pk_fma_f32 v[144:145], v[72:73], v[32:33], v[144:145] op_sel:[0,1,0] op_sel_hi:[1,1,1] neg_lo:[1,0,0] neg_hi:[1,0,0]
  v_pk_fma_f32 v[146:147], v[74:75], v[32:33], v[146:147] op_sel:[0,1,0] op_sel_hi:[1,1,1] neg_lo:[1,0,0] neg_hi:[1,0,0]
  v_pk_mul_f32 v[144:145], v[88:89], v[144:145]
  v_pk_mul_f32 v[146:147], v[90:91], v[146:147]
  v_cvt_pk_bf16_f32 v40, v120, v121
  v_cvt_pk_bf16_f32 v41, v122, v123
  v_cvt_pk_bf16_f32 v42, v144, v145
  v_cvt_pk_bf16_f32 v43, v146, v147
  buffer_store_dwordx4 v[40:43], v10, s[12:15], s41 offen offset:1024 sc1
  ds_write_b128 v30, v[40:43] offset:41984
  s_waitcnt lgkmcnt(2)
  v_pk_fma_f32 v[164:165], v[76:77], v[32:33], v[164:165] op_sel:[0,0,0] op_sel_hi:[1,0,1] neg_lo:[1,0,0] neg_hi:[1,0,0]
  v_pk_fma_f32 v[166:167], v[78:79], v[32:33], v[166:167] op_sel:[0,0,0] op_sel_hi:[1,0,1] neg_lo:[1,0,0] neg_hi:[1,0,0]
  v_pk_mul_f32 v[164:165], v[92:93], v[164:165]
  v_pk_mul_f32 v[166:167], v[94:95], v[166:167]
  v_pk_fma_f32 v[188:189], v[80:81], v[32:33], v[188:189] op_sel:[0,0,0] op_sel_hi:[1,0,1] neg_lo:[1,0,0] neg_hi:[1,0,0]
  v_pk_fma_f32 v[190:191], v[82:83], v[32:33], v[190:191] op_sel:[0,0,0] op_sel_hi:[1,0,1] neg_lo:[1,0,0] neg_hi:[1,0,0]
  v_pk_mul_f32 v[188:189], v[96:97], v[188:189]
  v_pk_mul_f32 v[190:191], v[98:99], v[190:191]
  v_cvt_pk_bf16_f32 v36, v164, v165
  v_cvt_pk_bf16_f32 v37, v166, v167
  v_cvt_pk_bf16_f32 v38, v188, v189
  v_cvt_pk_bf16_f32 v39, v190, v191
  buffer_store_dwordx4 v[36:39], v10, s[12:15], s41 offen offset:2048 sc1
  ds_write_b128 v30, v[36:39] offset:43008
  v_pk_fma_f32 v[168:169], v[76:77], v[32:33], v[168:169] op_sel:[0,1,0] op_sel_hi:[1,1,1] neg_lo:[1,0,0] neg_hi:[1,0,0]
  v_pk_fma_f32 v[170:171], v[78:79], v[32:33], v[170:171] op_sel:[0,1,0] op_sel_hi:[1,1,1] neg_lo:[1,0,0] neg_hi:[1,0,0]
  v_pk_mul_f32 v[168:169], v[92:93], v[168:169]
  v_pk_mul_f32 v[170:171], v[94:95], v[170:171]
  v_pk_fma_f32 v[192:193], v[80:81], v[32:33], v[192:193] op_sel:[0,1,0] op_sel_hi:[1,1,1] neg_lo:[1,0,0] neg_hi:[1,0,0]
  v_pk_fma_f32 v[194:195], v[82:83], v[32:33], v[194:195] op_sel:[0,1,0] op_sel_hi:[1,1,1] neg_lo:[1,0,0] neg_hi:[1,0,0]
  v_pk_mul_f32 v[192:193], v[96:97], v[192:193]
  v_pk_mul_f32 v[194:195], v[98:99], v[194:195]
  v_cvt_pk_bf16_f32 v40, v168, v169
  v_cvt_pk_bf16_f32 v41, v170, v171
  v_cvt_pk_bf16_f32 v42, v192, v193
  v_cvt_pk_bf16_f32 v43, v194, v195
  buffer_store_dwordx4 v[40:43], v10, s[12:15], s41 offen offset:3072 sc1
  ds_write_b128 v30, v[40:43] offset:44032
  v_mul_f32 v24, 0x3e8293ee, v24
  v_mul_f32 v25, 0x3e8293ee, v25
  v_mul_f32 v26, 0x3e8293ee, v26
  v_mul_f32 v27, 0x3e8293ee, v27
  s_lshl_b32 s68, s43, 13
  s_lshl_b32 s67, s42, 12
  s_add_u32 s69, s68, s67
  v_lshlrev_b32 v28, 4, v1
  v_add_u32 v28, s69, v28
  v_add_u32 v28, 0x18000, v28
  v_pk_fma_f32 v[100:101], v[20:21], v[60:61], v[100:101] op_sel:[0,0,0] op_sel_hi:[0,1,1] neg_lo:[1,0,0] neg_hi:[1,0,0]
  v_pk_fma_f32 v[102:103], v[20:21], v[62:63], v[102:103] op_sel:[0,0,0] op_sel_hi:[0,1,1] neg_lo:[1,0,0] neg_hi:[1,0,0]
  v_pk_mul_f32 v[100:101], v[24:25], v[100:101] op_sel:[0,0] op_sel_hi:[0,1]
  v_pk_mul_f32 v[102:103], v[24:25], v[102:103] op_sel:[0,0] op_sel_hi:[0,1]
  v_pk_fma_f32 v[104:105], v[20:21], v[64:65], v[104:105] op_sel:[0,0,0] op_sel_hi:[0,1,1] neg_lo:[1,0,0] neg_hi:[1,0,0]
  v_pk_fma_f32 v[106:107], v[20:21], v[66:67], v[106:107] op_sel:[0,0,0] op_sel_hi:[0,1,1] neg_lo:[1,0,0] neg_hi:[1,0,0]
  v_pk_mul_f32 v[104:105], v[24:25], v[104:105] op_sel:[0,0] op_sel_hi:[0,1]
  v_pk_mul_f32 v[106:107], v[24:25], v[106:107] op_sel:[0,0] op_sel_hi:[0,1]
  s_nop 0
  v_cvt_pk_bf16_f32 v36, v100, v101
  v_cvt_pk_bf16_f32 v37, v102, v103
  v_cvt_pk_bf16_f32 v38, v104, v105
  v_cvt_pk_bf16_f32 v39, v106, v107
  ds_write_b128 v28, v[36:39] offset:0
  v_pk_fma_f32 v[124:125], v[20:21], v[60:61], v[124:125] op_sel:[1,0,0] op_sel_hi:[1,1,1] neg_lo:[1,0,0] neg_hi:[1,0,0]
  v_pk_fma_f32 v[126:127], v[20:21], v[62:63], v[126:127] op_sel:[1,0,0] op_sel_hi:[1,1,1] neg_lo:[1,0,0] neg_hi:[1,0,0]
  v_pk_mul_f32 v[124:125], v[24:25], v[124:125] op_sel:[1,0] op_sel_hi:[1,1]
  v_pk_mul_f32 v[126:127], v[24:25], v[126:127] op_sel:[1,0] op_sel_hi:[1,1]
  v_pk_fma_f32 v[128:129], v[20:21], v[64:65], v[128:129] op_sel:[1,0,0] op_sel_hi:[1,1,1] neg_lo:[1,0,0] neg_hi:[1,0,0]
  v_pk_fma_f32 v[130:131], v[20:21], v[66:67], v[130:131] op_sel:[1,0,0] op_sel_hi:[1,1,1] neg_lo:[1,0,0] neg_hi:[1,0,0]
  v_pk_mul_f32 v[128:129], v[24:25], v[128:129] op_sel:[1,0] op_sel_hi:[1,1]
  v_pk_mul_f32 v[130:131], v[24:25], v[130:131] op_sel:[1,0] op_sel_hi:[1,1]
  s_nop 0
  v_cvt_pk_bf16_f32 v40, v124, v125
  v_cvt_pk_bf16_f32 v41, v126, v127
  v_cvt_pk_bf16_f32 v42, v128, v129
  v_cvt_pk_bf16_f32 v43, v130, v131
  ds_write_b128 v28, v[40:43] offset:1024
  v_pk_fma_f32 v[148:149], v[22:23], v[60:61], v[148:149] op_sel:[0,0,0] op_sel_hi:[0,1,1] neg_lo:[1,0,0] neg_hi:[1,0,0]
  v_pk_fma_f32 v[150:151], v[22:23], v[62:63], v[150:151] op_sel:[0,0,0] op_sel_hi:[0,1,1] neg_lo:[1,0,0] neg_hi:[1,0,0]
  v_pk_mul_f32 v[148:149], v[26:27], v[148:149] op_sel:[0,0] op_sel_hi:[0,1]
  v_pk_mul_f32 v[150:151], v[26:27], v[150:151] op_sel:[0,0] op_sel_hi:[0,1]
  v_pk_fma_f32 v[152:153], v[22:23], v[64:65], v[152:153] op_sel:[0,0,0] op_sel_hi:[0,1,1] neg_lo:[1,0,0] neg_hi:[1,0,0]
  v_pk_fma_f32 v[154:155], v[22:23], v[66:67], v[154:155] op_sel:[0,0,0] op_sel_hi:[0,1,1] neg_lo:[1,0,0] neg_hi:[1,0,0]
  v_pk_mul_f32 v[152:153], v[26:27], v[152:153] op_sel:[0,0] op_sel_hi:[0,1]
  v_pk_mul_f32 v[154:155], v[26:27], v[154:155] op_sel:[0,0] op_sel_hi:[0,1]
  s_nop 0
  v_cvt_pk_bf16_f32 v36, v148, v149
  v_cvt_pk_bf16_f32 v37, v150, v151
  v_cvt_pk_bf16_f32 v38, v152, v153
  v_cvt_pk_bf16_f32 v39, v154, v155
  ds_write_b128 v28, v[36:39] offset:2048
  v_pk_fma_f32 v[172:173], v[22:23], v[60:61], v[172:173] op_sel:[1,0,0] op_sel_hi:[1,1,1] neg_lo:[1,0,0] neg_hi:[1,0,0]
  v_pk_fma_f32 v[174:175], v[22:23], v[62:63], v[174:175] op_sel:[1,0,0] op_sel_hi:[1,1,1] neg_lo:[1,0,0] neg_hi:[1,0,0]
  v_pk_mul_f32 v[172:173], v[26:27], v[172:173] op_sel:[1,0] op_sel_hi:[1,1]
  v_pk_mul_f32 v[174:175], v[26:27], v[174:175] op_sel:[1,0] op_sel_hi:[1,1]
  v_pk_fma_f32 v[176:177], v[22:23], v[64:65], v[176:177] op_sel:[1,0,0] op_sel_hi:[1,1,1] neg_lo:[1,0,0] neg_hi:[1,0,0]
  v_pk_fma_f32 v[178:179], v[22:23], v[66:67], v[178:179] op_sel:[1,0,0] op_sel_hi:[1,1,1] neg_lo:[1,0,0] neg_hi:[1,0,0]
  v_pk_mul_f32 v[176:177], v[26:27], v[176:177] op_sel:[1,0] op_sel_hi:[1,1]
  v_pk_mul_f32 v[178:179], v[26:27], v[178:179] op_sel:[1,0] op_sel_hi:[1,1]
  s_nop 0
  v_cvt_pk_bf16_f32 v40, v172, v173
  v_cvt_pk_bf16_f32 v41, v174, v175
  v_cvt_pk_bf16_f32 v42, v176, v177
  v_cvt_pk_bf16_f32 v43, v178, v179
  ds_write_b128 v28, v[40:43] offset:3072
  s_waitcnt vmcnt(0)
  v_mov_b32 v2, 163712
  v_mov_b32 v3, 1
  s_mov_b64 exec, 1
  ds_add_rtn_u32 v2, v2, v3
  s_lshl_b32 s31, s29, 4
  s_add_u32 s31, s31, s28
  s_lshl_b32 s31, s31, 7
  s_add_u32 s31, s31, 54689792
  s_waitcnt lgkmcnt(0)
  v_readfirstlane_b32 s39, v2
  v_mov_b32 v2, 0
  v_mov_b32 v3, s1
  s_nop 1
  s_cmp_eq_u32 s39, 3
  s_cbranch_scc0 L_notlast_kv
  buffer_store_dword v3, v2, s[12:15], s31 offen sc1
L_notlast_kv:
  s_mov_b64 exec, -1
  s_waitcnt lgkmcnt(0)
  s_mov_b32 s0, 0
  s_branch L_attn
L_attn_back_c:
  s_setprio 3
  s_barrier
  s_lshl_b32 s67, s42, 2
  s_lshl_b32 s68, s67, 1
  s_lshl_b32 s69, s68, 10
  v_lshlrev_b32 v12, 4, v1
  v_add_u32 v12, s69, v12
  v_lshrrev_b32 v14, 4, v1
  v_lshrrev_b32 v14, 1, v14
  v_lshlrev_b32 v14, 4, v14
  v_lshrrev_b32 v7, 4, v1
  v_and_b32 v7, 1, v7
  v_lshlrev_b32 v7, 2, v7
  v_add_u32 v14, v14, v7
  v_lshrrev_b32 v7, 2, v1
  v_and_b32 v7, 3, v7
  v_add_u32 v14, v14, v7
  v_lshlrev_b32 v14, 7, v14
  s_lshl_b32 s68, s43, 5
  s_lshr_b32 s69, s68, 3
  v_lshrrev_b32 v7, 1, v1
  v_and_b32 v7, 1, v7
  v_add_u32 v7, s69, v7
  v_lshrrev_b32 v6, 4, v1
  v_lshrrev_b32 v6, 1, v6
  v_lshlrev_b32 v6, 4, v6
  v_lshrrev_b32 v5, 4, v1
  v_and_b32 v5, 1, v5
  v_lshlrev_b32 v5, 2, v5
  v_add_u32 v6, v6, v5
  v_lshrrev_b32 v5, 2, v1
  v_and_b32 v5, 3, v5
  v_add_u32 v6, v6, v5
  v_lshrrev_b32 v6, 1, v6
  v_and_b32 v6, 3, v6
  v_lshlrev_b32 v6, 1, v6
  v_xor_b32 v7, v7, v6
  v_lshlrev_b32 v7, 4, v7
  v_add_u32 v14, v14, v7
  v_and_b32 v7, 1, v1
  v_lshlrev_b32 v7, 3, v7
  v_add_u32 v14, v14, v7
  v_add_u32 v14, 0x4000, v14
  v_lshrrev_b32 v15, 4, v1
  v_lshrrev_b32 v15, 1, v15
  v_lshlrev_b32 v15, 4, v15
  v_lshrrev_b32 v7, 4, v1
  v_and_b32 v7, 1, v7
  v_lshlrev_b32 v7, 2, v7
  v_add_u32 v15, v15, v7
  v_lshrrev_b32 v7, 2, v1
  v_and_b32 v7, 3, v7
  v_add_u32 v15, v15, v7
  v_lshlrev_b32 v15, 7, v15
  s_lshl_b32 s67, s43, 5
  s_add_u32 s68, s67, 16
  s_lshr_b32 s69, s68, 3
  v_lshrrev_b32 v7, 1, v1
  v_and_b32 v7, 1, v7
  v_add_u32 v7, s69, v7
  v_lshrrev_b32 v6, 4, v1
  v_lshrrev_b32 v6, 1, v6
  v_lshlrev_b32 v6, 4, v6
  v_lshrrev_b32 v5, 4, v1
  v_and_b32 v5, 1, v5
  v_lshlrev_b32 v5, 2, v5
  v_add_u32 v6, v6, v5
  v_lshrrev_b32 v5, 2, v1
  v_and_b32 v5, 3, v5
  v_add_u32 v6, v6, v5
  v_lshrrev_b32 v6, 1, v6
  v_and_b32 v6, 3, v6
  v_lshlrev_b32 v6, 1, v6
  v_xor_b32 v7, v7, v6
  v_lshlrev_b32 v7, 4, v7
  v_add_u32 v15, v15, v7
  v_and_b32 v7, 1, v1
  v_lshlrev_b32 v7, 3, v7
  v_add_u32 v15, v15, v7
  v_add_u32 v15, 0x4000, v15
  s_mov_b32 s4, s44
  s_mov_b32 s5, s45
  s_mov_b32 s6, 4194304
  s_mov_b32 s7, 0x20000
  v_and_b32 v116, 15, v1
  v_lshlrev_b32 v116, 11, v116
  v_lshrrev_b32 v7, 4, v1
  v_lshlrev_b32 v7, 3, v7
  v_add_u32 v116, v116, v7
  s_cmp_eq_u32 s70, 0
  s_cbranch_scc1 L_ores0
  s_lshl_b32 s31, s28, 1
  s_add_u32 s31, s31, s42
  s_lshl_b32 s31, s31, 17
  s_lshl_b32 s39, s29, 7
  s_add_u32 s31, s31, s39
  s_lshl_b32 s39, s43, 6
  s_add_u32 s31, s31, s39
  buffer_load_dwordx2 v[100:101], v116, s[4:7], s31 offen offset:0
  buffer_load_dwordx2 v[102:103], v116, s[4:7], s31 offen offset:32
  s_add_u32 s31, s31, 32768
  buffer_load_dwordx2 v[104:105], v116, s[4:7], s31 offen offset:0
  buffer_load_dwordx2 v[106:107], v116, s[4:7], s31 offen offset:32
  s_add_u32 s31, s31, 32768
  buffer_load_dwordx2 v[108:109], v116, s[4:7], s31 offen offset:0
  buffer_load_dwordx2 v[110:111], v116, s[4:7], s31 offen offset:32
  s_add_u32 s31, s31, 32768
  buffer_load_dwordx2 v[112:113], v116, s[4:7], s31 offen offset:0
  buffer_load_dwordx2 v[114:115], v116, s[4:7], s31 offen offset:32
L_ores0:
  s_cmp_lg_u32 s70, 0
  s_cbranch_scc1 L_nocpoll_o
  s_lshl_b32 s31, s28, 11
  s_add_u32 s31, s31, 54591488
  v_and_b32 v4, 15, v1
  v_lshlrev_b32 v4, 7, v4
  v_add_u32 v4, s31, v4
  s_xor_b32 s39, s29, 1
  s_lshl_b32 s39, s39, 7
  s_add_u32 s39, s39, s31
  v_and_b32 v2, 15, v1
  v_mov_b32 v3, s39
  v_cmp_eq_u32 vcc, s29, v2
  s_nop 1
  v_cndmask_b32 v4, v4, v3, vcc
  s_mov_b32 s36, 400000
L_poll_o:
  buffer_load_dword v2, v4, s[12:15], 0 offen sc1
  s_waitcnt vmcnt(0)
  v_cmp_eq_u32 vcc, s1, v2
  s_nop 4
  s_cmp_eq_u64 vcc, exec
  s_cbranch_scc1 L_polldone_o
  s_sleep 4
  s_sub_u32 s36, s36, 1
  s_cmp_lg_u32 s36, 0
  s_cbranch_scc1 L_poll_o
L_polldone_o:
L_nocpoll_o:
  s_barrier
  s_mov_b32 s34, 0
  v_add_u32 v13, s34, v12
  v_add_u32 v16, s34, v14
  v_add_u32 v17, s34, v15
  s_waitcnt lgkmcnt(0)
  s_setprio 0
  s_barrier
  ds_read_b128 v[20:23], v13 offset:0
  ds_read_b64_tr_b16 v[52:53], v16 offset:0
  ds_read_b64_tr_b16 v[54:55], v16 offset:1024
  ds_read_b128 v[24:27], v13 offset:2048
  ds_read_b128 v[28:31], v13 offset:4096
  ds_read_b128 v[32:35], v13 offset:6144
  ds_read_b64_tr_b16 v[56:57], v17 offset:0
  ds_read_b64_tr_b16 v[58:59], v17 offset:1024
  s_waitcnt lgkmcnt(5)
  v_mfma_f32_16x16x32_bf16 v[68:71], v[52:55], v[20:23], 0
  ds_read_b128 v[36:39], v13 offset:1024
  ds_read_b64_tr_b16 v[60:61], v16 offset:4096
  s_waitcnt lgkmcnt(6)
  v_mfma_f32_16x16x32_bf16 v[76:79], v[52:55], v[24:27], 0
  ds_read_b64_tr_b16 v[62:63], v16 offset:5120
  ds_read_b128 v[40:43], v13 offset:3072
  s_waitcnt lgkmcnt(7)
  v_mfma_f32_16x16x32_bf16 v[84:87], v[52:55], v[28:31], 0
  ds_read_b128 v[44:47], v13 offset:5120
  ds_read_b128 v[48:51], v13 offset:7168
  s_waitcnt lgkmcnt(8)
  v_mfma_f32_16x16x32_bf16 v[92:95], v[52:55], v[32:35], 0
  ds_read_b64_tr_b16 v[64:65], v17 offset:4096
  ds_read_b64_tr_b16 v[66:67], v17 offset:5120
  s_waitcnt lgkmcnt(8)
  v_mfma_f32_16x16x32_bf16 v[96:99], v[56:59], v[32:35], 0
  v_mfma_f32_16x16x32_bf16 v[88:91], v[56:59], v[28:31], 0
  v_mfma_f32_16x16x32_bf16 v[80:83], v[56:59], v[24:27], 0
  v_mfma_f32_16x16x32_bf16 v[72:75], v[56:59], v[20:23], 0
  s_add_u32 s34, s34, 24576
  s_cmp_eq_u32 s34, 147456
  s_cselect_b32 s34, 0, s34
  v_add_u32 v13, s34, v12
  v_add_u32 v16, s34, v14
  v_add_u32 v17, s34, v15
  s_waitcnt lgkmcnt(0)
  s_barrier
  s_mov_b32 s36, 14
  s_branch L_loop_o
L_top_o:
  s_barrier
L_loop_o:
  v_mfma_f32_16x16x32_bf16 v[68:71], v[60:63], v[36:39], v[68:71]
  ds_read_b128 v[20:23], v13 offset:0
  ds_read_b64_tr_b16 v[52:53], v16 offset:0
  v_mfma_f32_16x16x32_bf16 v[76:79], v[60:63], v[40:43], v[76:79]
  ds_read_b64_tr_b16 v[54:55], v16 offset:1024
  ds_read_b128 v[24:27], v13 offset:2048
  v_mfma_f32_16x16x32_bf16 v[84:87], v[60:63], v[44:47], v[84:87]
  ds_read_b128 v[28:31], v13 offset:4096
  ds_read_b128 v[32:35], v13 offset:6144
  s_cmp_eq_u32 s36, 13
  s_cbranch_scc1 L_hk_o_13
L_hkb_o_13:
  v_mfma_f32_16x16x32_bf16 v[92:95], v[60:63], v[48:51], v[92:95]
  ds_read_b64_tr_b16 v[56:57], v17 offset:0
  ds_read_b64_tr_b16 v[58:59], v17 offset:1024
  v_mfma_f32_16x16x32_bf16 v[96:99], v[64:67], v[48:51], v[96:99]
  v_mfma_f32_16x16x32_bf16 v[88:91], v[64:67], v[44:47], v[88:91]
  v_mfma_f32_16x16x32_bf16 v[80:83], v[64:67], v[40:43], v[80:83]
  v_mfma_f32_16x16x32_bf16 v[72:75], v[64:67], v[36:39], v[72:75]
  s_waitcnt lgkmcnt(5)
  v_mfma_f32_16x16x32_bf16 v[68:71], v[52:55], v[20:23], v[68:71]
  ds_read_b128 v[36:39], v13 offset:1024
  ds_read_b64_tr_b16 v[60:61], v16 offset:4096
  s_waitcnt lgkmcnt(6)
  v_mfma_f32_16x16x32_bf16 v[76:79], v[52:55], v[24:27], v[76:79]
  ds_read_b64_tr_b16 v[62:63], v16 offset:5120
  ds_read_b128 v[40:43], v13 offset:3072
  s_waitcnt lgkmcnt(7)
  v_mfma_f32_16x16x32_bf16 v[84:87], v[52:55], v[28:31], v[84:87]
  ds_read_b128 v[44:47], v13 offset:5120
  ds_read_b128 v[48:51], v13 offset:7168
  s_waitcnt lgkmcnt(8)
  v_mfma_f32_16x16x32_bf16 v[92:95], v[52:55], v[32:35], v[92:95]
  ds_read_b64_tr_b16 v[64:65], v17 offset:4096
  ds_read_b64_tr_b16 v[66:67], v17 offset:5120
  s_waitcnt lgkmcnt(8)
  v_mfma_f32_16x16x32_bf16 v[96:99], v[56:59], v[32:35], v[96:99]
  s_add_u32 s34, s34, 24576
  s_cmp_eq_u32 s34, 147456
  s_cselect_b32 s34, 0, s34
  v_add_u32 v13, s34, v12
  v_mfma_f32_16x16x32_bf16 v[88:91], v[56:59], v[28:31], v[88:91]
  v_add_u32 v16, s34, v14
  v_add_u32 v17, s34, v15
  v_mfma_f32_16x16x32_bf16 v[80:83], v[56:59], v[24:27], v[80:83]
  s_sub_u32 s36, s36, 1
  s_cmp_lg_u32 s36, 0
  v_mfma_f32_16x16x32_bf16 v[72:75], v[56:59], v[20:23], v[72:75]
  s_waitcnt lgkmcnt(0)
  s_cbranch_scc1 L_top_o
  s_barrier
  v_mfma_f32_16x16x32_bf16 v[68:71], v[60:63], v[36:39], v[68:71]
  ds_read_b128 v[20:23], v13 offset:0
  ds_read_b64_tr_b16 v[52:53], v16 offset:0
  v_mfma_f32_16x16x32_bf16 v[76:79], v[60:63], v[40:43], v[76:79]
  ds_read_b64_tr_b16 v[54:55], v16 offset:1024
  ds_read_b128 v[24:27], v13 offset:2048
  v_mfma_f32_16x16x32_bf16 v[84:87], v[60:63], v[44:47], v[84:87]
  ds_read_b128 v[28:31], v13 offset:4096
  ds_read_b128 v[32:35], v13 offset:6144
  v_mfma_f32_16x16x32_bf16 v[92:95], v[60:63], v[48:51], v[92:95]
  ds_read_b64_tr_b16 v[56:57], v17 offset:0
  ds_read_b64_tr_b16 v[58:59], v17 offset:1024
  v_mfma_f32_16x16x32_bf16 v[96:99], v[64:67], v[48:51], v[96:99]
  v_mfma_f32_16x16x32_bf16 v[88:91], v[64:67], v[44:47], v[88:91]
  v_mfma_f32_16x16x32_bf16 v[80:83], v[64:67], v[40:43], v[80:83]
  v_mfma_f32_16x16x32_bf16 v[72:75], v[64:67], v[36:39], v[72:75]
  s_waitcnt lgkmcnt(5)
  v_mfma_f32_16x16x32_bf16 v[68:71], v[52:55], v[20:23], v[68:71]
  ds_read_b128 v[36:39], v13 offset:1024
  ds_read_b64_tr_b16 v[60:61], v16 offset:4096
  s_waitcnt lgkmcnt(6)
  v_mfma_f32_16x16x32_bf16 v[76:79], v[52:55], v[24:27], v[76:79]
  ds_read_b64_tr_b16 v[62:63], v16 offset:5120
  ds_read_b128 v[40:43], v13 offset:3072
  s_waitcnt lgkmcnt(7)
  v_mfma_f32_16x16x32_bf16 v[84:87], v[52:55], v[28:31], v[84:87]
  ds_read_b128 v[44:47], v13 offset:5120
  ds_read_b128 v[48:51], v13 offset:7168
  s_waitcnt lgkmcnt(8)
  v_mfma_f32_16x16x32_bf16 v[92:95], v[52:55], v[32:35], v[92:95]
  ds_read_b64_tr_b16 v[64:65], v17 offset:4096
  ds_read_b64_tr_b16 v[66:67], v17 offset:5120
  s_waitcnt lgkmcnt(8)
  v_mfma_f32_16x16x32_bf16 v[96:99], v[56:59], v[32:35], v[96:99]
  s_add_u32 s34, s34, 24576
  s_cmp_eq_u32 s34, 147456
  s_cselect_b32 s34, 0, s34
  v_add_u32 v13, s34, v12
  v_mfma_f32_16x16x32_bf16 v[88:91], v[56:59], v[28:31], v[88:91]
  v_add_u32 v16, s34, v14
  v_mfma_f32_16x16x32_bf16 v[80:83], v[56:59], v[24:27], v[80:83]
  v_add_u32 v17, s34, v15
  v_mfma_f32_16x16x32_bf16 v[72:75], v[56:59], v[20:23], v[72:75]
  s_waitcnt lgkmcnt(0)
  s_barrier
  v_mfma_f32_16x16x32_bf16 v[68:71], v[60:63], v[36:39], v[68:71]
  v_mfma_f32_16x16x32_bf16 v[76:79], v[60:63], v[40:43], v[76:79]
  v_mfma_f32_16x16x32_bf16 v[84:87], v[60:63], v[44:47], v[84:87]
  v_mfma_f32_16x16x32_bf16 v[92:95], v[60:63], v[48:51], v[92:95]
  v_mfma_f32_16x16x32_bf16 v[96:99], v[64:67], v[48:51], v[96:99]
  v_mfma_f32_16x16x32_bf16 v[88:91], v[64:67], v[44:47], v[88:91]
  v_mfma_f32_16x16x32_bf16 v[80:83], v[64:67], v[40:43], v[80:83]
  v_mfma_f32_16x16x32_bf16 v[72:75], v[64:67], v[36:39], v[72:75]
  s_setprio 3
  s_nop 6
  s_waitcnt vmcnt(0)
  v_lshlrev_b32 v2, 16, v100
  v_and_b32 v3, 0xffff0000, v100
  v_add_f32 v68, v68, v2
  v_add_f32 v69, v69, v3
  v_lshlrev_b32 v2, 16, v101
  v_and_b32 v3, 0xffff0000, v101
  v_add_f32 v70, v70, v2
  v_add_f32 v71, v71, v3
  v_lshlrev_b32 v2, 16, v102
  v_and_b32 v3, 0xffff0000, v102
  v_add_f32 v72, v72, v2
  v_add_f32 v73, v73, v3
  v_lshlrev_b32 v2, 16, v103
  v_and_b32 v3, 0xffff0000, v103
  v_add_f32 v74, v74, v2
  v_add_f32 v75, v75, v3
  v_lshlrev_b32 v2, 16, v104
  v_and_b32 v3, 0xffff0000, v104
  v_add_f32 v76, v76, v2
  v_add_f32 v77, v77, v3
  v_lshlrev_b32 v2, 16, v105
  v_and_b32 v3, 0xffff0000, v105
  v_add_f32 v78, v78, v2
  v_add_f32 v79, v79, v3
  v_lshlrev_b32 v2, 16, v106
  v_and_b32 v3, 0xffff0000, v106
  v_add_f32 v80, v80, v2
  v_add_f32 v81, v81, v3
  v_lshlrev_b32 v2, 16, v107
  v_and_b32 v3, 0xffff0000, v107
  v_add_f32 v82, v82, v2
  v_add_f32 v83, v83, v3
  v_lshlrev_b32 v2, 16, v108
  v_and_b32 v3, 0xffff0000, v108
  v_add_f32 v84, v84, v2
  v_add_f32 v85, v85, v3
  v_lshlrev_b32 v2, 16, v109
  v_and_b32 v3, 0xffff0000, v109
  v_add_f32 v86, v86, v2
  v_add_f32 v87, v87, v3
  v_lshlrev_b32 v2, 16, v110
  v_and_b32 v3, 0xffff0000, v110
  v_add_f32 v88, v88, v2
  v_add_f32 v89, v89, v3
  v_lshlrev_b32 v2, 16, v111
  v_and_b32 v3, 0xffff0000, v111
  v_add_f32 v90, v90, v2
  v_add_f32 v91, v91, v3
  v_lshlrev_b32 v2, 16, v112
  v_and_b32 v3, 0xffff0000, v112
  v_add_f32 v92, v92, v2
  v_add_f32 v93, v93, v3
  v_lshlrev_b32 v2, 16, v113
  v_and_b32 v3, 0xffff0000, v113
  v_add_f32 v94, v94, v2
  v_add_f32 v95, v95, v3
  v_lshlrev_b32 v2, 16, v114
  v_and_b32 v3, 0xffff0000, v114
  v_add_f32 v96, v96, v2
  v_add_f32 v97, v97, v3
  v_lshlrev_b32 v2, 16, v115
  v_and_b32 v3, 0xffff0000, v115
  v_add_f32 v98, v98, v2
  v_add_f32 v99, v99, v3
  s_lshl_b32 s31, s28, 4
  s_add_u32 s31, s31, s29
  s_lshl_b32 s31, s31, 14
  s_lshl_b32 s39, s42, 13
  s_add_u32 s31, s31, s39
  s_lshl_b32 s39, s43, 10
  s_add_u32 s31, s31, s39
  s_add_u32 s31, s31, 16777216
  v_cvt_pk_bf16_f32 v120, v68, v69
  v_cvt_pk_bf16_f32 v121, v70, v71
  v_cvt_pk_bf16_f32 v122, v72, v73
  v_cvt_pk_bf16_f32 v123, v74, v75
  buffer_store_dwordx4 v[120:123], v10, s[12:15], s31 offen offset:0 sc1
  s_lshl_b32 s68, s42, 13
  s_lshl_b32 s67, s43, 10
  s_add_u32 s69, s68, s67
  v_lshlrev_b32 v116, 4, v1
  v_add_u32 v116, s69, v116
  v_add_u32 v116, 0x16000, v116
  ds_write_b128 v116, v[120:123] offset:0
  v_cvt_pk_bf16_f32 v124, v76, v77
  v_cvt_pk_bf16_f32 v125, v78, v79
  v_cvt_pk_bf16_f32 v126, v80, v81
  v_cvt_pk_bf16_f32 v127, v82, v83
  buffer_store_dwordx4 v[124:127], v10, s[12:15], s31 offen offset:2048 sc1
  ds_write_b128 v116, v[124:127] offset:2048
  v_cvt_pk_bf16_f32 v120, v84, v85
  v_cvt_pk_bf16_f32 v121, v86, v87
  v_cvt_pk_bf16_f32 v122, v88, v89
  v_cvt_pk_bf16_f32 v123, v90, v91
  s_add_u32 s31, s31, 4096
  buffer_store_dwordx4 v[120:123], v10, s[12:15], s31 offen offset:0 sc1
  ds_write_b128 v116, v[120:123] offset:4096
  v_cvt_pk_bf16_f32 v124, v92, v93
  v_cvt_pk_bf16_f32 v125, v94, v95
  v_cvt_pk_bf16_f32 v126, v96, v97
  v_cvt_pk_bf16_f32 v127, v98, v99
  buffer_store_dwordx4 v[124:127], v10, s[12:15], s31 offen offset:2048 sc1
  ds_write_b128 v116, v[124:127] offset:6144
  s_barrier
  s_waitcnt vmcnt(0)
  v_mov_b32 v2, 163720
  v_mov_b32 v3, 1
  s_mov_b64 exec, 1
  ds_add_rtn_u32 v2, v2, v3
  s_lshl_b32 s31, s28, 4
  s_add_u32 s31, s31, s29
  s_lshl_b32 s31, s31, 7
  s_add_u32 s31, s31, 54525952
  s_waitcnt lgkmcnt(0)
  v_readfirstlane_b32 s39, v2
  v_mov_b32 v2, 0
  v_mov_b32 v3, s1
  s_nop 1
  s_cmp_eq_u32 s39, 3
  s_cbranch_scc0 L_notlast_h
  buffer_store_dword v3, v2, s[12:15], s31 offen sc1
L_notlast_h:
  s_mov_b64 exec, -1
  v_add_f32 v128, v68, v69
  v_add_f32 v128, v128, v70
  v_add_f32 v128, v128, v71
  v_add_f32 v128, v128, v72
  v_add_f32 v128, v128, v73
  v_add_f32 v128, v128, v74
  v_add_f32 v128, v128, v75
  v_add_f32 v130, v76, v77
  v_add_f32 v130, v130, v78
  v_add_f32 v130, v130, v79
  v_add_f32 v130, v130, v80
  v_add_f32 v130, v130, v81
  v_add_f32 v130, v130, v82
  v_add_f32 v130, v130, v83
  v_add_f32 v132, v84, v85
  v_add_f32 v132, v132, v86
  v_add_f32 v132, v132, v87
  v_add_f32 v132, v132, v88
  v_add_f32 v132, v132, v89
  v_add_f32 v132, v132, v90
  v_add_f32 v132, v132, v91
  v_add_f32 v134, v92, v93
  v_add_f32 v134, v134, v94
  v_add_f32 v134, v134, v95
  v_add_f32 v134, v134, v96
  v_add_f32 v134, v134, v97
  v_add_f32 v134, v134, v98
  v_add_f32 v134, v134, v99
  v_mov_b32 v136, v128
  v_mov_b32 v137, v130
  v_mov_b32 v138, v132
  v_mov_b32 v139, v134
  s_nop 1
  v_permlane16_swap_b32 v136, v128
  v_permlane16_swap_b32 v137, v130
  v_permlane16_swap_b32 v138, v132
  v_permlane16_swap_b32 v139, v134
  s_nop 1
  v_add_f32 v128, v128, v136
  v_add_f32 v130, v130, v137
  v_add_f32 v132, v132, v138
  v_add_f32 v134, v134, v139
  v_mov_b32 v136, v128
  v_mov_b32 v137, v130
  v_mov_b32 v138, v132
  v_mov_b32 v139, v134
  s_nop 1
  v_permlane32_swap_b32 v136, v128
  v_permlane32_swap_b32 v137, v130
  v_permlane32_swap_b32 v138, v132
  v_permlane32_swap_b32 v139, v134
  s_nop 1
  v_add_f32 v128, v128, v136
  v_add_f32 v130, v130, v137
  v_add_f32 v132, v132, v138
  v_add_f32 v134, v134, v139
  v_mul_f32 v2, 0x3d000000, v128
  v_sub_f32 v3, v68, v2
  v_mul_f32 v129, v3, v3
  v_sub_f32 v3, v69, v2
  v_fmac_f32 v129, v3, v3
  v_sub_f32 v3, v70, v2
  v_fmac_f32 v129, v3, v3
  v_sub_f32 v3, v71, v2
  v_fmac_f32 v129, v3, v3
  v_sub_f32 v3, v72, v2
  v_fmac_f32 v129, v3, v3
  v_sub_f32 v3, v73, v2
  v_fmac_f32 v129, v3, v3
  v_sub_f32 v3, v74, v2
  v_fmac_f32 v129, v3, v3
  v_sub_f32 v3, v75, v2
  v_fmac_f32 v129, v3, v3
  v_mul_f32 v2, 0x3d000000, v130
  v_sub_f32 v3, v76, v2
  v_mul_f32 v131, v3, v3
  v_sub_f32 v3, v77, v2
  v_fmac_f32 v131, v3, v3
  v_sub_f32 v3, v78, v2
  v_fmac_f32 v131, v3, v3
  v_sub_f32 v3, v79, v2
  v_fmac_f32 v131, v3, v3
  v_sub_f32 v3, v80, v2
  v_fmac_f32 v131, v3, v3
  v_sub_f32 v3, v81, v2
  v_fmac_f32 v131, v3, v3
  v_sub_f32 v3, v82, v2
  v_fmac_f32 v131, v3, v3
  v_sub_f32 v3, v83, v2
  v_fmac_f32 v131, v3, v3
  v_mul_f32 v2, 0x3d000000, v132
  v_sub_f32 v3, v84, v2
  v_mul_f32 v133, v3, v3
  v_sub_f32 v3, v85, v2
  v_fmac_f32 v133, v3, v3
  v_sub_f32 v3, v86, v2
  v_fmac_f32 v133, v3, v3
  v_sub_f32 v3, v87, v2
  v_fmac_f32 v133, v3, v3
  v_sub_f32 v3, v88, v2
  v_fmac_f32 v133, v3, v3
  v_sub_f32 v3, v89, v2
  v_fmac_f32 v133, v3, v3
  v_sub_f32 v3, v90, v2
  v_fmac_f32 v133, v3, v3
  v_sub_f32 v3, v91, v2
  v_fmac_f32 v133, v3, v3
  v_mul_f32 v2, 0x3d000000, v134
  v_sub_f32 v3, v92, v2
  v_mul_f32 v135, v3, v3
  v_sub_f32 v3, v93, v2
  v_fmac_f32 v135, v3, v3
  v_sub_f32 v3, v94, v2
  v_fmac_f32 v135, v3, v3
  v_sub_f32 v3, v95, v2
  v_fmac_f32 v135, v3, v3
  v_sub_f32 v3, v96, v2
  v_fmac_f32 v135, v3, v3
  v_sub_f32 v3, v97, v2
  v_fmac_f32 v135, v3, v3
  v_sub_f32 v3, v98, v2
  v_fmac_f32 v135, v3, v3
  v_sub_f32 v3, v99, v2
  v_fmac_f32 v135, v3, v3
  v_mov_b32 v136, v129
  v_mov_b32 v137, v131
  v_mov_b32 v138, v133
  v_mov_b32 v139, v135
  s_nop 1
  v_permlane16_swap_b32 v136, v129
  v_permlane16_swap_b32 v137, v131
  v_permlane16_swap_b32 v138, v133
  v_permlane16_swap_b32 v139, v135
  s_nop 1
  v_add_f32 v129, v129, v136
  v_add_f32 v131, v131, v137
  v_add_f32 v133, v133, v138
  v_add_f32 v135, v135, v139
  v_mov_b32 v136, v129
  v_mov_b32 v137, v131
  v_mov_b32 v138, v133
  v_mov_b32 v139, v135
  s_nop 1
  v_permlane32_swap_b32 v136, v129
  v_permlane32_swap_b32 v137, v131
  v_permlane32_swap_b32 v138, v133
  v_permlane32_swap_b32 v139, v135
  s_nop 1
  v_add_f32 v129, v129, v136
  v_add_f32 v131, v131, v137
  v_add_f32 v133, v133, v138
  v_add_f32 v135, v135, v139
  s_lshl_b32 s31, s29, 1
  s_add_u32 s31, s31, s43
  s_lshl_b32 s31, s31, 11
  s_lshl_b32 s39, s28, 7
  s_add_u32 s31, s31, s39
  s_lshl_b32 s39, s42, 6
  s_add_u32 s31, s31, s39
  s_lshl_b32 s31, s31, 3
  s_add_u32 s31, s31, 38797312
  v_lshlrev_b32 v2, 3, v1
  v_cmp_gt_u32 vcc, 16, v1
  s_and_saveexec_b64 s[62:63], vcc
  buffer_store_dwordx2 v[128:129], v2, s[12:15], s31 offen offset:0 sc1
  buffer_store_dwordx2 v[130:131], v2, s[12:15], s31 offen offset:128 sc1
  buffer_store_dwordx2 v[132:133], v2, s[12:15], s31 offen offset:256 sc1
  buffer_store_dwordx2 v[134:135], v2, s[12:15], s31 offen offset:384 sc1
  s_mov_b64 exec, s[62:63]
  s_lshl_b32 s67, s42, 2
  s_lshl_b32 s68, s67, 1
  s_lshl_b32 s69, s68, 10
  v_lshlrev_b32 v12, 4, v1
  v_add_u32 v12, s69, v12
  v_lshrrev_b32 v14, 4, v1
  v_lshlrev_b32 v14, 2, v14
  v_lshrrev_b32 v7, 2, v1
  v_and_b32 v7, 3, v7
  v_add_u32 v14, v14, v7
  v_mul_u32_u24 v14, 0x1c0, v14
  s_lshl_b32 s68, s43, 7
  s_lshr_b32 s69, s68, 3
  v_lshrrev_b32 v7, 1, v1
  v_and_b32 v7, 1, v7
  v_add_u32 v7, s69, v7
  v_lshrrev_b32 v6, 4, v1
  v_lshlrev_b32 v6, 2, v6
  v_lshrrev_b32 v5, 2, v1
  v_and_b32 v5, 3, v5
  v_add_u32 v6, v6, v5
  v_lshrrev_b32 v6, 2, v6
  v_and_b32 v6, 1, v6
  v_lshlrev_b32 v6, 1, v6
  v_xor_b32 v7, v7, v6
  v_lshlrev_b32 v7, 4, v7
  v_add_u32 v14, v14, v7
  v_and_b32 v7, 1, v1
  v_lshlrev_b32 v7, 3, v7
  v_add_u32 v14, v14, v7
  v_add_u32 v14, 0x4000, v14
  v_lshrrev_b32 v15, 4, v1
  v_lshlrev_b32 v15, 2, v15
  v_lshrrev_b32 v7, 2, v1
  v_and_b32 v7, 3, v7
  v_add_u32 v15, v15, v7
  v_mul_u32_u24 v15, 0x1c0, v15
  s_lshl_b32 s67, s43, 7
  s_add_u32 s68, s67, 16
  s_lshr_b32 s69, s68, 3
  v_lshrrev_b32 v7, 1, v1
  v_and_b32 v7, 1, v7
  v_add_u32 v7, s69, v7
  v_lshrrev_b32 v6, 4, v1
  v_lshlrev_b32 v6, 2, v6
  v_lshrrev_b32 v5, 2, v1
  v_and_b32 v5, 3, v5
  v_add_u32 v6, v6, v5
  v_lshrrev_b32 v6, 2, v6
  v_and_b32 v6, 1, v6
  v_lshlrev_b32 v6, 1, v6
  v_xor_b32 v7, v7, v6
  v_lshlrev_b32 v7, 4, v7
  v_add_u32 v15, v15, v7
  v_and_b32 v7, 1, v1
  v_lshlrev_b32 v7, 3, v7
  v_add_u32 v15, v15, v7
  v_add_u32 v15, 0x4000, v15
  v_lshrrev_b32 v16, 4, v1
  v_lshlrev_b32 v16, 2, v16
  v_lshrrev_b32 v7, 2, v1
  v_and_b32 v7, 3, v7
  v_add_u32 v16, v16, v7
  v_mul_u32_u24 v16, 0x1c0, v16
  s_lshl_b32 s67, s43, 4
  s_add_u32 s68, s67, 0x60
  s_lshr_b32 s69, s68, 3
  v_lshrrev_b32 v7, 1, v1
  v_and_b32 v7, 1, v7
  v_add_u32 v7, s69, v7
  v_lshrrev_b32 v6, 4, v1
  v_lshlrev_b32 v6, 2, v6
  v_lshrrev_b32 v5, 2, v1
  v_and_b32 v5, 3, v5
  v_add_u32 v6, v6, v5
  v_lshrrev_b32 v6, 2, v6
  v_and_b32 v6, 1, v6
  v_lshlrev_b32 v6, 1, v6
  v_xor_b32 v7, v7, v6
  v_lshlrev_b32 v7, 4, v7
  v_add_u32 v16, v16, v7
  v_and_b32 v7, 1, v1
  v_lshlrev_b32 v7, 3, v7
  v_add_u32 v16, v16, v7
  v_add_u32 v16, 0x4000, v16
  s_mov_b32 s34, 90112
  v_add_u32 v13, s34, v12
  v_add_u32 v17, s34, v14
  v_add_u32 v18, s34, v15
  v_add_u32 v19, s34, v16
  s_waitcnt lgkmcnt(0)
  s_setprio 0
  s_barrier
  ds_read_b128 v[20:23], v13 offset:0
  ds_read_b64_tr_b16 v[52:53], v17 offset:0
  ds_read_b64_tr_b16 v[54:55], v17 offset:7168
  ds_read_b128 v[24:27], v13 offset:2048
  ds_read_b128 v[28:31], v13 offset:4096
  ds_read_b128 v[32:35], v13 offset:6144
  ds_read_b64_tr_b16 v[56:57], v18 offset:0
  ds_read_b64_tr_b16 v[58:59], v18 offset:7168
  ds_read_b64_tr_b16 v[60:61], v17 offset:64
  ds_read_b64_tr_b16 v[62:63], v17 offset:7232
  ds_read_b64_tr_b16 v[64:65], v18 offset:64
  ds_read_b64_tr_b16 v[66:67], v18 offset:7232
  ds_read_b64_tr_b16 v[68:69], v17 offset:128
  ds_read_b64_tr_b16 v[70:71], v17 offset:7296
  ds_read_b64_tr_b16 v[72:73], v18 offset:128
  ds_read_b64_tr_b16 v[74:75], v18 offset:7296
  ds_read_b64_tr_b16 v[76:77], v19 offset:0
  ds_read_b64_tr_b16 v[78:79], v19 offset:7168
  s_waitcnt lgkmcnt(15)
  v_mfma_f32_16x16x32_bf16 v[108:111], v[52:55], v[20:23], 0
  ds_read_b128 v[36:39], v13 offset:1024
  s_waitcnt lgkmcnt(15)
  v_mfma_f32_16x16x32_bf16 v[136:139], v[52:55], v[24:27], 0
  ds_read_b64_tr_b16 v[80:81], v17 offset:14336
  s_waitcnt lgkmcnt(15)
  v_mfma_f32_16x16x32_bf16 v[164:167], v[52:55], v[28:31], 0
  ds_read_b64_tr_b16 v[82:83], v17 offset:21504
  s_waitcnt lgkmcnt(15)
  v_mfma_f32_16x16x32_bf16 v[192:195], v[52:55], v[32:35], 0
  s_waitcnt lgkmcnt(13)
  v_mfma_f32_16x16x32_bf16 v[196:199], v[56:59], v[32:35], 0
  ds_read_b128 v[40:43], v13 offset:3072
  v_mfma_f32_16x16x32_bf16 v[168:171], v[56:59], v[28:31], 0
  ds_read_b128 v[44:47], v13 offset:5120
  v_mfma_f32_16x16x32_bf16 v[140:143], v[56:59], v[24:27], 0
  ds_read_b128 v[48:51], v13 offset:7168
  v_mfma_f32_16x16x32_bf16 v[112:115], v[56:59], v[20:23], 0
  s_waitcnt lgkmcnt(14)
  v_mfma_f32_16x16x32_bf16 v[116:119], v[60:63], v[20:23], 0
  ds_read_b64_tr_b16 v[84:85], v18 offset:14336
  v_mfma_f32_16x16x32_bf16 v[144:147], v[60:63], v[24:27], 0
  ds_read_b64_tr_b16 v[86:87], v18 offset:21504
  v_mfma_f32_16x16x32_bf16 v[172:175], v[60:63], v[28:31], 0
  v_mfma_f32_16x16x32_bf16 v[200:203], v[60:63], v[32:35], 0
  ds_read_b64_tr_b16 v[88:89], v17 offset:14400
  s_waitcnt lgkmcnt(15)
  v_mfma_f32_16x16x32_bf16 v[204:207], v[64:67], v[32:35], 0
  ds_read_b64_tr_b16 v[90:91], v17 offset:21568
  v_mfma_f32_16x16x32_bf16 v[176:179], v[64:67], v[28:31], 0
  ds_read_b64_tr_b16 v[92:93], v18 offset:14400
  v_mfma_f32_16x16x32_bf16 v[148:151], v[64:67], v[24:27], 0
  v_mfma_f32_16x16x32_bf16 v[120:123], v[64:67], v[20:23], 0
  ds_read_b64_tr_b16 v[94:95], v18 offset:21568
  s_waitcnt lgkmcnt(15)
  v_mfma_f32_16x16x32_bf16 v[124:127], v[68:71], v[20:23], 0
  ds_read_b64_tr_b16 v[96:97], v17 offset:14464
  v_mfma_f32_16x16x32_bf16 v[152:155], v[68:71], v[24:27], 0
  v_mfma_f32_16x16x32_bf16 v[180:183], v[68:71], v[28:31], 0
  ds_read_b64_tr_b16 v[98:99], v17 offset:21632
  v_mfma_f32_16x16x32_bf16 v[208:211], v[68:71], v[32:35], 0
  ds_read_b64_tr_b16 v[100:101], v18 offset:14464
  s_waitcnt lgkmcnt(15)
  v_mfma_f32_16x16x32_bf16 v[212:215], v[72:75], v[32:35], 0
  ds_read_b64_tr_b16 v[102:103], v18 offset:21632
  v_mfma_f32_16x16x32_bf16 v[184:187], v[72:75], v[28:31], 0
  v_mfma_f32_16x16x32_bf16 v[156:159], v[72:75], v[24:27], 0
  ds_read_b64_tr_b16 v[104:105], v19 offset:14336
  v_mfma_f32_16x16x32_bf16 v[128:131], v[72:75], v[20:23], 0
  ds_read_b64_tr_b16 v[106:107], v19 offset:21504
  v_mfma_f32_16x16x32_bf16 v[132:135], v[76:79], v[20:23], 0
  v_mfma_f32_16x16x32_bf16 v[160:163], v[76:79], v[24:27], 0
  v_mfma_f32_16x16x32_bf16 v[188:191], v[76:79], v[28:31], 0
  v_mfma_f32_16x16x32_bf16 v[216:219], v[76:79], v[32:35], 0
  s_waitcnt lgkmcnt(0)
  s_barrier
  v_mfma_f32_16x16x32_bf16 v[108:111], v[80:83], v[36:39], v[108:111]
  v_mfma_f32_16x16x32_bf16 v[136:139], v[80:83], v[40:43], v[136:139]
  v_mfma_f32_16x16x32_bf16 v[164:167], v[80:83], v[44:47], v[164:167]
  v_mfma_f32_16x16x32_bf16 v[192:195], v[80:83], v[48:51], v[192:195]
  v_mfma_f32_16x16x32_bf16 v[196:199], v[84:87], v[48:51], v[196:199]
  v_mfma_f32_16x16x32_bf16 v[168:171], v[84:87], v[44:47], v[168:171]
  v_mfma_f32_16x16x32_bf16 v[140:143], v[84:87], v[40:43], v[140:143]
  v_mfma_f32_16x16x32_bf16 v[112:115], v[84:87], v[36:39], v[112:115]
  v_mfma_f32_16x16x32_bf16 v[116:119], v[88:91], v[36:39], v[116:119]
  v_mfma_f32_16x16x32_bf16 v[144:147], v[88:91], v[40:43], v[144:147]
  v_mfma_f32_16x16x32_bf16 v[172:175], v[88:91], v[44:47], v[172:175]
  v_mfma_f32_16x16x32_bf16 v[200:203], v[88:91], v[48:51], v[200:203]
  v_mfma_f32_16x16x32_bf16 v[204:207], v[92:95], v[48:51], v[204:207]
  v_mfma_f32_16x16x32_bf16 v[176:179], v[92:95], v[44:47], v[176:179]
  v_mfma_f32_16x16x32_bf16 v[148:151], v[92:95], v[40:43], v[148:151]
  v_mfma_f32_16x16x32_bf16 v[120:123], v[92:95], v[36:39], v[120:123]
  v_mfma_f32_16x16x32_bf16 v[124:127], v[96:99], v[36:39], v[124:127]
  v_mfma_f32_16x16x32_bf16 v[152:155], v[96:99], v[40:43], v[152:155]
  v_mfma_f32_16x16x32_bf16 v[180:183], v[96:99], v[44:47], v[180:183]
  v_mfma_f32_16x16x32_bf16 v[208:211], v[96:99], v[48:51], v[208:211]
  v_mfma_f32_16x16x32_bf16 v[212:215], v[100:103], v[48:51], v[212:215]
  v_mfma_f32_16x16x32_bf16 v[184:187], v[100:103], v[44:47], v[184:187]
  v_mfma_f32_16x16x32_bf16 v[156:159], v[100:103], v[40:43], v[156:159]
  v_mfma_f32_16x16x32_bf16 v[128:131], v[100:103], v[36:39], v[128:131]
  v_mfma_f32_16x16x32_bf16 v[132:135], v[104:107], v[36:39], v[132:135]
  v_mfma_f32_16x16x32_bf16 v[160:163], v[104:107], v[40:43], v[160:163]
  v_mfma_f32_16x16x32_bf16 v[188:191], v[104:107], v[44:47], v[188:191]
  v_mfma_f32_16x16x32_bf16 v[216:219], v[104:107], v[48:51], v[216:219]
  s_setprio 3
  s_waitcnt vmcnt(0)
  v_mov_b32 v2, 163728
  v_mov_b32 v3, 1
  s_mov_b64 exec, 1
  ds_add_rtn_u32 v2, v2, v3
  s_lshl_b32 s31, s28, 4
  s_add_u32 s31, s31, s29
  s_lshl_b32 s31, s31, 7
  s_add_u32 s31, s31, 54624256
  s_waitcnt lgkmcnt(0)
  v_readfirstlane_b32 s39, v2
  v_mov_b32 v2, 0
  v_mov_b32 v3, s1
  s_nop 1
  s_cmp_eq_u32 s39, 3
  s_cbranch_scc0 L_notlast_s2
  buffer_store_dword v3, v2, s[12:15], s31 offen sc1
L_notlast_s2:
  s_mov_b64 exec, -1
  s_cmp_lg_u32 s70, 0
  s_cbranch_scc1 L_nocpoll_f1
  s_lshl_b32 s31, s28, 11
  s_add_u32 s31, s31, 54525952
  v_and_b32 v4, 15, v1
  v_lshlrev_b32 v4, 7, v4
  v_add_u32 v4, s31, v4
  s_mov_b32 s36, 400000
L_poll_f1:
  buffer_load_dword v2, v4, s[12:15], 0 offen sc1
  s_waitcnt vmcnt(0)
  v_cmp_eq_u32 vcc, s1, v2
  s_nop 4
  s_cmp_eq_u64 vcc, exec
  s_cbranch_scc1 L_polldone_f1
  s_sleep 4
  s_sub_u32 s36, s36, 1
  s_cmp_lg_u32 s36, 0
  s_cbranch_scc1 L_poll_f1
L_polldone_f1:
L_nocpoll_f1:
  s_barrier
  s_mov_b32 s34, 0
  v_add_u32 v13, s34, v12
  v_add_u32 v17, s34, v14
  v_add_u32 v18, s34, v15
  v_add_u32 v19, s34, v16
  s_waitcnt lgkmcnt(0)
  s_setprio 0
  s_barrier
  ds_read_b128 v[20:23], v13 offset:0
  ds_read_b64_tr_b16 v[52:53], v17 offset:0
  ds_read_b64_tr_b16 v[54:55], v17 offset:7168
  ds_read_b128 v[24:27], v13 offset:2048
  ds_read_b128 v[28:31], v13 offset:4096
  ds_read_b128 v[32:35], v13 offset:6144
  ds_read_b64_tr_b16 v[56:57], v18 offset:0
  ds_read_b64_tr_b16 v[58:59], v18 offset:7168
  ds_read_b64_tr_b16 v[60:61], v17 offset:64
  ds_read_b64_tr_b16 v[62:63], v17 offset:7232
  ds_read_b64_tr_b16 v[64:65], v18 offset:64
  ds_read_b64_tr_b16 v[66:67], v18 offset:7232
  ds_read_b64_tr_b16 v[68:69], v17 offset:128
  ds_read_b64_tr_b16 v[70:71], v17 offset:7296
  ds_read_b64_tr_b16 v[72:73], v18 offset:128
  ds_read_b64_tr_b16 v[74:75], v18 offset:7296
  ds_read_b64_tr_b16 v[76:77], v19 offset:0
  ds_read_b64_tr_b16 v[78:79], v19 offset:7168
  s_waitcnt lgkmcnt(15)
  v_mfma_f32_16x16x32_bf16 v[108:111], v[52:55], v[20:23], v[108:111]
  ds_read_b128 v[36:39], v13 offset:1024
  s_waitcnt lgkmcnt(15)
  v_mfma_f32_16x16x32_bf16 v[136:139], v[52:55], v[24:27], v[136:139]
  ds_read_b64_tr_b16 v[80:81], v17 offset:14336
  s_waitcnt lgkmcnt(15)
  v_mfma_f32_16x16x32_bf16 v[164:167], v[52:55], v[28:31], v[164:167]
  ds_read_b64_tr_b16 v[82:83], v17 offset:21504
  s_waitcnt lgkmcnt(15)
  v_mfma_f32_16x16x32_bf16 v[192:195], v[52:55], v[32:35], v[192:195]
  s_waitcnt lgkmcnt(13)
  v_mfma_f32_16x16x32_bf16 v[196:199], v[56:59], v[32:35], v[196:199]
  ds_read_b128 v[40:43], v13 offset:3072
  v_mfma_f32_16x16x32_bf16 v[168:171], v[56:59], v[28:31], v[168:171]
  ds_read_b128 v[44:47], v13 offset:5120
  v_mfma_f32_16x16x32_bf16 v[140:143], v[56:59], v[24:27], v[140:143]
  ds_read_b128 v[48:51], v13 offset:7168
  v_mfma_f32_16x16x32_bf16 v[112:115], v[56:59], v[20:23], v[112:115]
  s_waitcnt lgkmcnt(14)
  v_mfma_f32_16x16x32_bf16 v[116:119], v[60:63], v[20:23], v[116:119]
  ds_read_b64_tr_b16 v[84:85], v18 offset:14336
  v_mfma_f32_16x16x32_bf16 v[144:147], v[60:63], v[24:27], v[144:147]
  ds_read_b64_tr_b16 v[86:87], v18 offset:21504
  v_mfma_f32_16x16x32_bf16 v[172:175], v[60:63], v[28:31], v[172:175]
  v_mfma_f32_16x16x32_bf16 v[200:203], v[60:63], v[32:35], v[200:203]
  ds_read_b64_tr_b16 v[88:89], v17 offset:14400
  s_waitcnt lgkmcnt(15)
  v_mfma_f32_16x16x32_bf16 v[204:207], v[64:67], v[32:35], v[204:207]
  ds_read_b64_tr_b16 v[90:91], v17 offset:21568
  v_mfma_f32_16x16x32_bf16 v[176:179], v[64:67], v[28:31], v[176:179]
  ds_read_b64_tr_b16 v[92:93], v18 offset:14400
  v_mfma_f32_16x16x32_bf16 v[148:151], v[64:67], v[24:27], v[148:151]
  v_mfma_f32_16x16x32_bf16 v[120:123], v[64:67], v[20:23], v[120:123]
  ds_read_b64_tr_b16 v[94:95], v18 offset:21568
  s_waitcnt lgkmcnt(15)
  v_mfma_f32_16x16x32_bf16 v[124:127], v[68:71], v[20:23], v[124:127]
  ds_read_b64_tr_b16 v[96:97], v17 offset:14464
  v_mfma_f32_16x16x32_bf16 v[152:155], v[68:71], v[24:27], v[152:155]
  v_mfma_f32_16x16x32_bf16 v[180:183], v[68:71], v[28:31], v[180:183]
  ds_read_b64_tr_b16 v[98:99], v17 offset:21632
  v_mfma_f32_16x16x32_bf16 v[208:211], v[68:71], v[32:35], v[208:211]
  ds_read_b64_tr_b16 v[100:101], v18 offset:14464
  s_waitcnt lgkmcnt(15)
  v_mfma_f32_16x16x32_bf16 v[212:215], v[72:75], v[32:35], v[212:215]
  ds_read_b64_tr_b16 v[102:103], v18 offset:21632
  v_mfma_f32_16x16x32_bf16 v[184:187], v[72:75], v[28:31], v[184:187]
  v_mfma_f32_16x16x32_bf16 v[156:159], v[72:75], v[24:27], v[156:159]
  ds_read_b64_tr_b16 v[104:105], v19 offset:14336
  v_mfma_f32_16x16x32_bf16 v[128:131], v[72:75], v[20:23], v[128:131]
  ds_read_b64_tr_b16 v[106:107], v19 offset:21504
  v_mfma_f32_16x16x32_bf16 v[132:135], v[76:79], v[20:23], v[132:135]
  v_mfma_f32_16x16x32_bf16 v[160:163], v[76:79], v[24:27], v[160:163]
  v_mfma_f32_16x16x32_bf16 v[188:191], v[76:79], v[28:31], v[188:191]
  v_mfma_f32_16x16x32_bf16 v[216:219], v[76:79], v[32:35], v[216:219]
  s_add_u32 s34, s34, 45056
  s_cmp_eq_u32 s34, 135168
  s_cselect_b32 s34, 0, s34
  v_add_u32 v13, s34, v12
  v_add_u32 v17, s34, v14
  v_add_u32 v18, s34, v15
  v_add_u32 v19, s34, v16
  s_waitcnt lgkmcnt(0)
  s_barrier
  s_mov_b32 s36, 13
  s_branch L_loop_f1
L_top_f1:
  s_barrier
L_loop_f1:
  v_mfma_f32_16x16x32_bf16 v[108:111], v[80:83], v[36:39], v[108:111]
  ds_read_b128 v[20:23], v13 offset:0
  v_mfma_f32_16x16x32_bf16 v[136:139], v[80:83], v[40:43], v[136:139]
  ds_read_b64_tr_b16 v[52:53], v17 offset:0
  v_mfma_f32_16x16x32_bf16 v[164:167], v[80:83], v[44:47], v[164:167]
  ds_read_b64_tr_b16 v[54:55], v17 offset:7168
  v_mfma_f32_16x16x32_bf16 v[192:195], v[80:83], v[48:51], v[192:195]
  v_mfma_f32_16x16x32_bf16 v[196:199], v[84:87], v[48:51], v[196:199]
  ds_read_b128 v[24:27], v13 offset:2048
  v_mfma_f32_16x16x32_bf16 v[168:171], v[84:87], v[44:47], v[168:171]
  ds_read_b128 v[28:31], v13 offset:4096
  v_mfma_f32_16x16x32_bf16 v[140:143], v[84:87], v[40:43], v[140:143]
  ds_read_b128 v[32:35], v13 offset:6144
  v_mfma_f32_16x16x32_bf16 v[112:115], v[84:87], v[36:39], v[112:115]
  v_mfma_f32_16x16x32_bf16 v[116:119], v[88:91], v[36:39], v[116:119]
  ds_read_b64_tr_b16 v[56:57], v18 offset:0
  v_mfma_f32_16x16x32_bf16 v[144:147], v[88:91], v[40:43], v[144:147]
  ds_read_b64_tr_b16 v[58:59], v18 offset:7168
  v_mfma_f32_16x16x32_bf16 v[172:175], v[88:91], v[44:47], v[172:175]
  v_mfma_f32_16x16x32_bf16 v[200:203], v[88:91], v[48:51], v[200:203]
  ds_read_b64_tr_b16 v[60:61], v17 offset:64
  v_mfma_f32_16x16x32_bf16 v[204:207], v[92:95], v[48:51], v[204:207]
  ds_read_b64_tr_b16 v[62:63], v17 offset:7232
  v_mfma_f32_16x16x32_bf16 v[176:179], v[92:95], v[44:47], v[176:179]
  ds_read_b64_tr_b16 v[64:65], v18 offset:64
  v_mfma_f32_16x16x32_bf16 v[148:151], v[92:95], v[40:43], v[148:151]
  v_mfma_f32_16x16x32_bf16 v[120:123], v[92:95], v[36:39], v[120:123]
  ds_read_b64_tr_b16 v[66:67], v18 offset:7232
  v_mfma_f32_16x16x32_bf16 v[124:127], v[96:99], v[36:39], v[124:127]
  ds_read_b64_tr_b16 v[68:69], v17 offset:128
  v_mfma_f32_16x16x32_bf16 v[152:155], v[96:99], v[40:43], v[152:155]
  v_mfma_f32_16x16x32_bf16 v[180:183], v[96:99], v[44:47], v[180:183]
  ds_read_b64_tr_b16 v[70:71], v17 offset:7296
  v_mfma_f32_16x16x32_bf16 v[208:211], v[96:99], v[48:51], v[208:211]
  ds_read_b64_tr_b16 v[72:73], v18 offset:128
  v_mfma_f32_16x16x32_bf16 v[212:215], v[100:103], v[48:51], v[212:215]
  ds_read_b64_tr_b16 v[74:75], v18 offset:7296
  v_mfma_f32_16x16x32_bf16 v[184:187], v[100:103], v[44:47], v[184:187]
  v_mfma_f32_16x16x32_bf16 v[156:159], v[100:103], v[40:43], v[156:159]
  ds_read_b64_tr_b16 v[76:77], v19 offset:0
  v_mfma_f32_16x16x32_bf16 v[128:131], v[100:103], v[36:39], v[128:131]
  ds_read_b64_tr_b16 v[78:79], v19 offset:7168
  v_mfma_f32_16x16x32_bf16 v[132:135], v[104:107], v[36:39], v[132:135]
  v_mfma_f32_16x16x32_bf16 v[160:163], v[104:107], v[40:43], v[160:163]
  v_mfma_f32_16x16x32_bf16 v[188:191], v[104:107], v[44:47], v[188:191]
  v_mfma_f32_16x16x32_bf16 v[216:219], v[104:107], v[48:51], v[216:219]
  s_waitcnt lgkmcnt(15)
  v_mfma_f32_16x16x32_bf16 v[108:111], v[52:55], v[20:23], v[108:111]
  ds_read_b128 v[36:39], v13 offset:1024
  s_waitcnt lgkmcnt(15)
  v_mfma_f32_16x16x32_bf16 v[136:139], v[52:55], v[24:27], v[136:139]
  ds_read_b64_tr_b16 v[80:81], v17 offset:14336
  s_waitcnt lgkmcnt(15)
  v_mfma_f32_16x16x32_bf16 v[164:167], v[52:55], v[28:31], v[164:167]
  ds_read_b64_tr_b16 v[82:83], v17 offset:21504
  s_waitcnt lgkmcnt(15)
  v_mfma_f32_16x16x32_bf16 v[192:195], v[52:55], v[32:35], v[192:195]
  s_waitcnt lgkmcnt(13)
  v_mfma_f32_16x16x32_bf16 v[196:199], v[56:59], v[32:35], v[196:199]
  ds_read_b128 v[40:43], v13 offset:3072
  v_mfma_f32_16x16x32_bf16 v[168:171], v[56:59], v[28:31], v[168:171]
  ds_read_b128 v[44:47], v13 offset:5120
  v_mfma_f32_16x16x32_bf16 v[140:143], v[56:59], v[24:27], v[140:143]
  ds_read_b128 v[48:51], v13 offset:7168
  v_mfma_f32_16x16x32_bf16 v[112:115], v[56:59], v[20:23], v[112:115]
  s_waitcnt lgkmcnt(14)
  v_mfma_f32_16x16x32_bf16 v[116:119], v[60:63], v[20:23], v[116:119]
  ds_read_b64_tr_b16 v[84:85], v18 offset:14336
  v_mfma_f32_16x16x32_bf16 v[144:147], v[60:63], v[24:27], v[144:147]
  ds_read_b64_tr_b16 v[86:87], v18 offset:21504
  v_mfma_f32_16x16x32_bf16 v[172:175], v[60:63], v[28:31], v[172:175]
  v_mfma_f32_16x16x32_bf16 v[200:203], v[60:63], v[32:35], v[200:203]
  ds_read_b64_tr_b16 v[88:89], v17 offset:14400
  s_waitcnt lgkmcnt(15)
  v_mfma_f32_16x16x32_bf16 v[204:207], v[64:67], v[32:35], v[204:207]
  ds_read_b64_tr_b16 v[90:91], v17 offset:21568
  v_mfma_f32_16x16x32_bf16 v[176:179], v[64:67], v[28:31], v[176:179]
  ds_read_b64_tr_b16 v[92:93], v18 offset:14400
  v_mfma_f32_16x16x32_bf16 v[148:151], v[64:67], v[24:27], v[148:151]
  v_mfma_f32_16x16x32_bf16 v[120:123], v[64:67], v[20:23], v[120:123]
  ds_read_b64_tr_b16 v[94:95], v18 offset:21568
  s_waitcnt lgkmcnt(15)
  v_mfma_f32_16x16x32_bf16 v[124:127], v[68:71], v[20:23], v[124:127]
  ds_read_b64_tr_b16 v[96:97], v17 offset:14464
  v_mfma_f32_16x16x32_bf16 v[152:155], v[68:71], v[24:27], v[152:155]
  v_mfma_f32_16x16x32_bf16 v[180:183], v[68:71], v[28:31], v[180:183]
  ds_read_b64_tr_b16 v[98:99], v17 offset:21632
  v_mfma_f32_16x16x32_bf16 v[208:211], v[68:71], v[32:35], v[208:211]
  ds_read_b64_tr_b16 v[100:101], v18 offset:14464
  s_waitcnt lgkmcnt(15)
  v_mfma_f32_16x16x32_bf16 v[212:215], v[72:75], v[32:35], v[212:215]
  ds_read_b64_tr_b16 v[102:103], v18 offset:21632
  v_mfma_f32_16x16x32_bf16 v[184:187], v[72:75], v[28:31], v[184:187]
  v_mfma_f32_16x16x32_bf16 v[156:159], v[72:75], v[24:27], v[156:159]
  ds_read_b64_tr_b16 v[104:105], v19 offset:14336
  v_mfma_f32_16x16x32_bf16 v[128:131], v[72:75], v[20:23], v[128:131]
  ds_read_b64_tr_b16 v[106:107], v19 offset:21504
  v_mfma_f32_16x16x32_bf16 v[132:135], v[76:79], v[20:23], v[132:135]
  v_mfma_f32_16x16x32_bf16 v[160:163], v[76:79], v[24:27], v[160:163]
  s_add_u32 s34, s34, 45056
  s_cmp_eq_u32 s34, 135168
  s_cselect_b32 s34, 0, s34
  v_add_u32 v13, s34, v12
  v_add_u32 v17, s34, v14
  v_mfma_f32_16x16x32_bf16 v[188:191], v[76:79], v[28:31], v[188:191]
  v_add_u32 v18, s34, v15
  v_add_u32 v19, s34, v16
  s_sub_u32 s36, s36, 1
  s_cmp_lg_u32 s36, 0
  v_mfma_f32_16x16x32_bf16 v[216:219], v[76:79], v[32:35], v[216:219]
  s_waitcnt lgkmcnt(0)
  s_cbranch_scc1 L_top_f1
  s_barrier
  v_mfma_f32_16x16x32_bf16 v[108:111], v[80:83], v[36:39], v[108:111]
  ds_read_b128 v[20:23], v13 offset:0
  v_mfma_f32_16x16x32_bf16 v[136:139], v[80:83], v[40:43], v[136:139]
  ds_read_b64_tr_b16 v[52:53], v17 offset:0
  v_mfma_f32_16x16x32_bf16 v[164:167], v[80:83], v[44:47], v[164:167]
  ds_read_b64_tr_b16 v[54:55], v17 offset:7168
  v_mfma_f32_16x16x32_bf16 v[192:195], v[80:83], v[48:51], v[192:195]
  v_mfma_f32_16x16x32_bf16 v[196:199], v[84:87], v[48:51], v[196:199]
  ds_read_b128 v[24:27], v13 offset:2048
  v_mfma_f32_16x16x32_bf16 v[168:171], v[84:87], v[44:47], v[168:171]
  ds_read_b128 v[28:31], v13 offset:4096
  v_mfma_f32_16x16x32_bf16 v[140:143], v[84:87], v[40:43], v[140:143]
  ds_read_b128 v[32:35], v13 offset:6144
  v_mfma_f32_16x16x32_bf16 v[112:115], v[84:87], v[36:39], v[112:115]
  v_mfma_f32_16x16x32_bf16 v[116:119], v[88:91], v[36:39], v[116:119]
  ds_read_b64_tr_b16 v[56:57], v18 offset:0
  v_mfma_f32_16x16x32_bf16 v[144:147], v[88:91], v[40:43], v[144:147]
  ds_read_b64_tr_b16 v[58:59], v18 offset:7168
  v_mfma_f32_16x16x32_bf16 v[172:175], v[88:91], v[44:47], v[172:175]
  v_mfma_f32_16x16x32_bf16 v[200:203], v[88:91], v[48:51], v[200:203]
  ds_read_b64_tr_b16 v[60:61], v17 offset:64
  v_mfma_f32_16x16x32_bf16 v[204:207], v[92:95], v[48:51], v[204:207]
  ds_read_b64_tr_b16 v[62:63], v17 offset:7232
  v_mfma_f32_16x16x32_bf16 v[176:179], v[92:95], v[44:47], v[176:179]
  ds_read_b64_tr_b16 v[64:65], v18 offset:64
  v_mfma_f32_16x16x32_bf16 v[148:151], v[92:95], v[40:43], v[148:151]
  v_mfma_f32_16x16x32_bf16 v[120:123], v[92:95], v[36:39], v[120:123]
  ds_read_b64_tr_b16 v[66:67], v18 offset:7232
  v_mfma_f32_16x16x32_bf16 v[124:127], v[96:99], v[36:39], v[124:127]
  ds_read_b64_tr_b16 v[68:69], v17 offset:128
  v_mfma_f32_16x16x32_bf16 v[152:155], v[96:99], v[40:43], v[152:155]
  v_mfma_f32_16x16x32_bf16 v[180:183], v[96:99], v[44:47], v[180:183]
  ds_read_b64_tr_b16 v[70:71], v17 offset:7296
  v_mfma_f32_16x16x32_bf16 v[208:211], v[96:99], v[48:51], v[208:211]
  ds_read_b64_tr_b16 v[72:73], v18 offset:128
  v_mfma_f32_16x16x32_bf16 v[212:215], v[100:103], v[48:51], v[212:215]
  ds_read_b64_tr_b16 v[74:75], v18 offset:7296
  v_mfma_f32_16x16x32_bf16 v[184:187], v[100:103], v[44:47], v[184:187]
  v_mfma_f32_16x16x32_bf16 v[156:159], v[100:103], v[40:43], v[156:159]
  ds_read_b64_tr_b16 v[76:77], v19 offset:0
  v_mfma_f32_16x16x32_bf16 v[128:131], v[100:103], v[36:39], v[128:131]
  ds_read_b64_tr_b16 v[78:79], v19 offset:7168
  v_mfma_f32_16x16x32_bf16 v[132:135], v[104:107], v[36:39], v[132:135]
  v_mfma_f32_16x16x32_bf16 v[160:163], v[104:107], v[40:43], v[160:163]
  v_mfma_f32_16x16x32_bf16 v[188:191], v[104:107], v[44:47], v[188:191]
  v_mfma_f32_16x16x32_bf16 v[216:219], v[104:107], v[48:51], v[216:219]
  s_waitcnt lgkmcnt(15)
  v_mfma_f32_16x16x32_bf16 v[108:111], v[52:55], v[20:23], v[108:111]
  ds_read_b128 v[36:39], v13 offset:1024
  s_waitcnt lgkmcnt(15)
  v_mfma_f32_16x16x32_bf16 v[136:139], v[52:55], v[24:27], v[136:139]
  ds_read_b64_tr_b16 v[80:81], v17 offset:14336
  s_waitcnt lgkmcnt(15)
  v_mfma_f32_16x16x32_bf16 v[164:167], v[52:55], v[28:31], v[164:167]
  ds_read_b64_tr_b16 v[82:83], v17 offset:21504
  s_waitcnt lgkmcnt(15)
  v_mfma_f32_16x16x32_bf16 v[192:195], v[52:55], v[32:35], v[192:195]
  s_waitcnt lgkmcnt(13)
  v_mfma_f32_16x16x32_bf16 v[196:199], v[56:59], v[32:35], v[196:199]
  ds_read_b128 v[40:43], v13 offset:3072
  v_mfma_f32_16x16x32_bf16 v[168:171], v[56:59], v[28:31], v[168:171]
  ds_read_b128 v[44:47], v13 offset:5120
  v_mfma_f32_16x16x32_bf16 v[140:143], v[56:59], v[24:27], v[140:143]
  ds_read_b128 v[48:51], v13 offset:7168
  v_mfma_f32_16x16x32_bf16 v[112:115], v[56:59], v[20:23], v[112:115]
  s_waitcnt lgkmcnt(14)
  v_mfma_f32_16x16x32_bf16 v[116:119], v[60:63], v[20:23], v[116:119]
  ds_read_b64_tr_b16 v[84:85], v18 offset:14336
  v_mfma_f32_16x16x32_bf16 v[144:147], v[60:63], v[24:27], v[144:147]
  ds_read_b64_tr_b16 v[86:87], v18 offset:21504
  v_mfma_f32_16x16x32_bf16 v[172:175], v[60:63], v[28:31], v[172:175]
  v_mfma_f32_16x16x32_bf16 v[200:203], v[60:63], v[32:35], v[200:203]
  ds_read_b64_tr_b16 v[88:89], v17 offset:14400
  s_waitcnt lgkmcnt(15)
  v_mfma_f32_16x16x32_bf16 v[204:207], v[64:67], v[32:35], v[204:207]
  ds_read_b64_tr_b16 v[90:91], v17 offset:21568
  v_mfma_f32_16x16x32_bf16 v[176:179], v[64:67], v[28:31], v[176:179]
  ds_read_b64_tr_b16 v[92:93], v18 offset:14400
  v_mfma_f32_16x16x32_bf16 v[148:151], v[64:67], v[24:27], v[148:151]
  v_mfma_f32_16x16x32_bf16 v[120:123], v[64:67], v[20:23], v[120:123]
  ds_read_b64_tr_b16 v[94:95], v18 offset:21568
  s_waitcnt lgkmcnt(15)
  v_mfma_f32_16x16x32_bf16 v[124:127], v[68:71], v[20:23], v[124:127]
  ds_read_b64_tr_b16 v[96:97], v17 offset:14464
  v_mfma_f32_16x16x32_bf16 v[152:155], v[68:71], v[24:27], v[152:155]
  v_mfma_f32_16x16x32_bf16 v[180:183], v[68:71], v[28:31], v[180:183]
  ds_read_b64_tr_b16 v[98:99], v17 offset:21632
  v_mfma_f32_16x16x32_bf16 v[208:211], v[68:71], v[32:35], v[208:211]
  ds_read_b64_tr_b16 v[100:101], v18 offset:14464
  s_waitcnt lgkmcnt(15)
  v_mfma_f32_16x16x32_bf16 v[212:215], v[72:75], v[32:35], v[212:215]
  ds_read_b64_tr_b16 v[102:103], v18 offset:21632
  v_mfma_f32_16x16x32_bf16 v[184:187], v[72:75], v[28:31], v[184:187]
  v_mfma_f32_16x16x32_bf16 v[156:159], v[72:75], v[24:27], v[156:159]
  ds_read_b64_tr_b16 v[104:105], v19 offset:14336
  v_mfma_f32_16x16x32_bf16 v[128:131], v[72:75], v[20:23], v[128:131]
  ds_read_b64_tr_b16 v[106:107], v19 offset:21504
  v_mfma_f32_16x16x32_bf16 v[132:135], v[76:79], v[20:23], v[132:135]
  v_mfma_f32_16x16x32_bf16 v[160:163], v[76:79], v[24:27], v[160:163]
  s_add_u32 s34, s34, 45056
  s_cmp_eq_u32 s34, 135168
  s_cselect_b32 s34, 0, s34
  v_add_u32 v13, s34, v12
  v_add_u32 v17, s34, v14
  v_mfma_f32_16x16x32_bf16 v[188:191], v[76:79], v[28:31], v[188:191]
  v_add_u32 v18, s34, v15
  v_add_u32 v19, s34, v16
  v_mfma_f32_16x16x32_bf16 v[216:219], v[76:79], v[32:35], v[216:219]
  s_waitcnt lgkmcnt(0)
  s_barrier
  v_mfma_f32_16x16x32_bf16 v[108:111], v[80:83], v[36:39], v[108:111]
  s_lshl_b32 s69, s42, 6
  v_and_b32 v24, 15, v1
  v_mfma_f32_16x16x32_bf16 v[136:139], v[80:83], v[40:43], v[136:139]
  v_add_u32 v24, s69, v24
  v_mfma_f32_16x16x32_bf16 v[164:167], v[80:83], v[44:47], v[164:167]
  v_lshlrev_b32 v24, 2, v24
  v_mfma_f32_16x16x32_bf16 v[192:195], v[80:83], v[48:51], v[192:195]
  v_add_u32 v24, 0x27800, v24
  v_mfma_f32_16x16x32_bf16 v[196:199], v[84:87], v[48:51], v[196:199]
  ds_read_b32 v20, v24 offset:0
  ds_read_b32 v21, v24 offset:64
  v_mfma_f32_16x16x32_bf16 v[168:171], v[84:87], v[44:47], v[168:171]
  ds_read_b32 v22, v24 offset:128
  v_mfma_f32_16x16x32_bf16 v[140:143], v[84:87], v[40:43], v[140:143]
  ds_read_b32 v23, v24 offset:192
  v_mfma_f32_16x16x32_bf16 v[112:115], v[84:87], v[36:39], v[112:115]
  s_lshl_b32 s69, s43, 9
  v_mfma_f32_16x16x32_bf16 v[116:119], v[88:91], v[36:39], v[116:119]
  v_lshrrev_b32 v25, 4, v1
  v_lshlrev_b32 v25, 4, v25
  v_mfma_f32_16x16x32_bf16 v[144:147], v[88:91], v[40:43], v[144:147]
  v_add_u32 v25, s69, v25
  v_mfma_f32_16x16x32_bf16 v[172:175], v[88:91], v[44:47], v[172:175]
  v_add_u32 v25, 0x27c00, v25
  v_mfma_f32_16x16x32_bf16 v[200:203], v[88:91], v[48:51], v[200:203]
  s_lshl_b32 s69, s43, 6
  v_mfma_f32_16x16x32_bf16 v[204:207], v[92:95], v[48:51], v[204:207]
  v_lshrrev_b32 v26, 4, v1
  v_mfma_f32_16x16x32_bf16 v[176:179], v[92:95], v[44:47], v[176:179]
  v_lshlrev_b32 v26, 4, v26
  v_add_u32 v26, s69, v26
  v_mfma_f32_16x16x32_bf16 v[148:151], v[92:95], v[40:43], v[148:151]
  v_add_u32 v26, 0x27c00, v26
  v_mfma_f32_16x16x32_bf16 v[120:123], v[92:95], v[36:39], v[120:123]
  v_add_u32 v26, 0x180, v26
  v_mfma_f32_16x16x32_bf16 v[124:127], v[96:99], v[36:39], v[124:127]
  ds_read_b128 v[52:55], v25 offset:0
  v_mfma_f32_16x16x32_bf16 v[152:155], v[96:99], v[40:43], v[152:155]
  ds_read_b128 v[56:59], v25 offset:64
  ds_read_b128 v[60:63], v25 offset:128
  v_mfma_f32_16x16x32_bf16 v[180:183], v[96:99], v[44:47], v[180:183]
  ds_read_b128 v[64:67], v25 offset:192
  v_mfma_f32_16x16x32_bf16 v[208:211], v[96:99], v[48:51], v[208:211]
  ds_read_b128 v[68:71], v25 offset:256
  v_mfma_f32_16x16x32_bf16 v[212:215], v[100:103], v[48:51], v[212:215]
  ds_read_b128 v[72:75], v25 offset:320
  v_mfma_f32_16x16x32_bf16 v[184:187], v[100:103], v[44:47], v[184:187]
  ds_read_b128 v[76:79], v26
  s_mul_i32 s71, s28, 917504
  v_mfma_f32_16x16x32_bf16 v[156:159], v[100:103], v[40:43], v[156:159]
  s_lshl_b32 s31, s42, 13
  v_mfma_f32_16x16x32_bf16 v[128:131], v[100:103], v[36:39], v[128:131]
  s_add_u32 s71, s71, s31
  v_mfma_f32_16x16x32_bf16 v[132:135], v[104:107], v[36:39], v[132:135]
  s_add_u32 s71, s71, 20971520
  v_mfma_f32_16x16x32_bf16 v[160:163], v[104:107], v[40:43], v[160:163]
  s_mul_i32 s41, s29, 7
  v_mfma_f32_16x16x32_bf16 v[188:191], v[104:107], v[44:47], v[188:191]
  v_mfma_f32_16x16x32_bf16 v[216:219], v[104:107], v[48:51], v[216:219]
  s_setprio 3
  s_nop 6
  s_waitcnt lgkmcnt(5)
  s_lshl_b32 s39, s43, 2
  s_add_u32 s39, s39, 0
  s_and_b32 s40, s29, 1
  s_sub_i32 s39, s39, s40
  s_and_b32 s40, s39, 1
  s_lshl_b32 s40, s40, 10
  s_ashr_i32 s39, s39, 1
  s_and_b32 s39, s39, 3
  s_lshl_b32 s39, s39, 15
  s_add_u32 s39, s39, s40
  s_lshl_b32 s40, s42, 13
  s_add_u32 s39, s39, s40
  v_add_u32 v45, s39, v10
  s_lshl_b32 s31, s43, 2
  s_add_u32 s31, s31, s41
  s_add_u32 s31, s31, 0
  s_lshr_b32 s39, s31, 1
  s_lshl_b32 s39, s39, 14
  s_and_b32 s31, s31, 1
  s_lshl_b32 s31, s31, 10
  s_add_u32 s31, s31, s39
  s_add_u32 s31, s31, s71
  v_pk_fma_f32 v[108:109], v[20:21], v[52:53], v[108:109] op_sel:[0,0,0] op_sel_hi:[0,1,1] neg_lo:[1,0,0] neg_hi:[1,0,0]
  v_pk_fma_f32 v[110:111], v[20:21], v[54:55], v[110:111] op_sel:[0,0,0] op_sel_hi:[0,1,1] neg_lo:[1,0,0] neg_hi:[1,0,0]
  v_pk_fma_f32 v[112:113], v[20:21], v[56:57], v[112:113] op_sel:[0,0,0] op_sel_hi:[0,1,1] neg_lo:[1,0,0] neg_hi:[1,0,0]
  v_pk_fma_f32 v[114:115], v[20:21], v[58:59], v[114:115] op_sel:[0,0,0] op_sel_hi:[0,1,1] neg_lo:[1,0,0] neg_hi:[1,0,0]
  v_cvt_pk_bf16_f32 v36, v108, v109
  v_cvt_pk_bf16_f32 v37, v110, v111
  v_cvt_pk_bf16_f32 v38, v112, v113
  v_cvt_pk_bf16_f32 v39, v114, v115
  v_pk_max_i16 v36, v36, 0
  v_pk_max_i16 v37, v37, 0
  v_pk_max_i16 v38, v38, 0
  v_pk_max_i16 v39, v39, 0
  buffer_store_dwordx4 v[36:39], v10, s[12:15], s31 offen offset:0 sc1
  ds_write_b128 v45, v[36:39] offset:0
  v_pk_fma_f32 v[136:137], v[20:21], v[52:53], v[136:137] op_sel:[1,0,0] op_sel_hi:[1,1,1] neg_lo:[1,0,0] neg_hi:[1,0,0]
  v_pk_fma_f32 v[138:139], v[20:21], v[54:55], v[138:139] op_sel:[1,0,0] op_sel_hi:[1,1,1] neg_lo:[1,0,0] neg_hi:[1,0,0]
  v_pk_fma_f32 v[140:141], v[20:21], v[56:57], v[140:141] op_sel:[1,0,0] op_sel_hi:[1,1,1] neg_lo:[1,0,0] neg_hi:[1,0,0]
  v_pk_fma_f32 v[142:143], v[20:21], v[58:59], v[142:143] op_sel:[1,0,0] op_sel_hi:[1,1,1] neg_lo:[1,0,0] neg_hi:[1,0,0]
  v_cvt_pk_bf16_f32 v40, v136, v137
  v_cvt_pk_bf16_f32 v41, v138, v139
  v_cvt_pk_bf16_f32 v42, v140, v141
  v_cvt_pk_bf16_f32 v43, v142, v143
  v_pk_max_i16 v40, v40, 0
  v_pk_max_i16 v41, v41, 0
  v_pk_max_i16 v42, v42, 0
  v_pk_max_i16 v43, v43, 0
  buffer_store_dwordx4 v[40:43], v10, s[12:15], s31 offen offset:2048 sc1
  ds_write_b128 v45, v[40:43] offset:2048
  v_pk_fma_f32 v[164:165], v[22:23], v[52:53], v[164:165] op_sel:[0,0,0] op_sel_hi:[0,1,1] neg_lo:[1,0,0] neg_hi:[1,0,0]
  v_pk_fma_f32 v[166:167], v[22:23], v[54:55], v[166:167] op_sel:[0,0,0] op_sel_hi:[0,1,1] neg_lo:[1,0,0] neg_hi:[1,0,0]
  v_pk_fma_f32 v[168:169], v[22:23], v[56:57], v[168:169] op_sel:[0,0,0] op_sel_hi:[0,1,1] neg_lo:[1,0,0] neg_hi:[1,0,0]
  v_pk_fma_f32 v[170:171], v[22:23], v[58:59], v[170:171] op_sel:[0,0,0] op_sel_hi:[0,1,1] neg_lo:[1,0,0] neg_hi:[1,0,0]
  v_cvt_pk_bf16_f32 v36, v164, v165
  v_cvt_pk_bf16_f32 v37, v166, v167
  v_cvt_pk_bf16_f32 v38, v168, v169
  v_cvt_pk_bf16_f32 v39, v170, v171
  v_pk_max_i16 v36, v36, 0
  v_pk_max_i16 v37, v37, 0
  v_pk_max_i16 v38, v38, 0
  v_pk_max_i16 v39, v39, 0
  s_add_u32 s31, s31, 4096
  buffer_store_dwordx4 v[36:39], v10, s[12:15], s31 offen offset:0 sc1
  ds_write_b128 v45, v[36:39] offset:4096
  v_pk_fma_f32 v[192:193], v[22:23], v[52:53], v[192:193] op_sel:[1,0,0] op_sel_hi:[1,1,1] neg_lo:[1,0,0] neg_hi:[1,0,0]
  v_pk_fma_f32 v[194:195], v[22:23], v[54:55], v[194:195] op_sel:[1,0,0] op_sel_hi:[1,1,1] neg_lo:[1,0,0] neg_hi:[1,0,0]
  v_pk_fma_f32 v[196:197], v[22:23], v[56:57], v[196:197] op_sel:[1,0,0] op_sel_hi:[1,1,1] neg_lo:[1,0,0] neg_hi:[1,0,0]
  v_pk_fma_f32 v[198:199], v[22:23], v[58:59], v[198:199] op_sel:[1,0,0] op_sel_hi:[1,1,1] neg_lo:[1,0,0] neg_hi:[1,0,0]
  v_cvt_pk_bf16_f32 v40, v192, v193
  v_cvt_pk_bf16_f32 v41, v194, v195
  v_cvt_pk_bf16_f32 v42, v196, v197
  v_cvt_pk_bf16_f32 v43, v198, v199
  v_pk_max_i16 v40, v40, 0
  v_pk_max_i16 v41, v41, 0
  v_pk_max_i16 v42, v42, 0
  v_pk_max_i16 v43, v43, 0
  buffer_store_dwordx4 v[40:43], v10, s[12:15], s31 offen offset:2048 sc1
  ds_write_b128 v45, v[40:43] offset:6144
  s_waitcnt lgkmcnt(7)
  s_lshl_b32 s39, s43, 2
  s_add_u32 s39, s39, 1
  s_and_b32 s40, s29, 1
  s_sub_i32 s39, s39, s40
  s_and_b32 s40, s39, 1
  s_lshl_b32 s40, s40, 10
  s_ashr_i32 s39, s39, 1
  s_and_b32 s39, s39, 3
  s_lshl_b32 s39, s39, 15
  s_add_u32 s39, s39, s40
  s_lshl_b32 s40, s42, 13
  s_add_u32 s39, s39, s40
  v_add_u32 v45, s39, v10
  s_lshl_b32 s31, s43, 2
  s_add_u32 s31, s31, s41
  s_add_u32 s31, s31, 1
  s_lshr_b32 s39, s31, 1
  s_lshl_b32 s39, s39, 14
  s_and_b32 s31, s31, 1
  s_lshl_b32 s31, s31, 10
  s_add_u32 s31, s31, s39
  s_add_u32 s31, s31, s71
  v_pk_fma_f32 v[116:117], v[20:21], v[60:61], v[116:117] op_sel:[0,0,0] op_sel_hi:[0,1,1] neg_lo:[1,0,0] neg_hi:[1,0,0]
  v_pk_fma_f32 v[118:119], v[20:21], v[62:63], v[118:119] op_sel:[0,0,0] op_sel_hi:[0,1,1] neg_lo:[1,0,0] neg_hi:[1,0,0]
  v_pk_fma_f32 v[120:121], v[20:21], v[64:65], v[120:121] op_sel:[0,0,0] op_sel_hi:[0,1,1] neg_lo:[1,0,0] neg_hi:[1,0,0]
  v_pk_fma_f32 v[122:123], v[20:21], v[66:67], v[122:123] op_sel:[0,0,0] op_sel_hi:[0,1,1] neg_lo:[1,0,0] neg_hi:[1,0,0]
  v_cvt_pk_bf16_f32 v36, v116, v117
  v_cvt_pk_bf16_f32 v37, v118, v119
  v_cvt_pk_bf16_f32 v38, v120, v121
  v_cvt_pk_bf16_f32 v39, v122, v123
  v_pk_max_i16 v36, v36, 0
  v_pk_max_i16 v37, v37, 0
  v_pk_max_i16 v38, v38, 0
  v_pk_max_i16 v39, v39, 0
  buffer_store_dwordx4 v[36:39], v10, s[12:15], s31 offen offset:0 sc1
  ds_write_b128 v45, v[36:39] offset:0
  v_pk_fma_f32 v[144:145], v[20:21], v[60:61], v[144:145] op_sel:[1,0,0] op_sel_hi:[1,1,1] neg_lo:[1,0,0] neg_hi:[1,0,0]
  v_pk_fma_f32 v[146:147], v[20:21], v[62:63], v[146:147] op_sel:[1,0,0] op_sel_hi:[1,1,1] neg_lo:[1,0,0] neg_hi:[1,0,0]
  v_pk_fma_f32 v[148:149], v[20:21], v[64:65], v[148:149] op_sel:[1,0,0] op_sel_hi:[1,1,1] neg_lo:[1,0,0] neg_hi:[1,0,0]
  v_pk_fma_f32 v[150:151], v[20:21], v[66:67], v[150:151] op_sel:[1,0,0] op_sel_hi:[1,1,1] neg_lo:[1,0,0] neg_hi:[1,0,0]
  v_cvt_pk_bf16_f32 v40, v144, v145
  v_cvt_pk_bf16_f32 v41, v146, v147
  v_cvt_pk_bf16_f32 v42, v148, v149
  v_cvt_pk_bf16_f32 v43, v150, v151
  v_pk_max_i16 v40, v40, 0
  v_pk_max_i16 v41, v41, 0
  v_pk_max_i16 v42, v42, 0
  v_pk_max_i16 v43, v43, 0
  buffer_store_dwordx4 v[40:43], v10, s[12:15], s31 offen offset:2048 sc1
  ds_write_b128 v45, v[40:43] offset:2048
  v_pk_fma_f32 v[172:173], v[22:23], v[60:61], v[172:173] op_sel:[0,0,0] op_sel_hi:[0,1,1] neg_lo:[1,0,0] neg_hi:[1,0,0]
  v_pk_fma_f32 v[174:175], v[22:23], v[62:63], v[174:175] op_sel:[0,0,0] op_sel_hi:[0,1,1] neg_lo:[1,0,0] neg_hi:[1,0,0]
  v_pk_fma_f32 v[176:177], v[22:23], v[64:65], v[176:177] op_sel:[0,0,0] op_sel_hi:[0,1,1] neg_lo:[1,0,0] neg_hi:[1,0,0]
  v_pk_fma_f32 v[178:179], v[22:23], v[66:67], v[178:179] op_sel:[0,0,0] op_sel_hi:[0,1,1] neg_lo:[1,0,0] neg_hi:[1,0,0]
  v_cvt_pk_bf16_f32 v36, v172, v173
  v_cvt_pk_bf16_f32 v37, v174, v175
  v_cvt_pk_bf16_f32 v38, v176, v177
  v_cvt_pk_bf16_f32 v39, v178, v179
  v_pk_max_i16 v36, v36, 0
  v_pk_max_i16 v37, v37, 0
  v_pk_max_i16 v38, v38, 0
  v_pk_max_i16 v39, v39, 0
  s_add_u32 s31, s31, 4096
  buffer_store_dwordx4 v[36:39], v10, s[12:15], s31 offen offset:0 sc1
  ds_write_b128 v45, v[36:39] offset:4096
  v_pk_fma_f32 v[200:201], v[22:23], v[60:61], v[200:201] op_sel:[1,0,0] op_sel_hi:[1,1,1] neg_lo:[1,0,0] neg_hi:[1,0,0]
  v_pk_fma_f32 v[202:203], v[22:23], v[62:63], v[202:203] op_sel:[1,0,0] op_sel_hi:[1,1,1] neg_lo:[1,0,0] neg_hi:[1,0,0]
  v_pk_fma_f32 v[204:205], v[22:23], v[64:65], v[204:205] op_sel:[1,0,0] op_sel_hi:[1,1,1] neg_lo:[1,0,0] neg_hi:[1,0,0]
  v_pk_fma_f32 v[206:207], v[22:23], v[66:67], v[206:207] op_sel:[1,0,0] op_sel_hi:[1,1,1] neg_lo:[1,0,0] neg_hi:[1,0,0]
  v_cvt_pk_bf16_f32 v40, v200, v201
  v_cvt_pk_bf16_f32 v41, v202, v203
  v_cvt_pk_bf16_f32 v42, v204, v205
  v_cvt_pk_bf16_f32 v43, v206, v207
  v_pk_max_i16 v40, v40, 0
  v_pk_max_i16 v41, v41, 0
  v_pk_max_i16 v42, v42, 0
  v_pk_max_i16 v43, v43, 0
  buffer_store_dwordx4 v[40:43], v10, s[12:15], s31 offen offset:2048 sc1
  ds_write_b128 v45, v[40:43] offset:6144
  s_waitcnt lgkmcnt(9)
  s_lshl_b32 s39, s43, 2
  s_add_u32 s39, s39, 2
  s_and_b32 s40, s29, 1
  s_sub_i32 s39, s39, s40
  s_and_b32 s40, s39, 1
  s_lshl_b32 s40, s40, 10
  s_ashr_i32 s39, s39, 1
  s_and_b32 s39, s39, 3
  s_lshl_b32 s39, s39, 15
  s_add_u32 s39, s39, s40
  s_lshl_b32 s40, s42, 13
  s_add_u32 s39, s39, s40
  v_add_u32 v45, s39, v10
  s_lshl_b32 s31, s43, 2
  s_add_u32 s31, s31, s41
  s_add_u32 s31, s31, 2
  s_lshr_b32 s39, s31, 1
  s_lshl_b32 s39, s39, 14
  s_and_b32 s31, s31, 1
  s_lshl_b32 s31, s31, 10
  s_add_u32 s31, s31, s39
  s_add_u32 s31, s31, s71
  v_pk_fma_f32 v[124:125], v[20:21], v[68:69], v[124:125] op_sel:[0,0,0] op_sel_hi:[0,1,1] neg_lo:[1,0,0] neg_hi:[1,0,0]
  v_pk_fma_f32 v[126:127], v[20:21], v[70:71], v[126:127] op_sel:[0,0,0] op_sel_hi:[0,1,1] neg_lo:[1,0,0] neg_hi:[1,0,0]
  v_pk_fma_f32 v[128:129], v[20:21], v[72:73], v[128:129] op_sel:[0,0,0] op_sel_hi:[0,1,1] neg_lo:[1,0,0] neg_hi:[1,0,0]
  v_pk_fma_f32 v[130:131], v[20:21], v[74:75], v[130:131] op_sel:[0,0,0] op_sel_hi:[0,1,1] neg_lo:[1,0,0] neg_hi:[1,0,0]
  v_cvt_pk_bf16_f32 v36, v124, v125
  v_cvt_pk_bf16_f32 v37, v126, v127
  v_cvt_pk_bf16_f32 v38, v128, v129
  v_cvt_pk_bf16_f32 v39, v130, v131
  v_pk_max_i16 v36, v36, 0
  v_pk_max_i16 v37, v37, 0
  v_pk_max_i16 v38, v38, 0
  v_pk_max_i16 v39, v39, 0
  buffer_store_dwordx4 v[36:39], v10, s[12:15], s31 offen offset:0 sc1
  ds_write_b128 v45, v[36:39] offset:0
  v_pk_fma_f32 v[152:153], v[20:21], v[68:69], v[152:153] op_sel:[1,0,0] op_sel_hi:[1,1,1] neg_lo:[1,0,0] neg_hi:[1,0,0]
  v_pk_fma_f32 v[154:155], v[20:21], v[70:71], v[154:155] op_sel:[1,0,0] op_sel_hi:[1,1,1] neg_lo:[1,0,0] neg_hi:[1,0,0]
  v_pk_fma_f32 v[156:157], v[20:21], v[72:73], v[156:157] op_sel:[1,0,0] op_sel_hi:[1,1,1] neg_lo:[1,0,0] neg_hi:[1,0,0]
  v_pk_fma_f32 v[158:159], v[20:21], v[74:75], v[158:159] op_sel:[1,0,0] op_sel_hi:[1,1,1] neg_lo:[1,0,0] neg_hi:[1,0,0]
  v_cvt_pk_bf16_f32 v40, v152, v153
  v_cvt_pk_bf16_f32 v41, v154, v155
  v_cvt_pk_bf16_f32 v42, v156, v157
  v_cvt_pk_bf16_f32 v43, v158, v159
  v_pk_max_i16 v40, v40, 0
  v_pk_max_i16 v41, v41, 0
  v_pk_max_i16 v42, v42, 0
  v_pk_max_i16 v43, v43, 0
  buffer_store_dwordx4 v[40:43], v10, s[12:15], s31 offen offset:2048 sc1
  ds_write_b128 v45, v[40:43] offset:2048
  v_pk_fma_f32 v[180:181], v[22:23], v[68:69], v[180:181] op_sel:[0,0,0] op_sel_hi:[0,1,1] neg_lo:[1,0,0] neg_hi:[1,0,0]
  v_pk_fma_f32 v[182:183], v[22:23], v[70:71], v[182:183] op_sel:[0,0,0] op_sel_hi:[0,1,1] neg_lo:[1,0,0] neg_hi:[1,0,0]
  v_pk_fma_f32 v[184:185], v[22:23], v[72:73], v[184:185] op_sel:[0,0,0] op_sel_hi:[0,1,1] neg_lo:[1,0,0] neg_hi:[1,0,0]
  v_pk_fma_f32 v[186:187], v[22:23], v[74:75], v[186:187] op_sel:[0,0,0] op_sel_hi:[0,1,1] neg_lo:[1,0,0] neg_hi:[1,0,0]
  v_cvt_pk_bf16_f32 v36, v180, v181
  v_cvt_pk_bf16_f32 v37, v182, v183
  v_cvt_pk_bf16_f32 v38, v184, v185
  v_cvt_pk_bf16_f32 v39, v186, v187
  v_pk_max_i16 v36, v36, 0
  v_pk_max_i16 v37, v37, 0
  v_pk_max_i16 v38, v38, 0
  v_pk_max_i16 v39, v39, 0
  s_add_u32 s31, s31, 4096
  buffer_store_dwordx4 v[36:39], v10, s[12:15], s31 offen offset:0 sc1
  ds_write_b128 v45, v[36:39] offset:4096
  v_pk_fma_f32 v[208:209], v[22:23], v[68:69], v[208:209] op_sel:[1,0,0] op_sel_hi:[1,1,1] neg_lo:[1,0,0] neg_hi:[1,0,0]
  v_pk_fma_f32 v[210:211], v[22:23], v[70:71], v[210:211] op_sel:[1,0,0] op_sel_hi:[1,1,1] neg_lo:[1,0,0] neg_hi:[1,0,0]
  v_pk_fma_f32 v[212:213], v[22:23], v[72:73], v[212:213] op_sel:[1,0,0] op_sel_hi:[1,1,1] neg_lo:[1,0,0] neg_hi:[1,0,0]
  v_pk_fma_f32 v[214:215], v[22:23], v[74:75], v[214:215] op_sel:[1,0,0] op_sel_hi:[1,1,1] neg_lo:[1,0,0] neg_hi:[1,0,0]
  v_cvt_pk_bf16_f32 v40, v208, v209
  v_cvt_pk_bf16_f32 v41, v210, v211
  v_cvt_pk_bf16_f32 v42, v212, v213
  v_cvt_pk_bf16_f32 v43, v214, v215
  v_pk_max_i16 v40, v40, 0
  v_pk_max_i16 v41, v41, 0
  v_pk_max_i16 v42, v42, 0
  v_pk_max_i16 v43, v43, 0
  buffer_store_dwordx4 v[40:43], v10, s[12:15], s31 offen offset:2048 sc1
  ds_write_b128 v45, v[40:43] offset:6144
  s_waitcnt lgkmcnt(12)
  s_add_u32 s31, s41, 3
  s_lshr_b32 s39, s31, 1
  s_lshl_b32 s39, s39, 14
  s_and_b32 s31, s31, 1
  s_lshl_b32 s31, s31, 10
  s_add_u32 s31, s31, s39
  s_add_u32 s31, s31, s71
  s_lshl_b32 s69, s43, 3
  v_lshlrev_b32 v44, 4, v1
  v_add_u32 v44, s69, v44
  s_mov_b32 s39, 3
  s_and_b32 s40, s29, 1
  s_sub_i32 s39, s39, s40
  s_and_b32 s40, s39, 1
  s_lshl_b32 s40, s40, 10
  s_ashr_i32 s39, s39, 1
  s_and_b32 s39, s39, 3
  s_lshl_b32 s39, s39, 15
  s_add_u32 s39, s39, s40
  s_lshl_b32 s40, s42, 13
  s_add_u32 s39, s39, s40
  v_add_u32 v45, s39, v10
  s_lshl_b32 s40, s43, 3
  v_add_u32 v45, s40, v45
  v_pk_fma_f32 v[132:133], v[20:21], v[76:77], v[132:133] op_sel:[0,0,0] op_sel_hi:[0,1,1] neg_lo:[1,0,0] neg_hi:[1,0,0]
  v_pk_fma_f32 v[134:135], v[20:21], v[78:79], v[134:135] op_sel:[0,0,0] op_sel_hi:[0,1,1] neg_lo:[1,0,0] neg_hi:[1,0,0]
  v_cvt_pk_bf16_f32 v36, v132, v133
  v_cvt_pk_bf16_f32 v37, v134, v135
  v_pk_max_i16 v36, v36, 0
  v_pk_max_i16 v37, v37, 0
  buffer_store_dwordx2 v[36:37], v44, s[12:15], s31 offen offset:0 sc1
  ds_write_b64 v45, v[36:37] offset:0
  v_pk_fma_f32 v[160:161], v[20:21], v[76:77], v[160:161] op_sel:[1,0,0] op_sel_hi:[1,1,1] neg_lo:[1,0,0] neg_hi:[1,0,0]
  v_pk_fma_f32 v[162:163], v[20:21], v[78:79], v[162:163] op_sel:[1,0,0] op_sel_hi:[1,1,1] neg_lo:[1,0,0] neg_hi:[1,0,0]
  v_cvt_pk_bf16_f32 v40, v160, v161
  v_cvt_pk_bf16_f32 v41, v162, v163
  v_pk_max_i16 v40, v40, 0
  v_pk_max_i16 v41, v41, 0
  buffer_store_dwordx2 v[40:41], v44, s[12:15], s31 offen offset:2048 sc1
  ds_write_b64 v45, v[40:41] offset:2048
  v_pk_fma_f32 v[188:189], v[22:23], v[76:77], v[188:189] op_sel:[0,0,0] op_sel_hi:[0,1,1] neg_lo:[1,0,0] neg_hi:[1,0,0]
  v_pk_fma_f32 v[190:191], v[22:23], v[78:79], v[190:191] op_sel:[0,0,0] op_sel_hi:[0,1,1] neg_lo:[1,0,0] neg_hi:[1,0,0]
  v_cvt_pk_bf16_f32 v36, v188, v189
  v_cvt_pk_bf16_f32 v37, v190, v191
  v_pk_max_i16 v36, v36, 0
  v_pk_max_i16 v37, v37, 0
  s_add_u32 s31, s31, 4096
  buffer_store_dwordx2 v[36:37], v44, s[12:15], s31 offen offset:0 sc1
  ds_write_b64 v45, v[36:37] offset:4096
  v_pk_fma_f32 v[216:217], v[22:23], v[76:77], v[216:217] op_sel:[1,0,0] op_sel_hi:[1,1,1] neg_lo:[1,0,0] neg_hi:[1,0,0]
  v_pk_fma_f32 v[218:219], v[22:23], v[78:79], v[218:219] op_sel:[1,0,0] op_sel_hi:[1,1,1] neg_lo:[1,0,0] neg_hi:[1,0,0]
  v_cvt_pk_bf16_f32 v40, v216, v217
  v_cvt_pk_bf16_f32 v41, v218, v219
  v_pk_max_i16 v40, v40, 0
  v_pk_max_i16 v41, v41, 0
  buffer_store_dwordx2 v[40:41], v44, s[12:15], s31 offen offset:2048 sc1
  ds_write_b64 v45, v[40:41] offset:6144
  s_lshr_b32 s3, s29, 3
  s_lshl_b32 s67, s42, 2
  s_lshl_b32 s68, s67, 1
  s_lshl_b32 s69, s68, 10
  v_lshlrev_b32 v12, 4, v1
  v_add_u32 v12, s69, v12
  v_lshrrev_b32 v14, 4, v1
  v_lshlrev_b32 v14, 2, v14
  v_lshrrev_b32 v7, 2, v1
  v_and_b32 v7, 3, v7
  v_add_u32 v14, v14, v7
  v_lshlrev_b32 v14, 8, v14
  s_lshl_b32 s67, s43, 6
  s_lshl_b32 s66, s3, 5
  s_add_u32 s68, s67, s66
  s_lshr_b32 s69, s68, 3
  v_lshrrev_b32 v7, 1, v1
  v_and_b32 v7, 1, v7
  v_add_u32 v7, s69, v7
  v_lshrrev_b32 v6, 4, v1
  v_lshlrev_b32 v6, 2, v6
  v_lshrrev_b32 v5, 2, v1
  v_and_b32 v5, 3, v5
  v_add_u32 v6, v6, v5
  v_and_b32 v6, 7, v6
  v_lshlrev_b32 v6, 1, v6
  v_xor_b32 v7, v7, v6
  v_lshlrev_b32 v7, 4, v7
  v_add_u32 v14, v14, v7
  v_and_b32 v7, 1, v1
  v_lshlrev_b32 v7, 3, v7
  v_add_u32 v14, v14, v7
  v_add_u32 v14, 0x4000, v14
  v_lshrrev_b32 v15, 4, v1
  v_lshlrev_b32 v15, 2, v15
  v_lshrrev_b32 v7, 2, v1
  v_and_b32 v7, 3, v7
  v_add_u32 v15, v15, v7
  v_lshlrev_b32 v15, 8, v15
  s_lshl_b32 s67, s43, 6
  s_lshl_b32 s65, s3, 5
  s_add_u32 s66, s67, s65
  s_add_u32 s68, s66, 16
  s_lshr_b32 s69, s68, 3
  v_lshrrev_b32 v7, 1, v1
  v_and_b32 v7, 1, v7
  v_add_u32 v7, s69, v7
  v_lshrrev_b32 v6, 4, v1
  v_lshlrev_b32 v6, 2, v6
  v_lshrrev_b32 v5, 2, v1
  v_and_b32 v5, 3, v5
  v_add_u32 v6, v6, v5
  v_and_b32 v6, 7, v6
  v_lshlrev_b32 v6, 1, v6
  v_xor_b32 v7, v7, v6
  v_lshlrev_b32 v7, 4, v7
  v_add_u32 v15, v15, v7
  v_and_b32 v7, 1, v1
  v_lshlrev_b32 v7, 3, v7
  v_add_u32 v15, v15, v7
  v_add_u32 v15, 0x4000, v15
  v_lshrrev_b32 v16, 4, v1
  v_lshlrev_b32 v16, 2, v16
  v_lshrrev_b32 v7, 2, v1
  v_and_b32 v7, 3, v7
  v_add_u32 v16, v16, v7
  v_lshlrev_b32 v16, 8, v16
  s_lshl_b32 s66, s43, 6
  s_xor_b32 s67, s3, 1
  s_lshl_b32 s65, s67, 5
  s_add_u32 s68, s66, s65
  s_lshr_b32 s69, s68, 3
  v_lshrrev_b32 v7, 1, v1
  v_and_b32 v7, 1, v7
  v_add_u32 v7, s69, v7
  v_lshrrev_b32 v6, 4, v1
  v_lshlrev_b32 v6, 2, v6
  v_lshrrev_b32 v5, 2, v1
  v_and_b32 v5, 3, v5
  v_add_u32 v6, v6, v5
  v_and_b32 v6, 7, v6
  v_lshlrev_b32 v6, 1, v6
  v_xor_b32 v7, v7, v6
  v_lshlrev_b32 v7, 4, v7
  v_add_u32 v16, v16, v7
  v_and_b32 v7, 1, v1
  v_lshlrev_b32 v7, 3, v7
  v_add_u32 v16, v16, v7
  v_add_u32 v16, 0x4000, v16
  v_lshrrev_b32 v17, 4, v1
  v_lshlrev_b32 v17, 2, v17
  v_lshrrev_b32 v7, 2, v1
  v_and_b32 v7, 3, v7
  v_add_u32 v17, v17, v7
  v_lshlrev_b32 v17, 8, v17
  s_lshl_b32 s66, s43, 6
  s_xor_b32 s64, s3, 1
  s_lshl_b32 s67, s64, 5
  s_add_u32 s65, s66, s67
  s_add_u32 s68, s65, 16
  s_lshr_b32 s69, s68, 3
  v_lshrrev_b32 v7, 1, v1
  v_and_b32 v7, 1, v7
  v_add_u32 v7, s69, v7
  v_lshrrev_b32 v6, 4, v1
  v_lshlrev_b32 v6, 2, v6
  v_lshrrev_b32 v5, 2, v1
  v_and_b32 v5, 3, v5
  v_add_u32 v6, v6, v5
  v_and_b32 v6, 7, v6
  v_lshlrev_b32 v6, 1, v6
  v_xor_b32 v7, v7, v6
  v_lshlrev_b32 v7, 4, v7
  v_add_u32 v17, v17, v7
  v_and_b32 v7, 1, v1
  v_lshlrev_b32 v7, 3, v7
  v_add_u32 v17, v17, v7
  v_add_u32 v17, 0x4000, v17
  s_mov_b32 s34, 0
  v_add_u32 v13, s34, v12
  v_add_u32 v18, s34, v14
  v_add_u32 v19, s34, v15
  v_add_u32 v20, s34, v16
  v_add_u32 v21, s34, v17
  s_waitcnt lgkmcnt(0)
  s_setprio 0
  s_barrier
  ds_read_b128 v[24:27], v13 offset:0
  ds_read_b64_tr_b16 v[56:57], v18 offset:0
  ds_read_b64_tr_b16 v[58:59], v18 offset:4096
  ds_read_b128 v[28:31], v13 offset:2048
  ds_read_b128 v[32:35], v13 offset:4096
  ds_read_b128 v[36:39], v13 offset:6144
  ds_read_b64_tr_b16 v[60:61], v19 offset:0
  ds_read_b64_tr_b16 v[62:63], v19 offset:4096
  ds_read_b64_tr_b16 v[64:65], v20 offset:0
  ds_read_b64_tr_b16 v[66:67], v20 offset:4096
  ds_read_b64_tr_b16 v[68:69], v21 offset:0
  ds_read_b64_tr_b16 v[70:71], v21 offset:4096
  s_waitcnt lgkmcnt(9)
  v_mfma_f32_16x16x32_bf16 v[88:91], v[56:59], v[24:27], 0
  ds_read_b128 v[40:43], v13 offset:1024
  s_waitcnt lgkmcnt(9)
  v_mfma_f32_16x16x32_bf16 v[104:107], v[56:59], v[28:31], 0
  ds_read_b64_tr_b16 v[72:73], v18 offset:8192
  s_waitcnt lgkmcnt(9)
  v_mfma_f32_16x16x32_bf16 v[120:123], v[56:59], v[32:35], 0
  ds_read_b64_tr_b16 v[74:75], v18 offset:12288
  s_waitcnt lgkmcnt(9)
  v_mfma_f32_16x16x32_bf16 v[136:139], v[56:59], v[36:39], 0
  ds_read_b128 v[44:47], v13 offset:3072
  s_waitcnt lgkmcnt(8)
  v_mfma_f32_16x16x32_bf16 v[140:143], v[60:63], v[36:39], 0
  ds_read_b128 v[48:51], v13 offset:5120
  v_mfma_f32_16x16x32_bf16 v[124:127], v[60:63], v[32:35], 0
  ds_read_b128 v[52:55], v13 offset:7168
  v_mfma_f32_16x16x32_bf16 v[108:111], v[60:63], v[28:31], 0
  ds_read_b64_tr_b16 v[76:77], v19 offset:8192
  v_mfma_f32_16x16x32_bf16 v[92:95], v[60:63], v[24:27], 0
  ds_read_b64_tr_b16 v[78:79], v19 offset:12288
  s_waitcnt lgkmcnt(10)
  v_mfma_f32_16x16x32_bf16 v[96:99], v[64:67], v[24:27], 0
  ds_read_b64_tr_b16 v[80:81], v20 offset:8192
  v_mfma_f32_16x16x32_bf16 v[112:115], v[64:67], v[28:31], 0
  ds_read_b64_tr_b16 v[82:83], v20 offset:12288
  v_mfma_f32_16x16x32_bf16 v[128:131], v[64:67], v[32:35], 0
  ds_read_b64_tr_b16 v[84:85], v21 offset:8192
  v_mfma_f32_16x16x32_bf16 v[144:147], v[64:67], v[36:39], 0
  ds_read_b64_tr_b16 v[86:87], v21 offset:12288
  s_waitcnt lgkmcnt(12)
  v_mfma_f32_16x16x32_bf16 v[148:151], v[68:71], v[36:39], 0
  v_mfma_f32_16x16x32_bf16 v[132:135], v[68:71], v[32:35], 0
  v_mfma_f32_16x16x32_bf16 v[116:119], v[68:71], v[28:31], 0
  v_mfma_f32_16x16x32_bf16 v[100:103], v[68:71], v[24:27], 0
  s_add_u32 s34, s34, 32768
  s_cmp_eq_u32 s34, 131072
  s_cselect_b32 s34, 0, s34
  v_add_u32 v13, s34, v12
  v_add_u32 v18, s34, v14
  v_add_u32 v19, s34, v15
  v_add_u32 v20, s34, v16
  v_add_u32 v21, s34, v17
  s_waitcnt lgkmcnt(0)
  s_barrier
  v_mfma_f32_16x16x32_bf16 v[88:91], v[72:75], v[40:43], v[88:91]
  ds_read_b128 v[24:27], v13 offset:0
  v_mfma_f32_16x16x32_bf16 v[104:107], v[72:75], v[44:47], v[104:107]
  ds_read_b64_tr_b16 v[56:57], v18 offset:0
  v_mfma_f32_16x16x32_bf16 v[120:123], v[72:75], v[48:51], v[120:123]
  ds_read_b64_tr_b16 v[58:59], v18 offset:4096
  v_mfma_f32_16x16x32_bf16 v[136:139], v[72:75], v[52:55], v[136:139]
  ds_read_b128 v[28:31], v13 offset:2048
  v_mfma_f32_16x16x32_bf16 v[140:143], v[76:79], v[52:55], v[140:143]
  ds_read_b128 v[32:35], v13 offset:4096
  v_mfma_f32_16x16x32_bf16 v[124:127], v[76:79], v[48:51], v[124:127]
  ds_read_b128 v[36:39], v13 offset:6144
  v_mfma_f32_16x16x32_bf16 v[108:111], v[76:79], v[44:47], v[108:111]
  ds_read_b64_tr_b16 v[60:61], v19 offset:0
  v_mfma_f32_16x16x32_bf16 v[92:95], v[76:79], v[40:43], v[92:95]
  ds_read_b64_tr_b16 v[62:63], v19 offset:4096
  v_mfma_f32_16x16x32_bf16 v[96:99], v[80:83], v[40:43], v[96:99]
  ds_read_b64_tr_b16 v[64:65], v20 offset:0
  v_mfma_f32_16x16x32_bf16 v[112:115], v[80:83], v[44:47], v[112:115]
  ds_read_b64_tr_b16 v[66:67], v20 offset:4096
  v_mfma_f32_16x16x32_bf16 v[128:131], v[80:83], v[48:51], v[128:131]
  ds_read_b64_tr_b16 v[68:69], v21 offset:0
  v_mfma_f32_16x16x32_bf16 v[144:147], v[80:83], v[52:55], v[144:147]
  ds_read_b64_tr_b16 v[70:71], v21 offset:4096
  v_mfma_f32_16x16x32_bf16 v[148:151], v[84:87], v[52:55], v[148:151]
  v_mfma_f32_16x16x32_bf16 v[132:135], v[84:87], v[48:51], v[132:135]
  v_mfma_f32_16x16x32_bf16 v[116:119], v[84:87], v[44:47], v[116:119]
  v_mfma_f32_16x16x32_bf16 v[100:103], v[84:87], v[40:43], v[100:103]
  s_waitcnt lgkmcnt(9)
  v_mfma_f32_16x16x32_bf16 v[88:91], v[56:59], v[24:27], v[88:91]
  ds_read_b128 v[40:43], v13 offset:1024
  s_waitcnt lgkmcnt(9)
  v_mfma_f32_16x16x32_bf16 v[104:107], v[56:59], v[28:31], v[104:107]
  ds_read_b64_tr_b16 v[72:73], v18 offset:8192
  s_waitcnt lgkmcnt(9)
  v_mfma_f32_16x16x32_bf16 v[120:123], v[56:59], v[32:35], v[120:123]
  ds_read_b64_tr_b16 v[74:75], v18 offset:12288
  s_waitcnt lgkmcnt(9)
  v_mfma_f32_16x16x32_bf16 v[136:139], v[56:59], v[36:39], v[136:139]
  ds_read_b128 v[44:47], v13 offset:3072
  s_waitcnt lgkmcnt(8)
  v_mfma_f32_16x16x32_bf16 v[140:143], v[60:63], v[36:39], v[140:143]
  ds_read_b128 v[48:51], v13 offset:5120
  v_mfma_f32_16x16x32_bf16 v[124:127], v[60:63], v[32:35], v[124:127]
  ds_read_b128 v[52:55], v13 offset:7168
  v_mfma_f32_16x16x32_bf16 v[108:111], v[60:63], v[28:31], v[108:111]
  ds_read_b64_tr_b16 v[76:77], v19 offset:8192
  v_mfma_f32_16x16x32_bf16 v[92:95], v[60:63], v[24:27], v[92:95]
  ds_read_b64_tr_b16 v[78:79], v19 offset:12288
  s_waitcnt lgkmcnt(10)
  v_mfma_f32_16x16x32_bf16 v[96:99], v[64:67], v[24:27], v[96:99]
  ds_read_b64_tr_b16 v[80:81], v20 offset:8192
  v_mfma_f32_16x16x32_bf16 v[112:115], v[64:67], v[28:31], v[112:115]
  ds_read_b64_tr_b16 v[82:83], v20 offset:12288
  v_mfma_f32_16x16x32_bf16 v[128:131], v[64:67], v[32:35], v[128:131]
  ds_read_b64_tr_b16 v[84:85], v21 offset:8192
  v_mfma_f32_16x16x32_bf16 v[144:147], v[64:67], v[36:39], v[144:147]
  ds_read_b64_tr_b16 v[86:87], v21 offset:12288
  s_waitcnt lgkmcnt(12)
  v_mfma_f32_16x16x32_bf16 v[148:151], v[68:71], v[36:39], v[148:151]
  s_add_u32 s34, s34, 32768
  s_cmp_eq_u32 s34, 131072
  s_cselect_b32 s34, 0, s34
  v_add_u32 v13, s34, v12
  v_mfma_f32_16x16x32_bf16 v[132:135], v[68:71], v[32:35], v[132:135]
  v_add_u32 v18, s34, v14
  v_add_u32 v19, s34, v15
  v_mfma_f32_16x16x32_bf16 v[116:119], v[68:71], v[28:31], v[116:119]
  v_add_u32 v20, s34, v16
  v_add_u32 v21, s34, v17
  v_mfma_f32_16x16x32_bf16 v[100:103], v[68:71], v[24:27], v[100:103]
  s_waitcnt lgkmcnt(0)
  s_setprio 3
  s_waitcnt vmcnt(0)
  v_mov_b32 v2, 163724
  v_mov_b32 v3, 1
  s_mov_b64 exec, 1
  ds_add_rtn_u32 v2, v2, v3
  s_lshl_b32 s31, s28, 4
  s_add_u32 s31, s31, s29
  s_lshl_b32 s31, s31, 7
  s_add_u32 s31, s31, 54558720
  s_waitcnt lgkmcnt(0)
  v_readfirstlane_b32 s39, v2
  v_mov_b32 v2, 0
  v_mov_b32 v3, s1
  s_nop 1
  s_cmp_eq_u32 s39, 3
  s_cbranch_scc0 L_notlast_h1
  buffer_store_dword v3, v2, s[12:15], s31 offen sc1
L_notlast_h1:
  s_mov_b64 exec, -1
  s_setprio 0
  s_barrier
  v_mfma_f32_16x16x32_bf16 v[88:91], v[72:75], v[40:43], v[88:91]
  ds_read_b128 v[24:27], v13 offset:0
  v_mfma_f32_16x16x32_bf16 v[104:107], v[72:75], v[44:47], v[104:107]
  ds_read_b64_tr_b16 v[56:57], v18 offset:0
  v_mfma_f32_16x16x32_bf16 v[120:123], v[72:75], v[48:51], v[120:123]
  ds_read_b64_tr_b16 v[58:59], v18 offset:4096
  v_mfma_f32_16x16x32_bf16 v[136:139], v[72:75], v[52:55], v[136:139]
  ds_read_b128 v[28:31], v13 offset:2048
  v_mfma_f32_16x16x32_bf16 v[140:143], v[76:79], v[52:55], v[140:143]
  ds_read_b128 v[32:35], v13 offset:4096
  v_mfma_f32_16x16x32_bf16 v[124:127], v[76:79], v[48:51], v[124:127]
  ds_read_b128 v[36:39], v13 offset:6144
  v_mfma_f32_16x16x32_bf16 v[108:111], v[76:79], v[44:47], v[108:111]
  ds_read_b64_tr_b16 v[60:61], v19 offset:0
  v_mfma_f32_16x16x32_bf16 v[92:95], v[76:79], v[40:43], v[92:95]
  ds_read_b64_tr_b16 v[62:63], v19 offset:4096
  v_mfma_f32_16x16x32_bf16 v[96:99], v[80:83], v[40:43], v[96:99]
  ds_read_b64_tr_b16 v[64:65], v20 offset:0
  v_mfma_f32_16x16x32_bf16 v[112:115], v[80:83], v[44:47], v[112:115]
  ds_read_b64_tr_b16 v[66:67], v20 offset:4096
  v_mfma_f32_16x16x32_bf16 v[128:131], v[80:83], v[48:51], v[128:131]
  ds_read_b64_tr_b16 v[68:69], v21 offset:0
  v_mfma_f32_16x16x32_bf16 v[144:147], v[80:83], v[52:55], v[144:147]
  ds_read_b64_tr_b16 v[70:71], v21 offset:4096
  v_mfma_f32_16x16x32_bf16 v[148:151], v[84:87], v[52:55], v[148:151]
  v_mfma_f32_16x16x32_bf16 v[132:135], v[84:87], v[48:51], v[132:135]
  v_mfma_f32_16x16x32_bf16 v[116:119], v[84:87], v[44:47], v[116:119]
  v_mfma_f32_16x16x32_bf16 v[100:103], v[84:87], v[40:43], v[100:103]
  s_waitcnt lgkmcnt(9)
  v_mfma_f32_16x16x32_bf16 v[88:91], v[56:59], v[24:27], v[88:91]
  ds_read_b128 v[40:43], v13 offset:1024
  s_waitcnt lgkmcnt(9)
  v_mfma_f32_16x16x32_bf16 v[104:107], v[56:59], v[28:31], v[104:107]
  ds_read_b64_tr_b16 v[72:73], v18 offset:8192
  s_waitcnt lgkmcnt(9)
  v_mfma_f32_16x16x32_bf16 v[120:123], v[56:59], v[32:35], v[120:123]
  ds_read_b64_tr_b16 v[74:75], v18 offset:12288
  s_waitcnt lgkmcnt(9)
  v_mfma_f32_16x16x32_bf16 v[136:139], v[56:59], v[36:39], v[136:139]
  ds_read_b128 v[44:47], v13 offset:3072
  s_waitcnt lgkmcnt(8)
  v_mfma_f32_16x16x32_bf16 v[140:143], v[60:63], v[36:39], v[140:143]
  ds_read_b128 v[48:51], v13 offset:5120
  v_mfma_f32_16x16x32_bf16 v[124:127], v[60:63], v[32:35], v[124:127]
  ds_read_b128 v[52:55], v13 offset:7168
  v_mfma_f32_16x16x32_bf16 v[108:111], v[60:63], v[28:31], v[108:111]
  ds_read_b64_tr_b16 v[76:77], v19 offset:8192
  v_mfma_f32_16x16x32_bf16 v[92:95], v[60:63], v[24:27], v[92:95]
  ds_read_b64_tr_b16 v[78:79], v19 offset:12288
  s_waitcnt lgkmcnt(10)
  v_mfma_f32_16x16x32_bf16 v[96:99], v[64:67], v[24:27], v[96:99]
  ds_read_b64_tr_b16 v[80:81], v20 offset:8192
  v_mfma_f32_16x16x32_bf16 v[112:115], v[64:67], v[28:31], v[112:115]
  ds_read_b64_tr_b16 v[82:83], v20 offset:12288
  v_mfma_f32_16x16x32_bf16 v[128:131], v[64:67], v[32:35], v[128:131]
  ds_read_b64_tr_b16 v[84:85], v21 offset:8192
  v_mfma_f32_16x16x32_bf16 v[144:147], v[64:67], v[36:39], v[144:147]
  ds_read_b64_tr_b16 v[86:87], v21 offset:12288
  s_waitcnt lgkmcnt(12)
  v_mfma_f32_16x16x32_bf16 v[148:151], v[68:71], v[36:39], v[148:151]
  s_add_u32 s34, s34, 32768
  s_cmp_eq_u32 s34, 131072
  s_cselect_b32 s34, 0, s34
  v_add_u32 v13, s34, v12
  v_mfma_f32_16x16x32_bf16 v[132:135], v[68:71], v[32:35], v[132:135]
  v_add_u32 v18, s34, v14
  v_add_u32 v19, s34, v15
  v_mfma_f32_16x16x32_bf16 v[116:119], v[68:71], v[28:31], v[116:119]
  v_add_u32 v20, s34, v16
  v_add_u32 v21, s34, v17
  v_mfma_f32_16x16x32_bf16 v[100:103], v[68:71], v[24:27], v[100:103]
  s_waitcnt lgkmcnt(0)
  s_barrier
  v_mfma_f32_16x16x32_bf16 v[88:91], v[72:75], v[40:43], v[88:91]
  v_mfma_f32_16x16x32_bf16 v[104:107], v[72:75], v[44:47], v[104:107]
  v_mfma_f32_16x16x32_bf16 v[120:123], v[72:75], v[48:51], v[120:123]
  v_mfma_f32_16x16x32_bf16 v[136:139], v[72:75], v[52:55], v[136:139]
  v_mfma_f32_16x16x32_bf16 v[140:143], v[76:79], v[52:55], v[140:143]
  v_mfma_f32_16x16x32_bf16 v[124:127], v[76:79], v[48:51], v[124:127]
  v_mfma_f32_16x16x32_bf16 v[108:111], v[76:79], v[44:47], v[108:111]
  v_mfma_f32_16x16x32_bf16 v[92:95], v[76:79], v[40:43], v[92:95]
  v_mfma_f32_16x16x32_bf16 v[96:99], v[80:83], v[40:43], v[96:99]
  v_mfma_f32_16x16x32_bf16 v[112:115], v[80:83], v[44:47], v[112:115]
  v_mfma_f32_16x16x32_bf16 v[128:131], v[80:83], v[48:51], v[128:131]
  v_mfma_f32_16x16x32_bf16 v[144:147], v[80:83], v[52:55], v[144:147]
  v_mfma_f32_16x16x32_bf16 v[148:151], v[84:87], v[52:55], v[148:151]
  v_mfma_f32_16x16x32_bf16 v[132:135], v[84:87], v[48:51], v[132:135]
  v_mfma_f32_16x16x32_bf16 v[116:119], v[84:87], v[44:47], v[116:119]
  v_mfma_f32_16x16x32_bf16 v[100:103], v[84:87], v[40:43], v[100:103]
  s_setprio 3
  s_nop 6
  s_cmp_eq_u32 s70, 0
  s_cbranch_scc1 L_res2a
  s_and_b32 s31, s29, 7
  s_lshl_b32 s31, s31, 1
  s_add_u32 s31, s31, s43
  s_lshl_b32 s39, s28, 4
  s_add_u32 s31, s31, s39
  s_lshl_b32 s31, s31, 14
  s_lshl_b32 s39, s42, 13
  s_add_u32 s31, s31, s39
  s_lshl_b32 s39, s3, 10
  s_add_u32 s31, s31, s39
  s_add_u32 s31, s31, 16777216
  buffer_load_dwordx4 v[152:155], v10, s[12:15], s31 offen offset:0 sc1
  buffer_load_dwordx4 v[156:159], v10, s[12:15], s31 offen offset:2048 sc1
  s_add_u32 s31, s31, 4096
  buffer_load_dwordx4 v[160:163], v10, s[12:15], s31 offen offset:0 sc1
  buffer_load_dwordx4 v[164:167], v10, s[12:15], s31 offen offset:2048 sc1
L_res2a:
  s_cmp_lg_u32 s70, 0
  s_cbranch_scc1 L_nocpoll_f2
  s_lshl_b32 s31, s28, 11
  s_add_u32 s31, s31, 54558720
  v_and_b32 v4, 15, v1
  v_lshlrev_b32 v4, 7, v4
  v_add_u32 v4, s31, v4
  s_mov_b32 s36, 400000
L_poll_f2:
  buffer_load_dword v2, v4, s[12:15], 0 offen sc1
  s_waitcnt vmcnt(0)
  v_cmp_eq_u32 vcc, s1, v2
  s_nop 4
  s_cmp_eq_u64 vcc, exec
  s_cbranch_scc1 L_polldone_f2
  s_sleep 4
  s_sub_u32 s36, s36, 1
  s_cmp_lg_u32 s36, 0
  s_cbranch_scc1 L_poll_f2
L_polldone_f2:
L_nocpoll_f2:
  s_barrier
  s_cmp_lg_u32 s70, 0
  s_cbranch_scc1 L_res2b
  s_and_b32 s31, s29, 7
  s_lshl_b32 s31, s31, 1
  s_add_u32 s31, s31, s43
  s_lshl_b32 s39, s28, 4
  s_add_u32 s31, s31, s39
  s_lshl_b32 s31, s31, 14
  s_lshl_b32 s39, s42, 13
  s_add_u32 s31, s31, s39
  s_lshl_b32 s39, s3, 10
  s_add_u32 s31, s31, s39
  s_add_u32 s31, s31, 16777216
  buffer_load_dwordx4 v[152:155], v10, s[12:15], s31 offen offset:0 sc1
  buffer_load_dwordx4 v[156:159], v10, s[12:15], s31 offen offset:2048 sc1
  s_add_u32 s31, s31, 4096
  buffer_load_dwordx4 v[160:163], v10, s[12:15], s31 offen offset:0 sc1
  buffer_load_dwordx4 v[164:167], v10, s[12:15], s31 offen offset:2048 sc1
L_res2b:
  s_mov_b32 s34, 0
  v_add_u32 v13, s34, v12
  v_add_u32 v18, s34, v14
  v_add_u32 v19, s34, v15
  v_add_u32 v20, s34, v16
  v_add_u32 v21, s34, v17
  s_waitcnt lgkmcnt(0)
  s_setprio 0
  s_barrier
  ds_read_b128 v[24:27], v13 offset:0
  ds_read_b64_tr_b16 v[56:57], v18 offset:0
  ds_read_b64_tr_b16 v[58:59], v18 offset:4096
  ds_read_b128 v[28:31], v13 offset:2048
  ds_read_b128 v[32:35], v13 offset:4096
  ds_read_b128 v[36:39], v13 offset:6144
  ds_read_b64_tr_b16 v[60:61], v19 offset:0
  ds_read_b64_tr_b16 v[62:63], v19 offset:4096
  ds_read_b64_tr_b16 v[64:65], v20 offset:0
  ds_read_b64_tr_b16 v[66:67], v20 offset:4096
  ds_read_b64_tr_b16 v[68:69], v21 offset:0
  ds_read_b64_tr_b16 v[70:71], v21 offset:4096
  s_waitcnt lgkmcnt(9)
  v_mfma_f32_16x16x32_bf16 v[88:91], v[56:59], v[24:27], v[88:91]
  ds_read_b128 v[40:43], v13 offset:1024
  s_waitcnt lgkmcnt(9)
  v_mfma_f32_16x16x32_bf16 v[104:107], v[56:59], v[28:31], v[104:107]
  ds_read_b64_tr_b16 v[72:73], v18 offset:8192
  s_waitcnt lgkmcnt(9)
  v_mfma_f32_16x16x32_bf16 v[120:123], v[56:59], v[32:35], v[120:123]
  ds_read_b64_tr_b16 v[74:75], v18 offset:12288
  s_waitcnt lgkmcnt(9)
  v_mfma_f32_16x16x32_bf16 v[136:139], v[56:59], v[36:39], v[136:139]
  ds_read_b128 v[44:47], v13 offset:3072
  s_waitcnt lgkmcnt(8)
  v_mfma_f32_16x16x32_bf16 v[140:143], v[60:63], v[36:39], v[140:143]
  ds_read_b128 v[48:51], v13 offset:5120
  v_mfma_f32_16x16x32_bf16 v[124:127], v[60:63], v[32:35], v[124:127]
  ds_read_b128 v[52:55], v13 offset:7168
  v_mfma_f32_16x16x32_bf16 v[108:111], v[60:63], v[28:31], v[108:111]
  ds_read_b64_tr_b16 v[76:77], v19 offset:8192
  v_mfma_f32_16x16x32_bf16 v[92:95], v[60:63], v[24:27], v[92:95]
  ds_read_b64_tr_b16 v[78:79], v19 offset:12288
  s_waitcnt lgkmcnt(10)
  v_mfma_f32_16x16x32_bf16 v[96:99], v[64:67], v[24:27], v[96:99]
  ds_read_b64_tr_b16 v[80:81], v20 offset:8192
  v_mfma_f32_16x16x32_bf16 v[112:115], v[64:67], v[28:31], v[112:115]
  ds_read_b64_tr_b16 v[82:83], v20 offset:12288
  v_mfma_f32_16x16x32_bf16 v[128:131], v[64:67], v[32:35], v[128:131]
  ds_read_b64_tr_b16 v[84:85], v21 offset:8192
  v_mfma_f32_16x16x32_bf16 v[144:147], v[64:67], v[36:39], v[144:147]
  ds_read_b64_tr_b16 v[86:87], v21 offset:12288
  s_waitcnt lgkmcnt(12)
  v_mfma_f32_16x16x32_bf16 v[148:151], v[68:71], v[36:39], v[148:151]
  v_mfma_f32_16x16x32_bf16 v[132:135], v[68:71], v[32:35], v[132:135]
  v_mfma_f32_16x16x32_bf16 v[116:119], v[68:71], v[28:31], v[116:119]
  v_mfma_f32_16x16x32_bf16 v[100:103], v[68:71], v[24:27], v[100:103]
  s_add_u32 s34, s34, 32768
  s_cmp_eq_u32 s34, 131072
  s_cselect_b32 s34, 0, s34
  v_add_u32 v13, s34, v12
  v_add_u32 v18, s34, v14
  v_add_u32 v19, s34, v15
  v_add_u32 v20, s34, v16
  v_add_u32 v21, s34, v17
  s_waitcnt lgkmcnt(0)
  s_barrier
  s_mov_b32 s36, 23
  s_branch L_loop_f2
L_top_f2:
  s_barrier
L_loop_f2:
  v_mfma_f32_16x16x32_bf16 v[88:91], v[72:75], v[40:43], v[88:91]
  ds_read_b128 v[24:27], v13 offset:0
  v_mfma_f32_16x16x32_bf16 v[104:107], v[72:75], v[44:47], v[104:107]
  ds_read_b64_tr_b16 v[56:57], v18 offset:0
  v_mfma_f32_16x16x32_bf16 v[120:123], v[72:75], v[48:51], v[120:123]
  ds_read_b64_tr_b16 v[58:59], v18 offset:4096
  v_mfma_f32_16x16x32_bf16 v[136:139], v[72:75], v[52:55], v[136:139]
  ds_read_b128 v[28:31], v13 offset:2048
  v_mfma_f32_16x16x32_bf16 v[140:143], v[76:79], v[52:55], v[140:143]
  ds_read_b128 v[32:35], v13 offset:4096
  v_mfma_f32_16x16x32_bf16 v[124:127], v[76:79], v[48:51], v[124:127]
  ds_read_b128 v[36:39], v13 offset:6144
  v_mfma_f32_16x16x32_bf16 v[108:111], v[76:79], v[44:47], v[108:111]
  ds_read_b64_tr_b16 v[60:61], v19 offset:0
  v_mfma_f32_16x16x32_bf16 v[92:95], v[76:79], v[40:43], v[92:95]
  ds_read_b64_tr_b16 v[62:63], v19 offset:4096
  v_mfma_f32_16x16x32_bf16 v[96:99], v[80:83], v[40:43], v[96:99]
  ds_read_b64_tr_b16 v[64:65], v20 offset:0
  v_mfma_f32_16x16x32_bf16 v[112:115], v[80:83], v[44:47], v[112:115]
  ds_read_b64_tr_b16 v[66:67], v20 offset:4096
  v_mfma_f32_16x16x32_bf16 v[128:131], v[80:83], v[48:51], v[128:131]
  ds_read_b64_tr_b16 v[68:69], v21 offset:0
  v_mfma_f32_16x16x32_bf16 v[144:147], v[80:83], v[52:55], v[144:147]
  ds_read_b64_tr_b16 v[70:71], v21 offset:4096
  v_mfma_f32_16x16x32_bf16 v[148:151], v[84:87], v[52:55], v[148:151]
  v_mfma_f32_16x16x32_bf16 v[132:135], v[84:87], v[48:51], v[132:135]
  v_mfma_f32_16x16x32_bf16 v[116:119], v[84:87], v[44:47], v[116:119]
  v_mfma_f32_16x16x32_bf16 v[100:103], v[84:87], v[40:43], v[100:103]
  s_waitcnt lgkmcnt(9)
  v_mfma_f32_16x16x32_bf16 v[88:91], v[56:59], v[24:27], v[88:91]
  ds_read_b128 v[40:43], v13 offset:1024
  s_waitcnt lgkmcnt(9)
  v_mfma_f32_16x16x32_bf16 v[104:107], v[56:59], v[28:31], v[104:107]
  ds_read_b64_tr_b16 v[72:73], v18 offset:8192
  s_waitcnt lgkmcnt(9)
  v_mfma_f32_16x16x32_bf16 v[120:123], v[56:59], v[32:35], v[120:123]
  ds_read_b64_tr_b16 v[74:75], v18 offset:12288
  s_waitcnt lgkmcnt(9)
  v_mfma_f32_16x16x32_bf16 v[136:139], v[56:59], v[36:39], v[136:139]
  ds_read_b128 v[44:47], v13 offset:3072
  s_waitcnt lgkmcnt(8)
  v_mfma_f32_16x16x32_bf16 v[140:143], v[60:63], v[36:39], v[140:143]
  ds_read_b128 v[48:51], v13 offset:5120
  v_mfma_f32_16x16x32_bf16 v[124:127], v[60:63], v[32:35], v[124:127]
  ds_read_b128 v[52:55], v13 offset:7168
  v_mfma_f32_16x16x32_bf16 v[108:111], v[60:63], v[28:31], v[108:111]
  ds_read_b64_tr_b16 v[76:77], v19 offset:8192
  v_mfma_f32_16x16x32_bf16 v[92:95], v[60:63], v[24:27], v[92:95]
  ds_read_b64_tr_b16 v[78:79], v19 offset:12288
  s_waitcnt lgkmcnt(10)
  v_mfma_f32_16x16x32_bf16 v[96:99], v[64:67], v[24:27], v[96:99]
  ds_read_b64_tr_b16 v[80:81], v20 offset:8192
  v_mfma_f32_16x16x32_bf16 v[112:115], v[64:67], v[28:31], v[112:115]
  ds_read_b64_tr_b16 v[82:83], v20 offset:12288
  v_mfma_f32_16x16x32_bf16 v[128:131], v[64:67], v[32:35], v[128:131]
  ds_read_b64_tr_b16 v[84:85], v21 offset:8192
  v_mfma_f32_16x16x32_bf16 v[144:147], v[64:67], v[36:39], v[144:147]
  ds_read_b64_tr_b16 v[86:87], v21 offset:12288
  s_waitcnt lgkmcnt(12)
  v_mfma_f32_16x16x32_bf16 v[148:151], v[68:71], v[36:39], v[148:151]
  s_add_u32 s34, s34, 32768
  s_cmp_eq_u32 s34, 131072
  s_cselect_b32 s34, 0, s34
  v_add_u32 v13, s34, v12
  v_add_u32 v18, s34, v14
  v_mfma_f32_16x16x32_bf16 v[132:135], v[68:71], v[32:35], v[132:135]
  v_add_u32 v19, s34, v15
  v_add_u32 v20, s34, v16
  v_mfma_f32_16x16x32_bf16 v[116:119], v[68:71], v[28:31], v[116:119]
  v_add_u32 v21, s34, v17
  s_sub_u32 s36, s36, 1
  s_cmp_lg_u32 s36, 0
  v_mfma_f32_16x16x32_bf16 v[100:103], v[68:71], v[24:27], v[100:103]
  s_waitcnt lgkmcnt(0)
  s_cbranch_scc1 L_top_f2
  s_barrier
  v_mfma_f32_16x16x32_bf16 v[88:91], v[72:75], v[40:43], v[88:91]
  ds_read_b128 v[24:27], v13 offset:0
  v_mfma_f32_16x16x32_bf16 v[104:107], v[72:75], v[44:47], v[104:107]
  ds_read_b64_tr_b16 v[56:57], v18 offset:0
  v_mfma_f32_16x16x32_bf16 v[120:123], v[72:75], v[48:51], v[120:123]
  ds_read_b64_tr_b16 v[58:59], v18 offset:4096
  v_mfma_f32_16x16x32_bf16 v[136:139], v[72:75], v[52:55], v[136:139]
  ds_read_b128 v[28:31], v13 offset:2048
  v_mfma_f32_16x16x32_bf16 v[140:143], v[76:79], v[52:55], v[140:143]
  ds_read_b128 v[32:35], v13 offset:4096
  v_mfma_f32_16x16x32_bf16 v[124:127], v[76:79], v[48:51], v[124:127]
  ds_read_b128 v[36:39], v13 offset:6144
  v_mfma_f32_16x16x32_bf16 v[108:111], v[76:79], v[44:47], v[108:111]
  ds_read_b64_tr_b16 v[60:61], v19 offset:0
  v_mfma_f32_16x16x32_bf16 v[92:95], v[76:79], v[40:43], v[92:95]
  ds_read_b64_tr_b16 v[62:63], v19 offset:4096
  v_mfma_f32_16x16x32_bf16 v[96:99], v[80:83], v[40:43], v[96:99]
  ds_read_b64_tr_b16 v[64:65], v20 offset:0
  v_mfma_f32_16x16x32_bf16 v[112:115], v[80:83], v[44:47], v[112:115]
  ds_read_b64_tr_b16 v[66:67], v20 offset:4096
  v_mfma_f32_16x16x32_bf16 v[128:131], v[80:83], v[48:51], v[128:131]
  ds_read_b64_tr_b16 v[68:69], v21 offset:0
  v_mfma_f32_16x16x32_bf16 v[144:147], v[80:83], v[52:55], v[144:147]
  ds_read_b64_tr_b16 v[70:71], v21 offset:4096
  v_mfma_f32_16x16x32_bf16 v[148:151], v[84:87], v[52:55], v[148:151]
  v_mfma_f32_16x16x32_bf16 v[132:135], v[84:87], v[48:51], v[132:135]
  v_mfma_f32_16x16x32_bf16 v[116:119], v[84:87], v[44:47], v[116:119]
  v_mfma_f32_16x16x32_bf16 v[100:103], v[84:87], v[40:43], v[100:103]
  s_waitcnt lgkmcnt(9)
  v_mfma_f32_16x16x32_bf16 v[88:91], v[56:59], v[24:27], v[88:91]
  ds_read_b128 v[40:43], v13 offset:1024
  s_waitcnt lgkmcnt(9)
  v_mfma_f32_16x16x32_bf16 v[104:107], v[56:59], v[28:31], v[104:107]
  ds_read_b64_tr_b16 v[72:73], v18 offset:8192
  s_waitcnt lgkmcnt(9)
  v_mfma_f32_16x16x32_bf16 v[120:123], v[56:59], v[32:35], v[120:123]
  ds_read_b64_tr_b16 v[74:75], v18 offset:12288
  s_waitcnt lgkmcnt(9)
  v_mfma_f32_16x16x32_bf16 v[136:139], v[56:59], v[36:39], v[136:139]
  ds_read_b128 v[44:47], v13 offset:3072
  s_waitcnt lgkmcnt(8)
  v_mfma_f32_16x16x32_bf16 v[140:143], v[60:63], v[36:39], v[140:143]
  ds_read_b128 v[48:51], v13 offset:5120
  v_mfma_f32_16x16x32_bf16 v[124:127], v[60:63], v[32:35], v[124:127]
  ds_read_b128 v[52:55], v13 offset:7168
  v_mfma_f32_16x16x32_bf16 v[108:111], v[60:63], v[28:31], v[108:111]
  ds_read_b64_tr_b16 v[76:77], v19 offset:8192
  v_mfma_f32_16x16x32_bf16 v[92:95], v[60:63], v[24:27], v[92:95]
  ds_read_b64_tr_b16 v[78:79], v19 offset:12288
  s_waitcnt lgkmcnt(10)
  v_mfma_f32_16x16x32_bf16 v[96:99], v[64:67], v[24:27], v[96:99]
  ds_read_b64_tr_b16 v[80:81], v20 offset:8192
  v_mfma_f32_16x16x32_bf16 v[112:115], v[64:67], v[28:31], v[112:115]
  ds_read_b64_tr_b16 v[82:83], v20 offset:12288
  v_mfma_f32_16x16x32_bf16 v[128:131], v[64:67], v[32:35], v[128:131]
  ds_read_b64_tr_b16 v[84:85], v21 offset:8192
  v_mfma_f32_16x16x32_bf16 v[144:147], v[64:67], v[36:39], v[144:147]
  ds_read_b64_tr_b16 v[86:87], v21 offset:12288
  s_waitcnt lgkmcnt(12)
  v_mfma_f32_16x16x32_bf16 v[148:151], v[68:71], v[36:39], v[148:151]
  s_add_u32 s34, s34, 32768
  s_cmp_eq_u32 s34, 131072
  s_cselect_b32 s34, 0, s34
  v_add_u32 v13, s34, v12
  v_mfma_f32_16x16x32_bf16 v[132:135], v[68:71], v[32:35], v[132:135]
  v_add_u32 v18, s34, v14
  v_add_u32 v19, s34, v15
  v_mfma_f32_16x16x32_bf16 v[116:119], v[68:71], v[28:31], v[116:119]
  v_add_u32 v20, s34, v16
  v_add_u32 v21, s34, v17
  v_mfma_f32_16x16x32_bf16 v[100:103], v[68:71], v[24:27], v[100:103]
  s_waitcnt lgkmcnt(0)
  s_barrier
  v_mfma_f32_16x16x32_bf16 v[88:91], v[72:75], v[40:43], v[88:91]
  v_mfma_f32_16x16x32_bf16 v[104:107], v[72:75], v[44:47], v[104:107]
  v_mfma_f32_16x16x32_bf16 v[120:123], v[72:75], v[48:51], v[120:123]
  v_mfma_f32_16x16x32_bf16 v[136:139], v[72:75], v[52:55], v[136:139]
  v_mfma_f32_16x16x32_bf16 v[140:143], v[76:79], v[52:55], v[140:143]
  v_mfma_f32_16x16x32_bf16 v[124:127], v[76:79], v[48:51], v[124:127]
  v_mfma_f32_16x16x32_bf16 v[108:111], v[76:79], v[44:47], v[108:111]
  v_mfma_f32_16x16x32_bf16 v[92:95], v[76:79], v[40:43], v[92:95]
  v_mfma_f32_16x16x32_bf16 v[96:99], v[80:83], v[40:43], v[96:99]
  v_mfma_f32_16x16x32_bf16 v[112:115], v[80:83], v[44:47], v[112:115]
  v_mfma_f32_16x16x32_bf16 v[128:131], v[80:83], v[48:51], v[128:131]
  v_mfma_f32_16x16x32_bf16 v[144:147], v[80:83], v[52:55], v[144:147]
  v_mfma_f32_16x16x32_bf16 v[148:151], v[84:87], v[52:55], v[148:151]
  v_mfma_f32_16x16x32_bf16 v[132:135], v[84:87], v[48:51], v[132:135]
  v_mfma_f32_16x16x32_bf16 v[116:119], v[84:87], v[44:47], v[116:119]
  v_mfma_f32_16x16x32_bf16 v[100:103], v[84:87], v[40:43], v[100:103]
  s_setprio 3
  s_nop 6
  s_lshl_b32 s31, s28, 4
  s_add_u32 s31, s31, s29
  s_lshl_b32 s31, s31, 15
  s_lshl_b32 s39, s70, 13
  s_add_u32 s31, s31, s39
  s_add_u32 s31, s31, 46137344
  buffer_store_dwordx4 v[96:99], v10, s[12:15], s31 offen offset:0 sc1
  buffer_store_dwordx4 v[100:103], v10, s[12:15], s31 offen offset:1024 sc1
  buffer_store_dwordx4 v[112:115], v10, s[12:15], s31 offen offset:2048 sc1
  buffer_store_dwordx4 v[116:119], v10, s[12:15], s31 offen offset:3072 sc1
  s_add_u32 s31, s31, 4096
  buffer_store_dwordx4 v[128:131], v10, s[12:15], s31 offen offset:0 sc1
  buffer_store_dwordx4 v[132:135], v10, s[12:15], s31 offen offset:1024 sc1
  buffer_store_dwordx4 v[144:147], v10, s[12:15], s31 offen offset:2048 sc1
  buffer_store_dwordx4 v[148:151], v10, s[12:15], s31 offen offset:3072 sc1
  s_lshl_b32 s69, s42, 6
  v_and_b32 v212, 15, v1
  v_add_u32 v212, s69, v212
  v_lshlrev_b32 v212, 2, v212
  v_add_u32 v212, 0x27a00, v212
  ds_read_b32 v200, v212 offset:0
  ds_read_b32 v201, v212 offset:64
  ds_read_b32 v202, v212 offset:128
  ds_read_b32 v203, v212 offset:192
  s_mov_b32 s20, s56
  s_mov_b32 s21, s57
  s_mov_b32 s22, 4194304
  s_mov_b32 s23, 0x20000
  v_and_b32 v213, 15, v1
  v_lshlrev_b32 v213, 11, v213
  v_lshrrev_b32 v7, 4, v1
  v_and_b32 v7, 1, v7
  v_lshlrev_b32 v7, 5, v7
  v_add_u32 v213, v213, v7
  v_lshrrev_b32 v7, 5, v1
  v_lshlrev_b32 v7, 4, v7
  v_add_u32 v213, v213, v7
  s_xor_b32 s31, s29, 8
  s_lshl_b32 s39, s28, 4
  s_add_u32 s31, s31, s39
  s_lshl_b32 s31, s31, 15
  s_lshl_b32 s39, s70, 13
  s_add_u32 s31, s31, s39
  s_add_u32 s40, s31, 46137344
  s_add_u32 s41, s40, 4096
  s_mov_b32 s36, 400000
L_xch:
  buffer_load_dwordx4 v[168:171], v10, s[12:15], s40 offen offset:0 sc1
  buffer_load_dwordx4 v[172:175], v10, s[12:15], s40 offen offset:1024 sc1
  buffer_load_dwordx4 v[176:179], v10, s[12:15], s40 offen offset:2048 sc1
  buffer_load_dwordx4 v[180:183], v10, s[12:15], s40 offen offset:3072 sc1
  buffer_load_dwordx4 v[184:187], v10, s[12:15], s41 offen offset:0 sc1
  buffer_load_dwordx4 v[188:191], v10, s[12:15], s41 offen offset:1024 sc1
  buffer_load_dwordx4 v[192:195], v10, s[12:15], s41 offen offset:2048 sc1
  buffer_load_dwordx4 v[196:199], v10, s[12:15], s41 offen offset:3072 sc1
  s_waitcnt vmcnt(0)
  v_max3_u32 v2, v168, v169, v170
  v_max3_u32 v2, v2, v171, v172
  v_max3_u32 v2, v2, v173, v174
  v_max3_u32 v2, v2, v175, v176
  v_max3_u32 v2, v2, v177, v178
  v_max3_u32 v2, v2, v179, v180
  v_max3_u32 v2, v2, v181, v182
  v_max3_u32 v2, v2, v183, v184
  v_max3_u32 v2, v2, v185, v186
  v_max3_u32 v2, v2, v187, v188
  v_max3_u32 v2, v2, v189, v190
  v_max3_u32 v2, v2, v191, v192
  v_max3_u32 v2, v2, v193, v194
  v_max3_u32 v2, v2, v195, v196
  v_max3_u32 v2, v2, v197, v198
  v_max_u32 v2, v2, v199
  v_cmp_ne_u32 vcc, -1, v2
  s_nop 4
  s_cmp_eq_u64 vcc, exec
  s_cbranch_scc1 L_xch_done
  s_sub_u32 s36, s36, 1
  s_cmp_lg_u32 s36, 0
  s_cbranch_scc1 L_xch
L_xch_done:
  s_lshl_b32 s31, s28, 1
  s_add_u32 s31, s31, s42
  s_lshl_b32 s31, s31, 17
  s_and_b32 s39, s29, 7
  s_lshl_b32 s39, s39, 8
  s_add_u32 s31, s31, s39
  s_lshl_b32 s39, s43, 7
  s_add_u32 s31, s31, s39
  s_lshl_b32 s39, s3, 6
  s_add_u32 s31, s31, s39
  s_waitcnt lgkmcnt(0)
  v_pk_add_f32 v[88:89], v[88:89], v[168:169]
  v_pk_add_f32 v[90:91], v[90:91], v[170:171]
  v_lshlrev_b32 v2, 16, v152
  v_and_b32 v3, 0xffff0000, v152
  v_fma_f32 v2, v88, v200, v2
  v_fma_f32 v3, v89, v200, v3
  v_cvt_pk_bf16_f32 v204, v2, v3
  v_lshlrev_b32 v2, 16, v153
  v_and_b32 v3, 0xffff0000, v153
  v_fma_f32 v2, v90, v200, v2
  v_fma_f32 v3, v91, v200, v3
  v_cvt_pk_bf16_f32 v205, v2, v3
  v_pk_add_f32 v[92:93], v[92:93], v[172:173]
  v_pk_add_f32 v[94:95], v[94:95], v[174:175]
  v_lshlrev_b32 v2, 16, v154
  v_and_b32 v3, 0xffff0000, v154
  v_fma_f32 v2, v92, v200, v2
  v_fma_f32 v3, v93, v200, v3
  v_cvt_pk_bf16_f32 v206, v2, v3
  v_lshlrev_b32 v2, 16, v155
  v_and_b32 v3, 0xffff0000, v155
  v_fma_f32 v2, v94, v200, v2
  v_fma_f32 v3, v95, v200, v3
  v_cvt_pk_bf16_f32 v207, v2, v3
  s_nop 1
  v_permlane16_swap_b32 v204, v206
  v_permlane16_swap_b32 v205, v207
  buffer_store_dwordx4 v[204:207], v213, s[20:23], s31 offen sc1
  s_add_u32 s31, s31, 32768
  v_pk_add_f32 v[104:105], v[104:105], v[176:177]
  v_pk_add_f32 v[106:107], v[106:107], v[178:179]
  v_lshlrev_b32 v2, 16, v156
  v_and_b32 v3, 0xffff0000, v156
  v_fma_f32 v2, v104, v201, v2
  v_fma_f32 v3, v105, v201, v3
  v_cvt_pk_bf16_f32 v208, v2, v3
  v_lshlrev_b32 v2, 16, v157
  v_and_b32 v3, 0xffff0000, v157
  v_fma_f32 v2, v106, v201, v2
  v_fma_f32 v3, v107, v201, v3
  v_cvt_pk_bf16_f32 v209, v2, v3
  v_pk_add_f32 v[108:109], v[108:109], v[180:181]
  v_pk_add_f32 v[110:111], v[110:111], v[182:183]
  v_lshlrev_b32 v2, 16, v158
  v_and_b32 v3, 0xffff0000, v158
  v_fma_f32 v2, v108, v201, v2
  v_fma_f32 v3, v109, v201, v3
  v_cvt_pk_bf16_f32 v210, v2, v3
  v_lshlrev_b32 v2, 16, v159
  v_and_b32 v3, 0xffff0000, v159
  v_fma_f32 v2, v110, v201, v2
  v_fma_f32 v3, v111, v201, v3
  v_cvt_pk_bf16_f32 v211, v2, v3
  s_nop 1
  v_permlane16_swap_b32 v208, v210
  v_permlane16_swap_b32 v209, v211
  buffer_store_dwordx4 v[208:211], v213, s[20:23], s31 offen sc1
  s_add_u32 s31, s31, 32768
  v_pk_add_f32 v[120:121], v[120:121], v[184:185]
  v_pk_add_f32 v[122:123], v[122:123], v[186:187]
  v_lshlrev_b32 v2, 16, v160
  v_and_b32 v3, 0xffff0000, v160
  v_fma_f32 v2, v120, v202, v2
  v_fma_f32 v3, v121, v202, v3
  v_cvt_pk_bf16_f32 v204, v2, v3
  v_lshlrev_b32 v2, 16, v161
  v_and_b32 v3, 0xffff0000, v161
  v_fma_f32 v2, v122, v202, v2
  v_fma_f32 v3, v123, v202, v3
  v_cvt_pk_bf16_f32 v205, v2, v3
  v_pk_add_f32 v[124:125], v[124:125], v[188:189]
  v_pk_add_f32 v[126:127], v[126:127], v[190:191]
  v_lshlrev_b32 v2, 16, v162
  v_and_b32 v3, 0xffff0000, v162
  v_fma_f32 v2, v124, v202, v2
  v_fma_f32 v3, v125, v202, v3
  v_cvt_pk_bf16_f32 v206, v2, v3
  v_lshlrev_b32 v2, 16, v163
  v_and_b32 v3, 0xffff0000, v163
  v_fma_f32 v2, v126, v202, v2
  v_fma_f32 v3, v127, v202, v3
  v_cvt_pk_bf16_f32 v207, v2, v3
  s_nop 1
  v_permlane16_swap_b32 v204, v206
  v_permlane16_swap_b32 v205, v207
  buffer_store_dwordx4 v[204:207], v213, s[20:23], s31 offen sc1
  s_add_u32 s31, s31, 32768
  v_pk_add_f32 v[136:137], v[136:137], v[192:193]
  v_pk_add_f32 v[138:139], v[138:139], v[194:195]
  v_lshlrev_b32 v2, 16, v164
  v_and_b32 v3, 0xffff0000, v164
  v_fma_f32 v2, v136, v203, v2
  v_fma_f32 v3, v137, v203, v3
  v_cvt_pk_bf16_f32 v208, v2, v3
  v_lshlrev_b32 v2, 16, v165
  v_and_b32 v3, 0xffff0000, v165
  v_fma_f32 v2, v138, v203, v2
  v_fma_f32 v3, v139, v203, v3
  v_cvt_pk_bf16_f32 v209, v2, v3
  v_pk_add_f32 v[140:141], v[140:141], v[196:197]
  v_pk_add_f32 v[142:143], v[142:143], v[198:199]
  v_lshlrev_b32 v2, 16, v166
  v_and_b32 v3, 0xffff0000, v166
  v_fma_f32 v2, v140, v203, v2
  v_fma_f32 v3, v141, v203, v3
  v_cvt_pk_bf16_f32 v210, v2, v3
  v_lshlrev_b32 v2, 16, v167
  v_and_b32 v3, 0xffff0000, v167
  v_fma_f32 v2, v142, v203, v2
  v_fma_f32 v3, v143, v203, v3
  v_cvt_pk_bf16_f32 v211, v2, v3
  s_nop 1
  v_permlane16_swap_b32 v208, v210
  v_permlane16_swap_b32 v209, v211
  buffer_store_dwordx4 v[208:211], v213, s[20:23], s31 offen sc1
  s_branch L_end
L_loader:
  s_setprio 3
  s_lshl_b32 s69, s70, 5
  v_lshrrev_b32 v12, 3, v1
  v_add_u32 v12, s69, v12
  v_lshlrev_b32 v12, 11, v12
  v_and_b32 v7, 7, v1
  v_lshrrev_b32 v6, 4, v1
  v_xor_b32 v7, v7, v6
  v_lshlrev_b32 v7, 4, v7
  v_add_u32 v12, v12, v7
  v_xor_b32 v13, 64, v12
  v_add_u32 v14, 30720, v12
  v_add_u32 v15, 46080, v13
  v_add_u32 v13, 15360, v13
  s_mul_i32 s32, s28, 262144
  s_mul_i32 s69, s70, 0x180
  v_add_u32 v9, s69, v1
  v_mul_u32_u24 v8, 0xaab, v9
  v_lshrrev_b32 v8, 16, v8
  v_mul_u32_u24 v7, 24, v8
  v_sub_u32 v9, v9, v7
  v_lshrrev_b32 v7, 1, v8
  v_and_b32 v7, 1, v7
  v_lshrrev_b32 v6, 3, v8
  v_and_b32 v6, 1, v6
  v_lshlrev_b32 v6, 1, v6
  v_or_b32 v7, v7, v6
  v_lshlrev_b32 v7, 1, v7
  v_xor_b32 v9, v9, v7
  v_mul_u32_u24 v16, 0x1800, v8
  v_lshrrev_b32 v7, 3, v9
  v_lshlrev_b32 v7, 11, v7
  v_and_b32 v6, 7, v9
  v_lshlrev_b32 v6, 4, v6
  v_add_u32 v7, v7, v6
  v_add_u32 v16, v16, v7
  s_mul_i32 s68, s70, 0x180
  s_add_u32 s69, s68, 64
  v_add_u32 v9, s69, v1
  v_mul_u32_u24 v8, 0xaab, v9
  v_lshrrev_b32 v8, 16, v8
  v_mul_u32_u24 v7, 24, v8
  v_sub_u32 v9, v9, v7
  v_lshrrev_b32 v7, 1, v8
  v_and_b32 v7, 1, v7
  v_lshrrev_b32 v6, 3, v8
  v_and_b32 v6, 1, v6
  v_lshlrev_b32 v6, 1, v6
  v_or_b32 v7, v7, v6
  v_lshlrev_b32 v7, 1, v7
  v_xor_b32 v9, v9, v7
  v_mul_u32_u24 v17, 0x1800, v8
  v_lshrrev_b32 v7, 3, v9
  v_lshlrev_b32 v7, 11, v7
  v_and_b32 v6, 7, v9
  v_lshlrev_b32 v6, 4, v6
  v_add_u32 v7, v7, v6
  v_add_u32 v17, v17, v7
  v_subrev_u32 v17, 0x400, v17
  s_mul_i32 s68, s70, 0x180
  s_add_u32 s69, s68, 0x80
  v_add_u32 v9, s69, v1
  v_mul_u32_u24 v8, 0xaab, v9
  v_lshrrev_b32 v8, 16, v8
  v_mul_u32_u24 v7, 24, v8
  v_sub_u32 v9, v9, v7
  v_lshrrev_b32 v7, 1, v8
  v_and_b32 v7, 1, v7
  v_lshrrev_b32 v6, 3, v8
  v_and_b32 v6, 1, v6
  v_lshlrev_b32 v6, 1, v6
  v_or_b32 v7, v7, v6
  v_lshlrev_b32 v7, 1, v7
  v_xor_b32 v9, v9, v7
  v_mul_u32_u24 v18, 0x1800, v8
  v_lshrrev_b32 v7, 3, v9
  v_lshlrev_b32 v7, 11, v7
  v_and_b32 v6, 7, v9
  v_lshlrev_b32 v6, 4, v6
  v_add_u32 v7, v7, v6
  v_add_u32 v18, v18, v7
  v_subrev_u32 v18, 0x800, v18
  s_mul_i32 s68, s70, 0x180
  s_add_u32 s69, s68, 0xc0
  v_add_u32 v9, s69, v1
  v_mul_u32_u24 v8, 0xaab, v9
  v_lshrrev_b32 v8, 16, v8
  v_mul_u32_u24 v7, 24, v8
  v_sub_u32 v9, v9, v7
  v_lshrrev_b32 v7, 1, v8
  v_and_b32 v7, 1, v7
  v_lshrrev_b32 v6, 3, v8
  v_and_b32 v6, 1, v6
  v_lshlrev_b32 v6, 1, v6
  v_or_b32 v7, v7, v6
  v_lshlrev_b32 v7, 1, v7
  v_xor_b32 v9, v9, v7
  v_mul_u32_u24 v19, 0x1800, v8
  v_lshrrev_b32 v7, 3, v9
  v_lshlrev_b32 v7, 11, v7
  v_and_b32 v6, 7, v9
  v_lshlrev_b32 v6, 4, v6
  v_add_u32 v7, v7, v6
  v_add_u32 v19, v19, v7
  v_subrev_u32 v19, 0xc00, v19
  s_mul_i32 s68, s70, 0x180
  s_add_u32 s69, s68, 0x100
  v_add_u32 v9, s69, v1
  v_mul_u32_u24 v8, 0xaab, v9
  v_lshrrev_b32 v8, 16, v8
  v_mul_u32_u24 v7, 24, v8
  v_sub_u32 v9, v9, v7
  v_lshrrev_b32 v7, 1, v8
  v_and_b32 v7, 1, v7
  v_lshrrev_b32 v6, 3, v8
  v_and_b32 v6, 1, v6
  v_lshlrev_b32 v6, 1, v6
  v_or_b32 v7, v7, v6
  v_lshlrev_b32 v7, 1, v7
  v_xor_b32 v9, v9, v7
  v_mul_u32_u24 v20, 0x1800, v8
  v_lshrrev_b32 v7, 3, v9
  v_lshlrev_b32 v7, 11, v7
  v_and_b32 v6, 7, v9
  v_lshlrev_b32 v6, 4, v6
  v_add_u32 v7, v7, v6
  v_add_u32 v20, v20, v7
  s_mul_i32 s68, s70, 0x180
  s_add_u32 s69, s68, 0x140
  v_add_u32 v9, s69, v1
  v_mul_u32_u24 v8, 0xaab, v9
  v_lshrrev_b32 v8, 16, v8
  v_mul_u32_u24 v7, 24, v8
  v_sub_u32 v9, v9, v7
  v_lshrrev_b32 v7, 1, v8
  v_and_b32 v7, 1, v7
  v_lshrrev_b32 v6, 3, v8
  v_and_b32 v6, 1, v6
  v_lshlrev_b32 v6, 1, v6
  v_or_b32 v7, v7, v6
  v_lshlrev_b32 v7, 1, v7
  v_xor_b32 v9, v9, v7
  v_mul_u32_u24 v21, 0x1800, v8
  v_lshrrev_b32 v7, 3, v9
  v_lshlrev_b32 v7, 11, v7
  v_and_b32 v6, 7, v9
  v_lshlrev_b32 v6, 4, v6
  v_add_u32 v7, v7, v6
  v_add_u32 v21, v21, v7
  v_subrev_u32 v21, 0x400, v21
  s_lshl_b32 s33, s29, 7
  s_lshl_b32 s37, s70, 12
  s_mul_i32 s38, s70, 6144
  s_add_u32 s38, s38, 16384
  s_waitcnt lgkmcnt(0)
  s_mov_b32 s4, s44
  s_mov_b32 s5, s45
  s_mov_b32 s6, 4194304
  s_mov_b32 s7, 0x20000
  s_mov_b32 s8, s46
  s_mov_b32 s9, s47
  s_mov_b32 s10, 6291456
  s_mov_b32 s11, 0x20000
  s_mov_b32 s72, s32
  s_mov_b32 s73, s33
  s_mov_b32 s35, 0
  s_mov_b32 s75, 0
  s_cmp_ge_u32 s75, s28
  s_addc_u32 s75, s75, 0
  s_mul_i32 s32, s75, 128
  s_add_u32 s32, s32, s72
  s_mul_i32 s33, s75, 393216
  s_add_u32 s33, s33, s73
  s_add_u32 m0, s35, s37
  s_nop 0
  buffer_load_dwordx4 v12, s[4:7], s32 offen offset:0  lds
  buffer_load_dwordx4 v13, s[4:7], s32 offen offset:1024  lds
  buffer_load_dwordx4 v14, s[4:7], s32 offen offset:2048  lds
  buffer_load_dwordx4 v15, s[4:7], s32 offen offset:3072  lds
  s_add_u32 s31, s35, s38
  s_add_u32 m0, s31, 0
  s_nop 0
  buffer_load_dwordx4 v16, s[8:11], s33 offen offset:0 lds
  buffer_load_dwordx4 v17, s[8:11], s33 offen offset:1024 lds
  buffer_load_dwordx4 v18, s[8:11], s33 offen offset:2048 lds
  buffer_load_dwordx4 v19, s[8:11], s33 offen offset:3072 lds
  s_add_u32 s31, s35, s38
  s_add_u32 m0, s31, 4096
  s_nop 0
  buffer_load_dwordx4 v20, s[8:11], s33 offen offset:0 lds
  buffer_load_dwordx4 v21, s[8:11], s33 offen offset:1024 lds
  s_add_u32 s35, s35, 40960
  s_setprio 1
  s_mov_b32 s75, 1
  s_cmp_ge_u32 s75, s28
  s_addc_u32 s75, s75, 0
  s_mul_i32 s32, s75, 128
  s_add_u32 s32, s32, s72
  s_mul_i32 s33, s75, 393216
  s_add_u32 s33, s33, s73
  s_add_u32 m0, s35, s37
  s_nop 0
  buffer_load_dwordx4 v12, s[4:7], s32 offen offset:0  lds
  buffer_load_dwordx4 v13, s[4:7], s32 offen offset:1024  lds
  buffer_load_dwordx4 v14, s[4:7], s32 offen offset:2048  lds
  buffer_load_dwordx4 v15, s[4:7], s32 offen offset:3072  lds
  s_add_u32 s31, s35, s38
  s_add_u32 m0, s31, 0
  s_nop 0
  buffer_load_dwordx4 v16, s[8:11], s33 offen offset:0 lds
  buffer_load_dwordx4 v17, s[8:11], s33 offen offset:1024 lds
  buffer_load_dwordx4 v18, s[8:11], s33 offen offset:2048 lds
  buffer_load_dwordx4 v19, s[8:11], s33 offen offset:3072 lds
  s_add_u32 s31, s35, s38
  s_add_u32 m0, s31, 4096
  s_nop 0
  buffer_load_dwordx4 v20, s[8:11], s33 offen offset:0 lds
  buffer_load_dwordx4 v21, s[8:11], s33 offen offset:1024 lds
  s_add_u32 s35, s35, 40960
  s_mov_b32 s12, s60
  s_mov_b32 s13, s61
  s_mov_b32 s14, 58720256
  s_mov_b32 s15, 0x20000
  s_mov_b32 s16, s58
  s_mov_b32 s17, s59
  s_mov_b32 s18, 256
  s_mov_b32 s19, 0x20000
  v_lshlrev_b32 v2, 2, v1
  v_add_u32 v2, 163712, v2
  v_cmp_gt_u32 vcc, 8, v1
  s_and_saveexec_b64 s[62:63], vcc
  ds_write_b32 v2, v11
  s_mov_b64 exec, s[62:63]
  v_mov_b32 v64, 0x3f803f80
  v_mov_b32 v65, 0x3f803f80
  v_mov_b32 v66, 0x3f803f80
  v_mov_b32 v67, 0x3f803f80
  s_waitcnt vmcnt(10)
  s_waitcnt lgkmcnt(0)
  s_barrier
  s_mov_b32 s75, s28
  s_mul_i32 s32, s75, 128
  s_add_u32 s32, s32, s72
  s_mul_i32 s33, s75, 393216
  s_add_u32 s33, s33, s73
  s_add_u32 m0, s35, s37
  s_nop 0
  buffer_load_dwordx4 v12, s[4:7], s32 offen offset:0  lds
  buffer_load_dwordx4 v13, s[4:7], s32 offen offset:1024  lds
  buffer_load_dwordx4 v14, s[4:7], s32 offen offset:2048  lds
  buffer_load_dwordx4 v15, s[4:7], s32 offen offset:3072  lds
  s_add_u32 s31, s35, s38
  s_add_u32 m0, s31, 0
  s_nop 0
  buffer_load_dwordx4 v16, s[8:11], s33 offen offset:0 lds
  buffer_load_dwordx4 v17, s[8:11], s33 offen offset:1024 lds
  buffer_load_dwordx4 v18, s[8:11], s33 offen offset:2048 lds
  buffer_load_dwordx4 v19, s[8:11], s33 offen offset:3072 lds
  s_add_u32 s31, s35, s38
  s_add_u32 m0, s31, 4096
  s_nop 0
  buffer_load_dwordx4 v20, s[8:11], s33 offen offset:0 lds
  buffer_load_dwordx4 v21, s[8:11], s33 offen offset:1024 lds
  s_mov_b32 s35, 0
  v_lshlrev_b32 v156, 2, v1
  v_lshrrev_b32 v8, 4, v1
  v_lshlrev_b32 v8, 3, v8
  v_lshrrev_b32 v7, 2, v1
  v_and_b32 v7, 3, v7
  v_add_u32 v8, v8, v7
  v_mul_u32_u24 v8, 0x180, v8
  v_and_b32 v7, 1, v1
  v_lshlrev_b32 v7, 3, v7
  v_add_u32 v8, v8, v7
  v_add_u32 v8, 0x4000, v8
  v_add_u32 v8, 0x14000, v8
  v_lshrrev_b32 v9, 4, v1
  v_lshlrev_b32 v9, 3, v9
  v_lshrrev_b32 v7, 2, v1
  v_and_b32 v7, 3, v7
  v_add_u32 v9, v9, v7
  v_lshrrev_b32 v9, 1, v9
  v_and_b32 v9, 1, v9
  v_lshrrev_b32 v7, 4, v1
  v_lshlrev_b32 v7, 3, v7
  v_lshrrev_b32 v6, 2, v1
  v_and_b32 v6, 3, v6
  v_add_u32 v7, v7, v6
  v_lshrrev_b32 v7, 3, v7
  v_and_b32 v7, 1, v7
  v_lshlrev_b32 v7, 1, v7
  v_or_b32 v9, v9, v7
  v_lshlrev_b32 v9, 1, v9
  s_mul_i32 s68, s70, 3
  s_lshl_b32 s69, s68, 1
  v_lshrrev_b32 v7, 1, v1
  v_and_b32 v7, 1, v7
  v_add_u32 v7, s69, v7
  v_xor_b32 v7, v7, v9
  v_lshlrev_b32 v7, 4, v7
  v_add_u32 v157, v8, v7
  s_mul_i32 s67, s70, 3
  s_add_u32 s68, s67, 1
  s_lshl_b32 s69, s68, 1
  v_lshrrev_b32 v7, 1, v1
  v_and_b32 v7, 1, v7
  v_add_u32 v7, s69, v7
  v_xor_b32 v7, v7, v9
  v_lshlrev_b32 v7, 4, v7
  v_add_u32 v158, v8, v7
  s_mul_i32 s67, s70, 3
  s_add_u32 s68, s67, 2
  s_lshl_b32 s69, s68, 1
  v_lshrrev_b32 v7, 1, v1
  v_and_b32 v7, 1, v7
  v_add_u32 v7, s69, v7
  v_xor_b32 v7, v7, v9
  v_lshlrev_b32 v7, 4, v7
  v_add_u32 v159, v8, v7
  s_waitcnt vmcnt(10)
  s_waitcnt lgkmcnt(0)
  s_barrier
  s_mov_b32 s75, 2
  s_cmp_ge_u32 s75, s28
  s_addc_u32 s75, s75, 0
  s_mul_i32 s32, s75, 128
  s_add_u32 s32, s32, s72
  s_mul_i32 s33, s75, 393216
  s_add_u32 s33, s33, s73
  s_add_u32 m0, s35, s37
  s_nop 0
  buffer_load_dwordx4 v12, s[4:7], s32 offen offset:0  lds
  buffer_load_dwordx4 v13, s[4:7], s32 offen offset:1024  lds
  buffer_load_dwordx4 v14, s[4:7], s32 offen offset:2048  lds
  buffer_load_dwordx4 v15, s[4:7], s32 offen offset:3072  lds
  s_add_u32 s31, s35, s38
  s_add_u32 m0, s31, 0
  s_nop 0
  buffer_load_dwordx4 v16, s[8:11], s33 offen offset:0 lds
  buffer_load_dwordx4 v17, s[8:11], s33 offen offset:1024 lds
  buffer_load_dwordx4 v18, s[8:11], s33 offen offset:2048 lds
  buffer_load_dwordx4 v19, s[8:11], s33 offen offset:3072 lds
  s_add_u32 s31, s35, s38
  s_add_u32 m0, s31, 4096
  s_nop 0
  buffer_load_dwordx4 v20, s[8:11], s33 offen offset:0 lds
  buffer_load_dwordx4 v21, s[8:11], s33 offen offset:1024 lds
  s_add_u32 s35, s35, 40960
  s_cmp_eq_u32 s35, 122880
  s_cselect_b32 s35, 0, s35
  buffer_load_dword v120, v11, s[16:19], 0 offen sc1
  s_waitcnt vmcnt(11)
  s_waitcnt lgkmcnt(0)
  s_waitcnt lgkmcnt(0)
  s_barrier
  s_mov_b32 s75, 3
  s_cmp_ge_u32 s75, s28
  s_addc_u32 s75, s75, 0
  s_mul_i32 s32, s75, 128
  s_add_u32 s32, s32, s72
  s_mul_i32 s33, s75, 393216
  s_add_u32 s33, s33, s73
  s_add_u32 m0, s35, s37
  s_nop 0
  buffer_load_dwordx4 v12, s[4:7], s32 offen offset:0  lds
  buffer_load_dwordx4 v13, s[4:7], s32 offen offset:1024  lds
  buffer_load_dwordx4 v14, s[4:7], s32 offen offset:2048  lds
  buffer_load_dwordx4 v15, s[4:7], s32 offen offset:3072  lds
  s_add_u32 s31, s35, s38
  s_add_u32 m0, s31, 0
  s_nop 0
  buffer_load_dwordx4 v16, s[8:11], s33 offen offset:0 lds
  buffer_load_dwordx4 v17, s[8:11], s33 offen offset:1024 lds
  buffer_load_dwordx4 v18, s[8:11], s33 offen offset:2048 lds
  buffer_load_dwordx4 v19, s[8:11], s33 offen offset:3072 lds
  s_add_u32 s31, s35, s38
  s_add_u32 m0, s31, 4096
  s_nop 0
  buffer_load_dwordx4 v20, s[8:11], s33 offen offset:0 lds
  buffer_load_dwordx4 v21, s[8:11], s33 offen offset:1024 lds
  s_add_u32 s35, s35, 40960
  s_cmp_eq_u32 s35, 122880
  s_cselect_b32 s35, 0, s35
  ds_read_b64_tr_b16 v[68:69], v157 offset:0
  ds_read_b64_tr_b16 v[70:71], v157 offset:1536
  ds_read_b64_tr_b16 v[72:73], v157 offset:12288
  ds_read_b64_tr_b16 v[74:75], v157 offset:13824
  ds_read_b64_tr_b16 v[76:77], v158 offset:0
  ds_read_b64_tr_b16 v[78:79], v158 offset:1536
  ds_read_b64_tr_b16 v[80:81], v158 offset:12288
  ds_read_b64_tr_b16 v[82:83], v158 offset:13824
  ds_read_b64_tr_b16 v[84:85], v159 offset:0
  ds_read_b64_tr_b16 v[86:87], v159 offset:1536
  ds_read_b64_tr_b16 v[88:89], v159 offset:12288
  ds_read_b64_tr_b16 v[90:91], v159 offset:13824
  s_waitcnt vmcnt(11)
  s_waitcnt lgkmcnt(0)
  s_waitcnt lgkmcnt(0)
  s_barrier
  s_mov_b32 s75, 4
  s_cmp_ge_u32 s75, s28
  s_addc_u32 s75, s75, 0
  s_mul_i32 s32, s75, 128
  s_add_u32 s32, s32, s72
  s_mul_i32 s33, s75, 393216
  s_add_u32 s33, s33, s73
  s_add_u32 m0, s35, s37
  s_nop 0
  buffer_load_dwordx4 v12, s[4:7], s32 offen offset:0  lds
  buffer_load_dwordx4 v13, s[4:7], s32 offen offset:1024  lds
  buffer_load_dwordx4 v14, s[4:7], s32 offen offset:2048  lds
  buffer_load_dwordx4 v15, s[4:7], s32 offen offset:3072  lds
  s_add_u32 s31, s35, s38
  s_add_u32 m0, s31, 0
  s_nop 0
  buffer_load_dwordx4 v16, s[8:11], s33 offen offset:0 lds
  buffer_load_dwordx4 v17, s[8:11], s33 offen offset:1024 lds
  buffer_load_dwordx4 v18, s[8:11], s33 offen offset:2048 lds
  buffer_load_dwordx4 v19, s[8:11], s33 offen offset:3072 lds
  s_add_u32 s31, s35, s38
  s_add_u32 m0, s31, 4096
  s_nop 0
  buffer_load_dwordx4 v20, s[8:11], s33 offen offset:0 lds
  buffer_load_dwordx4 v21, s[8:11], s33 offen offset:1024 lds
  s_add_u32 s35, s35, 40960
  s_cmp_eq_u32 s35, 122880
  s_cselect_b32 s35, 0, s35
  v_mov_b32 v64, 0x3f803f80
  v_mov_b32 v65, 0x3f803f80
  v_mov_b32 v66, 0x3f803f80
  v_mov_b32 v67, 0x3f803f80
  s_lshl_b32 s31, s28, 4
  s_add_u32 s31, s31, s29
  s_mul_i32 s39, s31, 768
  s_mul_i32 s31, s70, 192
  s_add_u32 s39, s39, s31
  s_add_u32 s39, s39, 37814272
  v_mfma_f32_16x16x32_bf16 v[100:103], v[64:67], v[68:71], 0
  v_mfma_f32_16x16x32_bf16 v[104:107], v[64:67], v[76:79], 0
  v_mfma_f32_16x16x32_bf16 v[108:111], v[64:67], v[84:87], 0
  v_mfma_f32_16x16x32_bf16 v[100:103], v[64:67], v[72:75], v[100:103]
  v_mfma_f32_16x16x32_bf16 v[104:107], v[64:67], v[80:83], v[104:107]
  v_mfma_f32_16x16x32_bf16 v[108:111], v[64:67], v[88:91], v[108:111]
  v_cmp_gt_u32 vcc, 16, v1
  s_nop 7
  s_and_saveexec_b64 s[62:63], vcc
  buffer_store_dword v100, v156, s[12:15], s39 offen offset:0 sc1
  buffer_store_dword v104, v156, s[12:15], s39 offen offset:64 sc1
  buffer_store_dword v108, v156, s[12:15], s39 offen offset:128 sc1
  s_mov_b64 exec, s[62:63]
  s_waitcnt vmcnt(23)
  v_cmp_ne_u32 vcc, 0, v120
  s_nop 4
  s_cmp_eq_u64 vcc, exec
  s_cbranch_scc1 L_tokready
  s_mov_b32 s36, 400000
L_poll_tok:
  buffer_load_dword v120, v11, s[16:19], 0 offen sc1
  s_waitcnt vmcnt(0)
  v_cmp_ne_u32 vcc, 0, v120
  s_nop 4
  s_cmp_eq_u64 vcc, exec
  s_cbranch_scc1 L_polldone_tok
  s_sleep 4
  s_sub_u32 s36, s36, 1
  s_cmp_lg_u32 s36, 0
  s_cbranch_scc1 L_poll_tok
L_polldone_tok:
L_tokready:
  v_readfirstlane_b32 s1, v120
  v_mov_b32 v121, 163744
  ds_write_b32 v121, v120
  s_waitcnt vmcnt(13)
  s_waitcnt lgkmcnt(0)
  s_waitcnt lgkmcnt(0)
  s_barrier
  s_mov_b32 s75, 5
  s_cmp_ge_u32 s75, s28
  s_addc_u32 s75, s75, 0
  s_mul_i32 s32, s75, 128
  s_add_u32 s32, s32, s72
  s_mul_i32 s33, s75, 393216
  s_add_u32 s33, s33, s73
  s_add_u32 m0, s35, s37
  s_nop 0
  buffer_load_dwordx4 v12, s[4:7], s32 offen offset:0  lds
  buffer_load_dwordx4 v13, s[4:7], s32 offen offset:1024  lds
  buffer_load_dwordx4 v14, s[4:7], s32 offen offset:2048  lds
  buffer_load_dwordx4 v15, s[4:7], s32 offen offset:3072  lds
  s_add_u32 s31, s35, s38
  s_add_u32 m0, s31, 0
  s_nop 0
  buffer_load_dwordx4 v16, s[8:11], s33 offen offset:0 lds
  buffer_load_dwordx4 v17, s[8:11], s33 offen offset:1024 lds
  buffer_load_dwordx4 v18, s[8:11], s33 offen offset:2048 lds
  buffer_load_dwordx4 v19, s[8:11], s33 offen offset:3072 lds
  s_add_u32 s31, s35, s38
  s_add_u32 m0, s31, 4096
  s_nop 0
  buffer_load_dwordx4 v20, s[8:11], s33 offen offset:0 lds
  buffer_load_dwordx4 v21, s[8:11], s33 offen offset:1024 lds
  s_add_u32 s35, s35, 40960
  s_cmp_eq_u32 s35, 122880
  s_cselect_b32 s35, 0, s35
  s_waitcnt vmcnt(13)
  s_waitcnt lgkmcnt(0)
  s_waitcnt lgkmcnt(0)
  s_barrier
  s_mov_b32 s75, 6
  s_cmp_ge_u32 s75, s28
  s_addc_u32 s75, s75, 0
  s_mul_i32 s32, s75, 128
  s_add_u32 s32, s32, s72
  s_mul_i32 s33, s75, 393216
  s_add_u32 s33, s33, s73
  s_add_u32 m0, s35, s37
  s_nop 0
  buffer_load_dwordx4 v12, s[4:7], s32 offen offset:0  lds
  buffer_load_dwordx4 v13, s[4:7], s32 offen offset:1024  lds
  buffer_load_dwordx4 v14, s[4:7], s32 offen offset:2048  lds
  buffer_load_dwordx4 v15, s[4:7], s32 offen offset:3072  lds
  s_add_u32 s31, s35, s38
  s_add_u32 m0, s31, 0
  s_nop 0
  buffer_load_dwordx4 v16, s[8:11], s33 offen offset:0 lds
  buffer_load_dwordx4 v17, s[8:11], s33 offen offset:1024 lds
  buffer_load_dwordx4 v18, s[8:11], s33 offen offset:2048 lds
  buffer_load_dwordx4 v19, s[8:11], s33 offen offset:3072 lds
  s_add_u32 s31, s35, s38
  s_add_u32 m0, s31, 4096
  s_nop 0
  buffer_load_dwordx4 v20, s[8:11], s33 offen offset:0 lds
  buffer_load_dwordx4 v21, s[8:11], s33 offen offset:1024 lds
  s_add_u32 s35, s35, 40960
  s_cmp_eq_u32 s35, 122880
  s_cselect_b32 s35, 0, s35
  s_waitcnt vmcnt(10)
  s_waitcnt lgkmcnt(0)
  s_waitcnt lgkmcnt(0)
  s_barrier
  s_mov_b32 s75, 7
  s_cmp_ge_u32 s75, s28
  s_addc_u32 s75, s75, 0
  s_mul_i32 s32, s75, 128
  s_add_u32 s32, s32, s72
  s_mul_i32 s33, s75, 393216
  s_add_u32 s33, s33, s73
  s_add_u32 m0, s35, s37
  s_nop 0
  buffer_load_dwordx4 v12, s[4:7], s32 offen offset:0  lds
  buffer_load_dwordx4 v13, s[4:7], s32 offen offset:1024  lds
  buffer_load_dwordx4 v14, s[4:7], s32 offen offset:2048  lds
  buffer_load_dwordx4 v15, s[4:7], s32 offen offset:3072  lds
  s_add_u32 s31, s35, s38
  s_add_u32 m0, s31, 0
  s_nop 0
  buffer_load_dwordx4 v16, s[8:11], s33 offen offset:0 lds
  buffer_load_dwordx4 v17, s[8:11], s33 offen offset:1024 lds
  buffer_load_dwordx4 v18, s[8:11], s33 offen offset:2048 lds
  buffer_load_dwordx4 v19, s[8:11], s33 offen offset:3072 lds
  s_add_u32 s31, s35, s38
  s_add_u32 m0, s31, 4096
  s_nop 0
  buffer_load_dwordx4 v20, s[8:11], s33 offen offset:0 lds
  buffer_load_dwordx4 v21, s[8:11], s33 offen offset:1024 lds
  s_add_u32 s35, s35, 40960
  s_cmp_eq_u32 s35, 122880
  s_cselect_b32 s35, 0, s35
  s_lshl_b32 s31, s28, 4
  s_add_u32 s31, s31, s29
  s_lshl_b32 s31, s31, 7
  s_add_u32 s31, s31, 54657024
  s_cmp_eq_u32 s70, 0
  s_cselect_b32 s31, s31, 0x7ffffff0
  v_mov_b32 v117, 0x7ffffff0
  v_writelane_b32 v117, s31, 0
  v_mov_b32 v116, s1
  buffer_store_dword v116, v117, s[12:15], 0 offen sc1
  s_waitcnt vmcnt(11)
  s_waitcnt lgkmcnt(0)
  s_waitcnt lgkmcnt(0)
  s_barrier
  s_mov_b32 s75, 8
  s_cmp_ge_u32 s75, s28
  s_addc_u32 s75, s75, 0
  s_mul_i32 s32, s75, 128
  s_add_u32 s32, s32, s72
  s_mul_i32 s33, s75, 393216
  s_add_u32 s33, s33, s73
  s_add_u32 m0, s35, s37
  s_nop 0
  buffer_load_dwordx4 v12, s[4:7], s32 offen offset:0  lds
  buffer_load_dwordx4 v13, s[4:7], s32 offen offset:1024  lds
  buffer_load_dwordx4 v14, s[4:7], s32 offen offset:2048  lds
  buffer_load_dwordx4 v15, s[4:7], s32 offen offset:3072  lds
  s_add_u32 s31, s35, s38
  s_add_u32 m0, s31, 0
  s_nop 0
  buffer_load_dwordx4 v16, s[8:11], s33 offen offset:0 lds
  buffer_load_dwordx4 v17, s[8:11], s33 offen offset:1024 lds
  buffer_load_dwordx4 v18, s[8:11], s33 offen offset:2048 lds
  buffer_load_dwordx4 v19, s[8:11], s33 offen offset:3072 lds
  s_add_u32 s31, s35, s38
  s_add_u32 m0, s31, 4096
  s_nop 0
  buffer_load_dwordx4 v20, s[8:11], s33 offen offset:0 lds
  buffer_load_dwordx4 v21, s[8:11], s33 offen offset:1024 lds
  s_add_u32 s35, s35, 40960
  s_cmp_eq_u32 s35, 122880
  s_cselect_b32 s35, 0, s35
  s_waitcnt vmcnt(11)
  s_waitcnt lgkmcnt(0)
  s_waitcnt lgkmcnt(0)
  s_barrier
  s_mov_b32 s75, 9
  s_cmp_ge_u32 s75, s28
  s_addc_u32 s75, s75, 0
  s_mul_i32 s32, s75, 128
  s_add_u32 s32, s32, s72
  s_mul_i32 s33, s75, 393216
  s_add_u32 s33, s33, s73
  s_add_u32 m0, s35, s37
  s_nop 0
  buffer_load_dwordx4 v12, s[4:7], s32 offen offset:0  lds
  buffer_load_dwordx4 v13, s[4:7], s32 offen offset:1024  lds
  buffer_load_dwordx4 v14, s[4:7], s32 offen offset:2048  lds
  buffer_load_dwordx4 v15, s[4:7], s32 offen offset:3072  lds
  s_add_u32 s31, s35, s38
  s_add_u32 m0, s31, 0
  s_nop 0
  buffer_load_dwordx4 v16, s[8:11], s33 offen offset:0 lds
  buffer_load_dwordx4 v17, s[8:11], s33 offen offset:1024 lds
  buffer_load_dwordx4 v18, s[8:11], s33 offen offset:2048 lds
  buffer_load_dwordx4 v19, s[8:11], s33 offen offset:3072 lds
  s_add_u32 s31, s35, s38
  s_add_u32 m0, s31, 4096
  s_nop 0
  buffer_load_dwordx4 v20, s[8:11], s33 offen offset:0 lds
  buffer_load_dwordx4 v21, s[8:11], s33 offen offset:1024 lds
  s_add_u32 s35, s35, 40960
  s_cmp_eq_u32 s35, 122880
  s_cselect_b32 s35, 0, s35
  s_waitcnt vmcnt(10)
  s_waitcnt lgkmcnt(0)
  s_waitcnt lgkmcnt(0)
  s_barrier
  s_mov_b32 s75, 10
  s_cmp_ge_u32 s75, s28
  s_addc_u32 s75, s75, 0
  s_mul_i32 s32, s75, 128
  s_add_u32 s32, s32, s72
  s_mul_i32 s33, s75, 393216
  s_add_u32 s33, s33, s73
  s_add_u32 m0, s35, s37
  s_nop 0
  buffer_load_dwordx4 v12, s[4:7], s32 offen offset:0  lds
  buffer_load_dwordx4 v13, s[4:7], s32 offen offset:1024  lds
  buffer_load_dwordx4 v14, s[4:7], s32 offen offset:2048  lds
  buffer_load_dwordx4 v15, s[4:7], s32 offen offset:3072  lds
  s_add_u32 s31, s35, s38
  s_add_u32 m0, s31, 0
  s_nop 0
  buffer_load_dwordx4 v16, s[8:11], s33 offen offset:0 lds
  buffer_load_dwordx4 v17, s[8:11], s33 offen offset:1024 lds
  buffer_load_dwordx4 v18, s[8:11], s33 offen offset:2048 lds
  buffer_load_dwordx4 v19, s[8:11], s33 offen offset:3072 lds
  s_add_u32 s31, s35, s38
  s_add_u32 m0, s31, 4096
  s_nop 0
  buffer_load_dwordx4 v20, s[8:11], s33 offen offset:0 lds
  buffer_load_dwordx4 v21, s[8:11], s33 offen offset:1024 lds
  s_add_u32 s35, s35, 40960
  s_cmp_eq_u32 s35, 122880
  s_cselect_b32 s35, 0, s35
  s_waitcnt vmcnt(10)
  s_waitcnt lgkmcnt(0)
  s_waitcnt lgkmcnt(0)
  s_barrier
  s_mov_b32 s75, 11
  s_cmp_ge_u32 s75, s28
  s_addc_u32 s75, s75, 0
  s_mul_i32 s32, s75, 128
  s_add_u32 s32, s32, s72
  s_mul_i32 s33, s75, 393216
  s_add_u32 s33, s33, s73
  s_add_u32 m0, s35, s37
  s_nop 0
  buffer_load_dwordx4 v12, s[4:7], s32 offen offset:0  lds
  buffer_load_dwordx4 v13, s[4:7], s32 offen offset:1024  lds
  buffer_load_dwordx4 v14, s[4:7], s32 offen offset:2048  lds
  buffer_load_dwordx4 v15, s[4:7], s32 offen offset:3072  lds
  s_add_u32 s31, s35, s38
  s_add_u32 m0, s31, 0
  s_nop 0
  buffer_load_dwordx4 v16, s[8:11], s33 offen offset:0 lds
  buffer_load_dwordx4 v17, s[8:11], s33 offen offset:1024 lds
  buffer_load_dwordx4 v18, s[8:11], s33 offen offset:2048 lds
  buffer_load_dwordx4 v19, s[8:11], s33 offen offset:3072 lds
  s_add_u32 s31, s35, s38
  s_add_u32 m0, s31, 4096
  s_nop 0
  buffer_load_dwordx4 v20, s[8:11], s33 offen offset:0 lds
  buffer_load_dwordx4 v21, s[8:11], s33 offen offset:1024 lds
  s_add_u32 s35, s35, 40960
  s_cmp_eq_u32 s35, 122880
  s_cselect_b32 s35, 0, s35
  v_and_b32 v2, 15, v1
  s_lshl_b32 s31, s28, 4
  v_add_u32 v3, s31, v2
  v_lshlrev_b32 v2, 4, v2
  v_add_u32 v2, s29, v2
  v_and_b32 v123, 16, v1
  v_cmp_eq_u32 vcc, 0, v123
  s_nop 1
  v_cndmask_b32 v123, v2, v3, vcc
  v_lshlrev_b32 v123, 7, v123
  v_add_u32 v123, 54657024, v123
  buffer_load_dword v122, v123, s[12:15], 0 offen sc1
  s_waitcnt vmcnt(11)
  s_waitcnt lgkmcnt(0)
  s_waitcnt lgkmcnt(0)
  s_barrier
  s_mov_b32 s75, 12
  s_cmp_ge_u32 s75, s28
  s_addc_u32 s75, s75, 0
  s_mul_i32 s32, s75, 128
  s_add_u32 s32, s32, s72
  s_mul_i32 s33, s75, 393216
  s_add_u32 s33, s33, s73
  s_add_u32 m0, s35, s37
  s_nop 0
  buffer_load_dwordx4 v12, s[4:7], s32 offen offset:0  lds
  buffer_load_dwordx4 v13, s[4:7], s32 offen offset:1024  lds
  buffer_load_dwordx4 v14, s[4:7], s32 offen offset:2048  lds
  buffer_load_dwordx4 v15, s[4:7], s32 offen offset:3072  lds
  s_add_u32 s31, s35, s38
  s_add_u32 m0, s31, 0
  s_nop 0
  buffer_load_dwordx4 v16, s[8:11], s33 offen offset:0 lds
  buffer_load_dwordx4 v17, s[8:11], s33 offen offset:1024 lds
  buffer_load_dwordx4 v18, s[8:11], s33 offen offset:2048 lds
  buffer_load_dwordx4 v19, s[8:11], s33 offen offset:3072 lds
  s_add_u32 s31, s35, s38
  s_add_u32 m0, s31, 4096
  s_nop 0
  buffer_load_dwordx4 v20, s[8:11], s33 offen offset:0 lds
  buffer_load_dwordx4 v21, s[8:11], s33 offen offset:1024 lds
  s_add_u32 s35, s35, 40960
  s_cmp_eq_u32 s35, 122880
  s_cselect_b32 s35, 0, s35
  s_waitcnt vmcnt(11)
  s_waitcnt lgkmcnt(0)
  s_waitcnt lgkmcnt(0)
  s_barrier
  s_mov_b32 s75, 13
  s_cmp_ge_u32 s75, s28
  s_addc_u32 s75, s75, 0
  s_mul_i32 s32, s75, 128
  s_add_u32 s32, s32, s72
  s_mul_i32 s33, s75, 393216
  s_add_u32 s33, s33, s73
  s_add_u32 m0, s35, s37
  s_nop 0
  buffer_load_dwordx4 v12, s[4:7], s32 offen offset:0  lds
  buffer_load_dwordx4 v13, s[4:7], s32 offen offset:1024  lds
  buffer_load_dwordx4 v14, s[4:7], s32 offen offset:2048  lds
  buffer_load_dwordx4 v15, s[4:7], s32 offen offset:3072  lds
  s_add_u32 s31, s35, s38
  s_add_u32 m0, s31, 0
  s_nop 0
  buffer_load_dwordx4 v16, s[8:11], s33 offen offset:0 lds
  buffer_load_dwordx4 v17, s[8:11], s33 offen offset:1024 lds
  buffer_load_dwordx4 v18, s[8:11], s33 offen offset:2048 lds
  buffer_load_dwordx4 v19, s[8:11], s33 offen offset:3072 lds
  s_add_u32 s31, s35, s38
  s_add_u32 m0, s31, 4096
  s_nop 0
  buffer_load_dwordx4 v20, s[8:11], s33 offen offset:0 lds
  buffer_load_dwordx4 v21, s[8:11], s33 offen offset:1024 lds
  s_add_u32 s35, s35, 40960
  s_cmp_eq_u32 s35, 122880
  s_cselect_b32 s35, 0, s35
  s_waitcnt vmcnt(20)
  v_cmp_eq_u32 vcc, s1, v122
  s_nop 4
  s_cmp_eq_u64 vcc, exec
  s_cbranch_scc1 L_qready
  s_mov_b32 s36, 400000
L_poll_q:
  buffer_load_dword v122, v123, s[12:15], 0 offen sc1
  s_waitcnt vmcnt(0)
  v_cmp_eq_u32 vcc, s1, v122
  s_nop 4
  s_cmp_eq_u64 vcc, exec
  s_cbranch_scc1 L_polldone_q
  s_sleep 4
  s_sub_u32 s36, s36, 1
  s_cmp_lg_u32 s36, 0
  s_cbranch_scc1 L_poll_q
L_polldone_q:
L_qready:
  s_mul_i32 s39, s29, 768
  s_mul_i32 s31, s70, 192
  s_add_u32 s39, s39, s31
  s_add_u32 s39, s39, 37814272
  v_lshrrev_b32 v117, 4, v1
  v_mul_u32_u24 v117, 12288, v117
  v_and_b32 v118, 15, v1
  v_cmp_gt_u32 vcc, 12, v118
  v_lshlrev_b32 v118, 4, v118
  v_add_u32 v117, v117, v118
  v_mov_b32 v118, 0x7ffffff0
  v_cndmask_b32 v117, v118, v117, vcc
  buffer_load_dwordx4 v[124:127], v117, s[12:15], s39 offen sc1
  s_add_u32 s39, s39, 49152
  buffer_load_dwordx4 v[128:131], v117, s[12:15], s39 offen sc1
  s_add_u32 s39, s39, 49152
  buffer_load_dwordx4 v[132:135], v117, s[12:15], s39 offen sc1
  s_add_u32 s39, s39, 49152
  buffer_load_dwordx4 v[136:139], v117, s[12:15], s39 offen sc1
  s_add_u32 s39, s39, 49152
  s_lshl_b32 s39, s28, 7
  s_lshl_b32 s31, s70, 5
  s_add_u32 s39, s39, s31
  s_lshl_b32 s39, s39, 3
  s_add_u32 s39, s39, 37748736
  v_and_b32 v119, 31, v1
  v_lshlrev_b32 v119, 3, v119
  buffer_load_dwordx2 v[140:141], v119, s[12:15], s39 offen sc1
  s_waitcnt vmcnt(15)
  s_waitcnt lgkmcnt(0)
  s_waitcnt lgkmcnt(0)
  s_barrier
  s_mov_b32 s75, 14
  s_cmp_ge_u32 s75, s28
  s_addc_u32 s75, s75, 0
  s_mul_i32 s32, s75, 128
  s_add_u32 s32, s32, s72
  s_mul_i32 s33, s75, 393216
  s_add_u32 s33, s33, s73
  s_add_u32 m0, s35, s37
  s_nop 0
  buffer_load_dwordx4 v12, s[4:7], s32 offen offset:0  lds
  buffer_load_dwordx4 v13, s[4:7], s32 offen offset:1024  lds
  buffer_load_dwordx4 v14, s[4:7], s32 offen offset:2048  lds
  buffer_load_dwordx4 v15, s[4:7], s32 offen offset:3072  lds
  s_add_u32 s31, s35, s38
  s_add_u32 m0, s31, 0
  s_nop 0
  buffer_load_dwordx4 v16, s[8:11], s33 offen offset:0 lds
  buffer_load_dwordx4 v17, s[8:11], s33 offen offset:1024 lds
  buffer_load_dwordx4 v18, s[8:11], s33 offen offset:2048 lds
  buffer_load_dwordx4 v19, s[8:11], s33 offen offset:3072 lds
  s_add_u32 s31, s35, s38
  s_add_u32 m0, s31, 4096
  s_nop 0
  buffer_load_dwordx4 v20, s[8:11], s33 offen offset:0 lds
  buffer_load_dwordx4 v21, s[8:11], s33 offen offset:1024 lds
  s_add_u32 s35, s35, 40960
  s_cmp_eq_u32 s35, 122880
  s_cselect_b32 s35, 0, s35
  s_waitcnt vmcnt(15)
  s_waitcnt lgkmcnt(0)
  s_waitcnt lgkmcnt(0)
  s_barrier
  s_waitcnt vmcnt(10)
  s_setprio 0
  v_add_f32 v124, v124, v128
  v_add_f32 v132, v132, v136
  v_add_f32 v125, v125, v129
  v_add_f32 v133, v133, v137
  v_add_f32 v126, v126, v130
  v_add_f32 v134, v134, v138
  v_add_f32 v127, v127, v131
  v_add_f32 v135, v135, v139
  v_add_f32 v124, v124, v132
  v_add_f32 v125, v125, v133
  v_add_f32 v126, v126, v134
  v_add_f32 v127, v127, v135
  v_mov_b32 v144, v124
  v_mov_b32 v145, v125
  v_mov_b32 v146, v126
  v_mov_b32 v147, v127
  s_nop 1
  v_permlane16_swap_b32 v144, v124
  v_permlane16_swap_b32 v145, v125
  v_permlane16_swap_b32 v146, v126
  v_permlane16_swap_b32 v147, v127
  s_nop 1
  v_add_f32 v124, v124, v144
  v_add_f32 v125, v125, v145
  v_add_f32 v126, v126, v146
  v_add_f32 v127, v127, v147
  v_mov_b32 v144, v124
  v_mov_b32 v145, v125
  v_mov_b32 v146, v126
  v_mov_b32 v147, v127
  s_nop 1
  v_permlane32_swap_b32 v144, v124
  v_permlane32_swap_b32 v145, v125
  v_permlane32_swap_b32 v146, v126
  v_permlane32_swap_b32 v147, v127
  s_nop 1
  v_add_f32 v124, v124, v144
  v_add_f32 v125, v125, v145
  v_add_f32 v126, v126, v146
  v_add_f32 v127, v127, v147
  s_mul_i32 s31, s70, 192
  s_add_u32 s31, s31, 160768
  v_lshlrev_b32 v117, 4, v1
  v_add_u32 v117, s31, v117
  v_cmp_gt_u32 vcc, 12, v1
  s_and_saveexec_b64 s[62:63], vcc
  ds_write_b128 v117, v[124:127]
  s_mov_b64 exec, s[62:63]
  s_setprio 1
  v_and_b32 v119, 31, v1
  s_lshl_b32 s31, s70, 5
  v_add_u32 v119, s31, v119
  v_lshlrev_b32 v119, 2, v119
  v_add_u32 v119, 159744, v119
  ds_write_b32 v119, v140
  ds_write_b32 v119, v141 offset:512
  s_waitcnt lgkmcnt(0)
  s_waitcnt vmcnt(0)
  s_waitcnt lgkmcnt(0)
  s_waitcnt lgkmcnt(0)
  s_barrier
  s_waitcnt lgkmcnt(0)
  s_waitcnt lgkmcnt(0)
  s_barrier
  s_mov_b32 s8, s48
  s_mov_b32 s9, s49
  s_mov_b32 s10, 2097152
  s_mov_b32 s11, 0x20000
  s_lshl_b32 s69, s70, 7
  v_add_u32 v9, s69, v1
  v_mul_u32_u24 v8, 0x2001, v9
  v_lshrrev_b32 v8, 16, v8
  v_lshlrev_b32 v7, 3, v8
  v_sub_u32 v9, v9, v7
  v_lshrrev_b32 v7, 1, v8
  v_and_b32 v7, 3, v7
  v_lshlrev_b32 v7, 1, v7
  v_xor_b32 v9, v9, v7
  v_lshlrev_b32 v23, 11, v8
  v_lshlrev_b32 v7, 4, v9
  v_add_u32 v23, v23, v7
  s_lshl_b32 s68, s70, 7
  s_add_u32 s69, s68, 64
  v_add_u32 v9, s69, v1
  v_mul_u32_u24 v8, 0x2001, v9
  v_lshrrev_b32 v8, 16, v8
  v_lshlrev_b32 v7, 3, v8
  v_sub_u32 v9, v9, v7
  v_lshrrev_b32 v7, 1, v8
  v_and_b32 v7, 3, v7
  v_lshlrev_b32 v7, 1, v7
  v_xor_b32 v9, v9, v7
  v_lshlrev_b32 v24, 11, v8
  v_lshlrev_b32 v7, 4, v9
  v_add_u32 v24, v24, v7
  v_subrev_u32 v24, 0x400, v24
  s_lshl_b32 s69, s70, 12
  v_lshlrev_b32 v22, 4, v1
  v_add_u32 v22, s69, v22
  s_lshl_b32 s33, s29, 7
  s_mul_i32 s32, s28, 262144
  s_add_u32 s32, s32, 12582912
  s_lshl_b32 s37, s70, 12
  s_mul_i32 s38, s70, 2048
  s_add_u32 s38, s38, 16384
  s_mov_b32 s0, 1
  s_branch L_attn
L_kvstage:
  v_mov_b32 v54, 163732
  s_cmp_lg_u32 s70, 0
  s_cbranch_scc1 L_kvwait
  s_sub_i32 s39, s28, 1
  s_max_i32 s39, s39, 0
  s_sub_i32 s72, s28, 2
  s_max_i32 s72, s72, 0
  v_mov_b32 v2, s39
  v_mov_b32 v3, s72
  v_and_b32 v52, 1, v1
  v_cmp_eq_u32 vcc, 0, v52
  s_nop 1
  v_cndmask_b32 v2, v3, v2, vcc
  v_lshlrev_b32 v2, 7, v2
  s_lshl_b32 s31, s29, 11
  s_add_u32 s31, s31, 54689792
  v_add_u32 v53, s31, v2
  s_mov_b32 s36, 400000
L_poll_kv:
  buffer_load_dword v52, v53, s[12:15], 0 offen sc1
  s_waitcnt vmcnt(0)
  v_cmp_eq_u32 vcc, s1, v52
  s_nop 4
  s_cmp_eq_u64 vcc, exec
  s_cbranch_scc1 L_polldone_kv
  s_sleep 4
  s_sub_u32 s36, s36, 1
  s_cmp_lg_u32 s36, 0
  s_cbranch_scc1 L_poll_kv
L_polldone_kv:
  v_mov_b32 v55, 1
  ds_write_b32 v54, v55
  s_branch L_kvgo
L_kvwait:
  s_mov_b32 s36, 3200000
L_kvspin:
  ds_read_b32 v55, v54
  s_waitcnt lgkmcnt(0)
  v_readfirstlane_b32 s31, v55
  s_nop 2
  s_cmp_lg_u32 s31, 0
  s_cbranch_scc1 L_kvgo
  s_sleep 1
  s_sub_u32 s36, s36, 1
  s_cmp_lg_u32 s36, 0
  s_cbranch_scc1 L_kvspin
L_kvgo:
  s_lshr_b32 s31, s70, 1
  s_sub_i32 s39, s28, 2
  s_add_i32 s39, s39, s31
  s_lshl_b32 s72, s39, 4
  s_add_u32 s72, s72, s29
  s_lshl_b32 s72, s72, 15
  s_and_b32 s73, s70, 1
  s_lshl_b32 s73, s73, 14
  s_add_u32 s72, s72, s73
  s_add_u32 s72, s72, 4194304
  s_cmp_lt_i32 s39, 0
  s_cselect_b32 s72, 0x7ff00000, s72
  s_and_b32 s73, s70, 1
  s_mul_i32 s73, s73, 49152
  s_lshl_b32 s31, s31, 13
  s_add_u32 s73, s73, s31
  s_add_u32 m0, s73, 0
  s_add_u32 s31, s72, 0
  buffer_load_dwordx4 v10, s[12:15], s31 offen offset:0 sc1 lds
  buffer_load_dwordx4 v10, s[12:15], s31 offen offset:1024 sc1 lds
  buffer_load_dwordx4 v10, s[12:15], s31 offen offset:2048 sc1 lds
  buffer_load_dwordx4 v10, s[12:15], s31 offen offset:3072 sc1 lds
  s_add_u32 m0, s73, 4096
  s_add_u32 s31, s72, 4096
  buffer_load_dwordx4 v10, s[12:15], s31 offen offset:0 sc1 lds
  buffer_load_dwordx4 v10, s[12:15], s31 offen offset:1024 sc1 lds
  buffer_load_dwordx4 v10, s[12:15], s31 offen offset:2048 sc1 lds
  buffer_load_dwordx4 v10, s[12:15], s31 offen offset:3072 sc1 lds
  s_add_u32 m0, s73, 24576
  s_add_u32 s31, s72, 8192
  buffer_load_dwordx4 v10, s[12:15], s31 offen offset:0 sc1 lds
  buffer_load_dwordx4 v10, s[12:15], s31 offen offset:1024 sc1 lds
  buffer_load_dwordx4 v10, s[12:15], s31 offen offset:2048 sc1 lds
  buffer_load_dwordx4 v10, s[12:15], s31 offen offset:3072 sc1 lds
  s_add_u32 m0, s73, 28672
  s_add_u32 s31, s72, 12288
  buffer_load_dwordx4 v10, s[12:15], s31 offen offset:0 sc1 lds
  buffer_load_dwordx4 v10, s[12:15], s31 offen offset:1024 sc1 lds
  buffer_load_dwordx4 v10, s[12:15], s31 offen offset:2048 sc1 lds
  buffer_load_dwordx4 v10, s[12:15], s31 offen offset:3072 sc1 lds
  s_waitcnt vmcnt(8)
  s_branch L_attn_go
L_attn_back_l:
  s_setprio 1
  s_barrier
  s_mov_b32 s35, 0
  s_add_u32 s31, s35, s38
  s_add_u32 m0, s31, 0
  s_nop 0
  buffer_load_dwordx4 v23, s[8:11], s33 offen offset:0 lds
  buffer_load_dwordx4 v24, s[8:11], s33 offen offset:1024 lds
  s_add_u32 s33, s33, 131072
  s_add_u32 s35, s35, 24576
  s_add_u32 s31, s35, s38
  s_add_u32 m0, s31, 0
  s_nop 0
  buffer_load_dwordx4 v23, s[8:11], s33 offen offset:0 lds
  buffer_load_dwordx4 v24, s[8:11], s33 offen offset:1024 lds
  s_add_u32 s33, s33, 131072
  s_add_u32 s35, s35, 24576
  s_add_u32 s31, s35, s38
  s_add_u32 m0, s31, 0
  s_nop 0
  buffer_load_dwordx4 v23, s[8:11], s33 offen offset:0 lds
  buffer_load_dwordx4 v24, s[8:11], s33 offen offset:1024 lds
  s_add_u32 s33, s33, 131072
  s_add_u32 s35, s35, 24576
  s_add_u32 s31, s35, s38
  s_add_u32 m0, s31, 0
  s_nop 0
  buffer_load_dwordx4 v23, s[8:11], s33 offen offset:0 lds
  buffer_load_dwordx4 v24, s[8:11], s33 offen offset:1024 lds
  s_add_u32 s33, s33, 131072
  s_add_u32 s35, s35, 24576
  s_add_u32 s31, s35, s38
  s_add_u32 m0, s31, 0
  s_nop 0
  buffer_load_dwordx4 v23, s[8:11], s33 offen offset:0 lds
  buffer_load_dwordx4 v24, s[8:11], s33 offen offset:1024 lds
  s_add_u32 s33, s33, 131072
  s_add_u32 s35, s35, 24576
  s_add_u32 s31, s35, s38
  s_add_u32 m0, s31, 0
  s_nop 0
  buffer_load_dwordx4 v23, s[8:11], s33 offen offset:0 lds
  buffer_load_dwordx4 v24, s[8:11], s33 offen offset:1024 lds
  s_add_u32 s33, s33, 131072
  s_add_u32 s35, s35, 24576
  v_mov_b32 v180, -1
  v_mov_b32 v181, -1
  v_mov_b32 v182, -1
  v_mov_b32 v183, -1
  s_lshl_b32 s31, s28, 4
  s_add_u32 s31, s31, s29
  s_lshl_b32 s31, s31, 15
  s_lshl_b32 s39, s70, 13
  s_add_u32 s31, s31, s39
  s_add_u32 s31, s31, 46137344
  buffer_store_dwordx4 v[180:183], v10, s[12:15], s31 offen offset:0 sc1
  buffer_store_dwordx4 v[180:183], v10, s[12:15], s31 offen offset:1024 sc1
  buffer_store_dwordx4 v[180:183], v10, s[12:15], s31 offen offset:2048 sc1
  buffer_store_dwordx4 v[180:183], v10, s[12:15], s31 offen offset:3072 sc1
  s_add_u32 s31, s31, 4096
  buffer_store_dwordx4 v[180:183], v10, s[12:15], s31 offen offset:0 sc1
  buffer_store_dwordx4 v[180:183], v10, s[12:15], s31 offen offset:1024 sc1
  buffer_store_dwordx4 v[180:183], v10, s[12:15], s31 offen offset:2048 sc1
  buffer_store_dwordx4 v[180:183], v10, s[12:15], s31 offen offset:3072 sc1
  s_mov_b32 s4, s60
  s_mov_b32 s5, s61
  s_mov_b32 s6, 58720256
  s_mov_b32 s7, 0x20000
  s_barrier
  s_mov_b32 s35, 0
  s_add_u32 m0, s35, s37
  s_nop 0
  buffer_load_dwordx4 v22, s[4:7], s32 offen offset:0 sc1 lds
  buffer_load_dwordx4 v22, s[4:7], s32 offen offset:1024 sc1 lds
  buffer_load_dwordx4 v22, s[4:7], s32 offen offset:2048 sc1 lds
  buffer_load_dwordx4 v22, s[4:7], s32 offen offset:3072 sc1 lds
  s_add_u32 s32, s32, 16384
  s_add_u32 s35, s35, 24576
  s_add_u32 m0, s35, s37
  s_nop 0
  buffer_load_dwordx4 v22, s[4:7], s32 offen offset:0 sc1 lds
  buffer_load_dwordx4 v22, s[4:7], s32 offen offset:1024 sc1 lds
  buffer_load_dwordx4 v22, s[4:7], s32 offen offset:2048 sc1 lds
  buffer_load_dwordx4 v22, s[4:7], s32 offen offset:3072 sc1 lds
  s_add_u32 s32, s32, 16384
  s_add_u32 s35, s35, 24576
  s_add_u32 m0, s35, s37
  s_nop 0
  buffer_load_dwordx4 v22, s[4:7], s32 offen offset:0 sc1 lds
  buffer_load_dwordx4 v22, s[4:7], s32 offen offset:1024 sc1 lds
  buffer_load_dwordx4 v22, s[4:7], s32 offen offset:2048 sc1 lds
  buffer_load_dwordx4 v22, s[4:7], s32 offen offset:3072 sc1 lds
  s_add_u32 s32, s32, 16384
  s_add_u32 s35, s35, 24576
  s_add_u32 m0, s35, s37
  s_nop 0
  buffer_load_dwordx4 v22, s[4:7], s32 offen offset:0 sc1 lds
  buffer_load_dwordx4 v22, s[4:7], s32 offen offset:1024 sc1 lds
  buffer_load_dwordx4 v22, s[4:7], s32 offen offset:2048 sc1 lds
  buffer_load_dwordx4 v22, s[4:7], s32 offen offset:3072 sc1 lds
  s_add_u32 s32, s32, 16384
  s_add_u32 s35, s35, 24576
  s_add_u32 m0, s35, s37
  s_nop 0
  buffer_load_dwordx4 v22, s[4:7], s32 offen offset:0 sc1 lds
  buffer_load_dwordx4 v22, s[4:7], s32 offen offset:1024 sc1 lds
  buffer_load_dwordx4 v22, s[4:7], s32 offen offset:2048 sc1 lds
  buffer_load_dwordx4 v22, s[4:7], s32 offen offset:3072 sc1 lds
  s_add_u32 s32, s32, 16384
  s_add_u32 s35, s35, 24576
  s_add_u32 m0, s35, s37
  s_nop 0
  buffer_load_dwordx4 v22, s[4:7], s32 offen offset:0 sc1 lds
  buffer_load_dwordx4 v22, s[4:7], s32 offen offset:1024 sc1 lds
  buffer_load_dwordx4 v22, s[4:7], s32 offen offset:2048 sc1 lds
  buffer_load_dwordx4 v22, s[4:7], s32 offen offset:3072 sc1 lds
  s_add_u32 s32, s32, 16384
  s_add_u32 s35, s35, 24576
  s_mov_b32 s35, 0
  s_waitcnt vmcnt(20)
  s_waitcnt lgkmcnt(0)
  s_barrier
  s_waitcnt vmcnt(16)
  s_waitcnt lgkmcnt(0)
  s_barrier
  s_add_u32 m0, s35, s37
  s_nop 0
  buffer_load_dwordx4 v22, s[4:7], s32 offen offset:0 sc1 lds
  buffer_load_dwordx4 v22, s[4:7], s32 offen offset:1024 sc1 lds
  buffer_load_dwordx4 v22, s[4:7], s32 offen offset:2048 sc1 lds
  buffer_load_dwordx4 v22, s[4:7], s32 offen offset:3072 sc1 lds
  s_add_u32 s32, s32, 16384
  s_add_u32 s31, s35, s38
  s_add_u32 m0, s31, 0
  s_nop 0
  buffer_load_dwordx4 v23, s[8:11], s33 offen offset:0 lds
  buffer_load_dwordx4 v24, s[8:11], s33 offen offset:1024 lds
  s_add_u32 s33, s33, 131072
  s_add_u32 s35, s35, 24576
  s_cmp_eq_u32 s35, 147456
  s_cselect_b32 s35, 0, s35
  s_waitcnt vmcnt(18)
  s_waitcnt lgkmcnt(0)
  s_waitcnt lgkmcnt(0)
  s_barrier
  s_add_u32 m0, s35, s37
  s_nop 0
  buffer_load_dwordx4 v22, s[4:7], s32 offen offset:0 sc1 lds
  buffer_load_dwordx4 v22, s[4:7], s32 offen offset:1024 sc1 lds
  buffer_load_dwordx4 v22, s[4:7], s32 offen offset:2048 sc1 lds
  buffer_load_dwordx4 v22, s[4:7], s32 offen offset:3072 sc1 lds
  s_add_u32 s32, s32, 16384
  s_add_u32 s31, s35, s38
  s_add_u32 m0, s31, 0
  s_nop 0
  buffer_load_dwordx4 v23, s[8:11], s33 offen offset:0 lds
  buffer_load_dwordx4 v24, s[8:11], s33 offen offset:1024 lds
  s_add_u32 s33, s33, 131072
  s_add_u32 s35, s35, 24576
  s_cmp_eq_u32 s35, 147456
  s_cselect_b32 s35, 0, s35
  s_waitcnt vmcnt(20)
  s_waitcnt lgkmcnt(0)
  s_waitcnt lgkmcnt(0)
  s_barrier
  s_add_u32 m0, s35, s37
  s_nop 0
  buffer_load_dwordx4 v22, s[4:7], s32 offen offset:0 sc1 lds
  buffer_load_dwordx4 v22, s[4:7], s32 offen offset:1024 sc1 lds
  buffer_load_dwordx4 v22, s[4:7], s32 offen offset:2048 sc1 lds
  buffer_load_dwordx4 v22, s[4:7], s32 offen offset:3072 sc1 lds
  s_add_u32 s32, s32, 16384
  s_add_u32 s31, s35, s38
  s_add_u32 m0, s31, 0
  s_nop 0
  buffer_load_dwordx4 v23, s[8:11], s33 offen offset:0 lds
  buffer_load_dwordx4 v24, s[8:11], s33 offen offset:1024 lds
  s_add_u32 s33, s33, 131072
  s_add_u32 s35, s35, 24576
  s_cmp_eq_u32 s35, 147456
  s_cselect_b32 s35, 0, s35
  s_waitcnt vmcnt(22)
  s_waitcnt lgkmcnt(0)
  s_waitcnt lgkmcnt(0)
  s_barrier
  s_add_u32 m0, s35, s37
  s_nop 0
  buffer_load_dwordx4 v22, s[4:7], s32 offen offset:0 sc1 lds
  buffer_load_dwordx4 v22, s[4:7], s32 offen offset:1024 sc1 lds
  buffer_load_dwordx4 v22, s[4:7], s32 offen offset:2048 sc1 lds
  buffer_load_dwordx4 v22, s[4:7], s32 offen offset:3072 sc1 lds
  s_add_u32 s32, s32, 16384
  s_add_u32 s31, s35, s38
  s_add_u32 m0, s31, 0
  s_nop 0
  buffer_load_dwordx4 v23, s[8:11], s33 offen offset:0 lds
  buffer_load_dwordx4 v24, s[8:11], s33 offen offset:1024 lds
  s_add_u32 s33, s33, 131072
  s_add_u32 s35, s35, 24576
  s_cmp_eq_u32 s35, 147456
  s_cselect_b32 s35, 0, s35
  s_waitcnt vmcnt(24)
  s_waitcnt lgkmcnt(0)
  s_waitcnt lgkmcnt(0)
  s_barrier
  s_mov_b32 s36, 6
L_lloop_o:
  s_add_u32 m0, s35, s37
  s_nop 0
  buffer_load_dwordx4 v22, s[4:7], s32 offen offset:0 sc1 lds
  buffer_load_dwordx4 v22, s[4:7], s32 offen offset:1024 sc1 lds
  buffer_load_dwordx4 v22, s[4:7], s32 offen offset:2048 sc1 lds
  buffer_load_dwordx4 v22, s[4:7], s32 offen offset:3072 sc1 lds
  s_add_u32 s32, s32, 16384
  s_add_u32 s31, s35, s38
  s_add_u32 m0, s31, 0
  s_nop 0
  buffer_load_dwordx4 v23, s[8:11], s33 offen offset:0 lds
  buffer_load_dwordx4 v24, s[8:11], s33 offen offset:1024 lds
  s_add_u32 s33, s33, 131072
  s_add_u32 s35, s35, 24576
  s_cmp_eq_u32 s35, 147456
  s_cselect_b32 s35, 0, s35
  s_waitcnt vmcnt(24)
  s_barrier
  s_sub_u32 s36, s36, 1
  s_cmp_lg_u32 s36, 0
  s_cbranch_scc1 L_lloop_o
  s_waitcnt vmcnt(18)
  s_waitcnt lgkmcnt(0)
  s_waitcnt lgkmcnt(0)
  s_barrier
  s_waitcnt vmcnt(12)
  s_waitcnt lgkmcnt(0)
  s_waitcnt lgkmcnt(0)
  s_barrier
  s_waitcnt vmcnt(6)
  s_waitcnt lgkmcnt(0)
  s_waitcnt lgkmcnt(0)
  s_barrier
  s_waitcnt vmcnt(0)
  s_waitcnt lgkmcnt(0)
  s_waitcnt lgkmcnt(0)
  s_barrier
  s_waitcnt lgkmcnt(0)
  s_waitcnt lgkmcnt(0)
  s_barrier
  s_mov_b32 s8, s52
  s_mov_b32 s9, s53
  s_mov_b32 s10, 7340032
  s_mov_b32 s11, 0x20000
  s_mul_i32 s69, s70, 0x1c0
  v_add_u32 v9, s69, v1
  v_mul_u32_u24 v8, 0x925, v9
  v_lshrrev_b32 v8, 16, v8
  v_mul_u32_u24 v7, 28, v8
  v_sub_u32 v9, v9, v7
  v_lshrrev_b32 v7, 2, v8
  v_and_b32 v7, 1, v7
  v_lshlrev_b32 v7, 1, v7
  v_xor_b32 v9, v9, v7
  v_mul_u32_u24 v26, 0x1c00, v8
  v_lshlrev_b32 v7, 4, v9
  v_add_u32 v26, v26, v7
  s_mul_i32 s68, s70, 0x1c0
  s_add_u32 s69, s68, 64
  v_add_u32 v9, s69, v1
  v_mul_u32_u24 v8, 0x925, v9
  v_lshrrev_b32 v8, 16, v8
  v_mul_u32_u24 v7, 28, v8
  v_sub_u32 v9, v9, v7
  v_lshrrev_b32 v7, 2, v8
  v_and_b32 v7, 1, v7
  v_lshlrev_b32 v7, 1, v7
  v_xor_b32 v9, v9, v7
  v_mul_u32_u24 v27, 0x1c00, v8
  v_lshlrev_b32 v7, 4, v9
  v_add_u32 v27, v27, v7
  v_subrev_u32 v27, 0x400, v27
  s_mul_i32 s68, s70, 0x1c0
  s_add_u32 s69, s68, 0x80
  v_add_u32 v9, s69, v1
  v_mul_u32_u24 v8, 0x925, v9
  v_lshrrev_b32 v8, 16, v8
  v_mul_u32_u24 v7, 28, v8
  v_sub_u32 v9, v9, v7
  v_lshrrev_b32 v7, 2, v8
  v_and_b32 v7, 1, v7
  v_lshlrev_b32 v7, 1, v7
  v_xor_b32 v9, v9, v7
  v_mul_u32_u24 v28, 0x1c00, v8
  v_lshlrev_b32 v7, 4, v9
  v_add_u32 v28, v28, v7
  v_subrev_u32 v28, 0x800, v28
  s_mul_i32 s68, s70, 0x1c0
  s_add_u32 s69, s68, 0xc0
  v_add_u32 v9, s69, v1
  v_mul_u32_u24 v8, 0x925, v9
  v_lshrrev_b32 v8, 16, v8
  v_mul_u32_u24 v7, 28, v8
  v_sub_u32 v9, v9, v7
  v_lshrrev_b32 v7, 2, v8
  v_and_b32 v7, 1, v7
  v_lshlrev_b32 v7, 1, v7
  v_xor_b32 v9, v9, v7
  v_mul_u32_u24 v29, 0x1c00, v8
  v_lshlrev_b32 v7, 4, v9
  v_add_u32 v29, v29, v7
  v_subrev_u32 v29, 0xc00, v29
  s_mul_i32 s68, s70, 0x1c0
  s_add_u32 s69, s68, 0x100
  v_add_u32 v9, s69, v1
  v_mul_u32_u24 v8, 0x925, v9
  v_lshrrev_b32 v8, 16, v8
  v_mul_u32_u24 v7, 28, v8
  v_sub_u32 v9, v9, v7
  v_lshrrev_b32 v7, 2, v8
  v_and_b32 v7, 1, v7
  v_lshlrev_b32 v7, 1, v7
  v_xor_b32 v9, v9, v7
  v_mul_u32_u24 v30, 0x1c00, v8
  v_lshlrev_b32 v7, 4, v9
  v_add_u32 v30, v30, v7
  s_mul_i32 s68, s70, 0x1c0
  s_add_u32 s69, s68, 0x140
  v_add_u32 v9, s69, v1
  v_mul_u32_u24 v8, 0x925, v9
  v_lshrrev_b32 v8, 16, v8
  v_mul_u32_u24 v7, 28, v8
  v_sub_u32 v9, v9, v7
  v_lshrrev_b32 v7, 2, v8
  v_and_b32 v7, 1, v7
  v_lshlrev_b32 v7, 1, v7
  v_xor_b32 v9, v9, v7
  v_mul_u32_u24 v31, 0x1c00, v8
  v_lshlrev_b32 v7, 4, v9
  v_add_u32 v31, v31, v7
  v_subrev_u32 v31, 0x400, v31
  s_mul_i32 s68, s70, 0x1c0
  s_add_u32 s69, s68, 0x180
  v_add_u32 v9, s69, v1
  v_mul_u32_u24 v8, 0x925, v9
  v_lshrrev_b32 v8, 16, v8
  v_mul_u32_u24 v7, 28, v8
  v_sub_u32 v9, v9, v7
  v_lshrrev_b32 v7, 2, v8
  v_and_b32 v7, 1, v7
  v_lshlrev_b32 v7, 1, v7
  v_xor_b32 v9, v9, v7
  v_mul_u32_u24 v32, 0x1c00, v8
  v_lshlrev_b32 v7, 4, v9
  v_add_u32 v32, v32, v7
  v_subrev_u32 v32, 0x800, v32
  s_lshl_b32 s69, s70, 12
  v_lshlrev_b32 v25, 4, v1
  v_add_u32 v25, s69, v25
  s_mul_i32 s33, s29, 448
  s_mul_i32 s32, s28, 262144
  s_add_u32 s32, s32, 16777216
  s_lshl_b32 s37, s70, 12
  s_mul_i32 s38, s70, 7168
  s_add_u32 s38, s38, 16384
  s_barrier
  s_min_u32 s78, s28, s29
  s_max_u32 s79, s28, s29
  s_cmp_eq_u32 s28, s29
  s_cselect_b32 s80, 1, 0
  s_cselect_b32 s79, 99, s79
  s_mov_b32 s72, s32
  s_mov_b32 s73, s33
  s_mul_i32 s33, s29, 458752
  s_add_u32 s33, s33, s73
  s_mov_b32 s35, 90112
  s_add_u32 s31, s35, s38
  s_add_u32 m0, s31, 0
  s_nop 0
  buffer_load_dwordx4 v26, s[8:11], s33 offen offset:0 lds
  buffer_load_dwordx4 v27, s[8:11], s33 offen offset:1024 lds
  buffer_load_dwordx4 v28, s[8:11], s33 offen offset:2048 lds
  buffer_load_dwordx4 v29, s[8:11], s33 offen offset:3072 lds
  s_add_u32 s31, s35, s38
  s_add_u32 m0, s31, 4096
  s_nop 0
  buffer_load_dwordx4 v30, s[8:11], s33 offen offset:0 lds
  buffer_load_dwordx4 v31, s[8:11], s33 offen offset:1024 lds
  buffer_load_dwordx4 v32, s[8:11], s33 offen offset:2048 lds
  s_mov_b32 s35, 0
  s_mov_b32 s75, 0
  s_cmp_ge_u32 s75, s78
  s_addc_u32 s75, s75, 0
  s_cmp_eq_u32 s80, 1
  s_cselect_b32 s75, s75, s28
  s_mul_i32 s32, s75, 16384
  s_add_u32 s32, s32, s72
  s_mul_i32 s33, s75, 458752
  s_add_u32 s33, s33, s73
  s_add_u32 s31, s35, s38
  s_add_u32 m0, s31, 0
  s_nop 0
  buffer_load_dwordx4 v26, s[8:11], s33 offen offset:0 lds
  buffer_load_dwordx4 v27, s[8:11], s33 offen offset:1024 lds
  buffer_load_dwordx4 v28, s[8:11], s33 offen offset:2048 lds
  buffer_load_dwordx4 v29, s[8:11], s33 offen offset:3072 lds
  s_add_u32 s31, s35, s38
  s_add_u32 m0, s31, 4096
  s_nop 0
  buffer_load_dwordx4 v30, s[8:11], s33 offen offset:0 lds
  buffer_load_dwordx4 v31, s[8:11], s33 offen offset:1024 lds
  buffer_load_dwordx4 v32, s[8:11], s33 offen offset:2048 lds
  s_add_u32 s35, s35, 45056
  s_add_u32 s75, s80, 0
  s_cmp_ge_u32 s75, s78
  s_addc_u32 s75, s75, 0
  s_cmp_ge_u32 s75, s79
  s_addc_u32 s75, s75, 0
  s_mul_i32 s32, s75, 16384
  s_add_u32 s32, s32, s72
  s_mul_i32 s33, s75, 458752
  s_add_u32 s33, s33, s73
  s_add_u32 s31, s35, s38
  s_add_u32 m0, s31, 0
  s_nop 0
  buffer_load_dwordx4 v26, s[8:11], s33 offen offset:0 lds
  buffer_load_dwordx4 v27, s[8:11], s33 offen offset:1024 lds
  buffer_load_dwordx4 v28, s[8:11], s33 offen offset:2048 lds
  buffer_load_dwordx4 v29, s[8:11], s33 offen offset:3072 lds
  s_add_u32 s31, s35, s38
  s_add_u32 m0, s31, 4096
  s_nop 0
  buffer_load_dwordx4 v30, s[8:11], s33 offen offset:0 lds
  buffer_load_dwordx4 v31, s[8:11], s33 offen offset:1024 lds
  buffer_load_dwordx4 v32, s[8:11], s33 offen offset:2048 lds
  s_add_u32 s35, s35, 45056
  v_lshlrev_b32 v176, 2, v1
  v_lshrrev_b32 v172, 4, v1
  v_lshlrev_b32 v172, 2, v172
  v_lshrrev_b32 v7, 2, v1
  v_and_b32 v7, 3, v7
  v_add_u32 v172, v172, v7
  v_mul_u32_u24 v172, 0x1c0, v172
  s_lshl_b32 s68, s70, 2
  s_lshl_b32 s69, s68, 1
  v_lshrrev_b32 v7, 1, v1
  v_and_b32 v7, 1, v7
  v_add_u32 v7, s69, v7
  v_lshrrev_b32 v6, 4, v1
  v_lshlrev_b32 v6, 2, v6
  v_lshrrev_b32 v5, 2, v1
  v_and_b32 v5, 3, v5
  v_add_u32 v6, v6, v5
  v_lshrrev_b32 v6, 2, v6
  v_and_b32 v6, 1, v6
  v_lshlrev_b32 v6, 1, v6
  v_xor_b32 v7, v7, v6
  v_lshlrev_b32 v7, 4, v7
  v_add_u32 v172, v172, v7
  v_and_b32 v7, 1, v1
  v_lshlrev_b32 v7, 3, v7
  v_add_u32 v172, v172, v7
  v_add_u32 v172, 0x4000, v172
  v_lshrrev_b32 v173, 4, v1
  v_lshlrev_b32 v173, 2, v173
  v_lshrrev_b32 v7, 2, v1
  v_and_b32 v7, 3, v7
  v_add_u32 v173, v173, v7
  v_mul_u32_u24 v173, 0x1c0, v173
  s_lshl_b32 s67, s70, 2
  s_add_u32 s68, s67, 1
  s_lshl_b32 s69, s68, 1
  v_lshrrev_b32 v7, 1, v1
  v_and_b32 v7, 1, v7
  v_add_u32 v7, s69, v7
  v_lshrrev_b32 v6, 4, v1
  v_lshlrev_b32 v6, 2, v6
  v_lshrrev_b32 v5, 2, v1
  v_and_b32 v5, 3, v5
  v_add_u32 v6, v6, v5
  v_lshrrev_b32 v6, 2, v6
  v_and_b32 v6, 1, v6
  v_lshlrev_b32 v6, 1, v6
  v_xor_b32 v7, v7, v6
  v_lshlrev_b32 v7, 4, v7
  v_add_u32 v173, v173, v7
  v_and_b32 v7, 1, v1
  v_lshlrev_b32 v7, 3, v7
  v_add_u32 v173, v173, v7
  v_add_u32 v173, 0x4000, v173
  s_waitcnt vmcnt(14)
  s_barrier
  s_cmp_eq_u32 s80, 1
  s_cbranch_scc0 L_csn_pre
  v_add_u32 v172, 90112, v172
  v_add_u32 v173, 90112, v173
  v_add_u32 v174, 90112, v174
  v_add_u32 v175, 90112, v175
  ds_read_b64_tr_b16 v[124:125], v172 offset:0
  ds_read_b64_tr_b16 v[126:127], v172 offset:7168
  ds_read_b64_tr_b16 v[128:129], v172 offset:14336
  ds_read_b64_tr_b16 v[130:131], v172 offset:21504
  ds_read_b64_tr_b16 v[132:133], v173 offset:0
  ds_read_b64_tr_b16 v[134:135], v173 offset:7168
  ds_read_b64_tr_b16 v[136:137], v173 offset:14336
  ds_read_b64_tr_b16 v[138:139], v173 offset:21504
  ds_read_b64_tr_b16 v[140:141], v172 offset:64
  ds_read_b64_tr_b16 v[142:143], v172 offset:7232
  ds_read_b64_tr_b16 v[144:145], v172 offset:14400
  ds_read_b64_tr_b16 v[146:147], v172 offset:21568
  ds_read_b64_tr_b16 v[148:149], v173 offset:64
  ds_read_b64_tr_b16 v[150:151], v173 offset:7232
  ds_read_b64_tr_b16 v[152:153], v173 offset:14400
  ds_read_b64_tr_b16 v[154:155], v173 offset:21568
L_csn_pre:
  s_waitcnt lgkmcnt(0)
  s_barrier
  s_mov_b32 s35, 90112
  s_add_u32 s75, s80, 1
  s_cmp_ge_u32 s75, s78
  s_addc_u32 s75, s75, 0
  s_cmp_ge_u32 s75, s79
  s_addc_u32 s75, s75, 0
  s_mul_i32 s32, s75, 16384
  s_add_u32 s32, s32, s72
  s_mul_i32 s33, s75, 458752
  s_add_u32 s33, s33, s73
  s_add_u32 s31, s35, s38
  s_add_u32 m0, s31, 0
  s_nop 0
  buffer_load_dwordx4 v26, s[8:11], s33 offen offset:0 lds
  buffer_load_dwordx4 v27, s[8:11], s33 offen offset:1024 lds
  buffer_load_dwordx4 v28, s[8:11], s33 offen offset:2048 lds
  buffer_load_dwordx4 v29, s[8:11], s33 offen offset:3072 lds
  s_add_u32 s31, s35, s38
  s_add_u32 m0, s31, 4096
  s_nop 0
  buffer_load_dwordx4 v30, s[8:11], s33 offen offset:0 lds
  buffer_load_dwordx4 v31, s[8:11], s33 offen offset:1024 lds
  buffer_load_dwordx4 v32, s[8:11], s33 offen offset:2048 lds
  s_mov_b32 s4, s60
  s_mov_b32 s5, s61
  s_mov_b32 s6, 58720256
  s_mov_b32 s7, 0x20000
  s_barrier
  s_mov_b32 s35, 0
  s_mov_b32 s75, 0
  s_cmp_ge_u32 s75, s78
  s_addc_u32 s75, s75, 0
  s_cmp_eq_u32 s80, 1
  s_cselect_b32 s75, s75, s28
  s_mul_i32 s32, s75, 16384
  s_add_u32 s32, s32, s72
  s_mul_i32 s33, s75, 458752
  s_add_u32 s33, s33, s73
  s_add_u32 m0, s35, s37
  s_nop 0
  buffer_load_dwordx4 v25, s[4:7], s32 offen offset:0 sc1 lds
  buffer_load_dwordx4 v25, s[4:7], s32 offen offset:1024 sc1 lds
  buffer_load_dwordx4 v25, s[4:7], s32 offen offset:2048 sc1 lds
  buffer_load_dwordx4 v25, s[4:7], s32 offen offset:3072 sc1 lds
  s_add_u32 s35, s35, 45056
  s_add_u32 s75, s80, 0
  s_cmp_ge_u32 s75, s78
  s_addc_u32 s75, s75, 0
  s_cmp_ge_u32 s75, s79
  s_addc_u32 s75, s75, 0
  s_mul_i32 s32, s75, 16384
  s_add_u32 s32, s32, s72
  s_mul_i32 s33, s75, 458752
  s_add_u32 s33, s33, s73
  s_add_u32 m0, s35, s37
  s_nop 0
  buffer_load_dwordx4 v25, s[4:7], s32 offen offset:0 sc1 lds
  buffer_load_dwordx4 v25, s[4:7], s32 offen offset:1024 sc1 lds
  buffer_load_dwordx4 v25, s[4:7], s32 offen offset:2048 sc1 lds
  buffer_load_dwordx4 v25, s[4:7], s32 offen offset:3072 sc1 lds
  s_add_u32 s35, s35, 45056
  s_add_u32 s75, s80, 1
  s_cmp_ge_u32 s75, s78
  s_addc_u32 s75, s75, 0
  s_cmp_ge_u32 s75, s79
  s_addc_u32 s75, s75, 0
  s_mul_i32 s32, s75, 16384
  s_add_u32 s32, s32, s72
  s_mul_i32 s33, s75, 458752
  s_add_u32 s33, s33, s73
  s_add_u32 m0, s35, s37
  s_nop 0
  buffer_load_dwordx4 v25, s[4:7], s32 offen offset:0 sc1 lds
  buffer_load_dwordx4 v25, s[4:7], s32 offen offset:1024 sc1 lds
  buffer_load_dwordx4 v25, s[4:7], s32 offen offset:2048 sc1 lds
  buffer_load_dwordx4 v25, s[4:7], s32 offen offset:3072 sc1 lds
  s_add_u32 s35, s35, 45056
  s_mov_b32 s35, 0
  s_waitcnt vmcnt(8)
  s_waitcnt lgkmcnt(0)
  s_barrier
  s_cmp_eq_u32 s80, 1
  s_cbranch_scc1 L_csn_main
  ds_read_b64_tr_b16 v[124:125], v172 offset:0
  ds_read_b64_tr_b16 v[126:127], v172 offset:7168
  ds_read_b64_tr_b16 v[128:129], v172 offset:14336
  ds_read_b64_tr_b16 v[130:131], v172 offset:21504
  ds_read_b64_tr_b16 v[132:133], v173 offset:0
  ds_read_b64_tr_b16 v[134:135], v173 offset:7168
  ds_read_b64_tr_b16 v[136:137], v173 offset:14336
  ds_read_b64_tr_b16 v[138:139], v173 offset:21504
  ds_read_b64_tr_b16 v[140:141], v172 offset:64
  ds_read_b64_tr_b16 v[142:143], v172 offset:7232
  ds_read_b64_tr_b16 v[144:145], v172 offset:14400
  ds_read_b64_tr_b16 v[146:147], v172 offset:21568
  ds_read_b64_tr_b16 v[148:149], v173 offset:64
  ds_read_b64_tr_b16 v[150:151], v173 offset:7232
  ds_read_b64_tr_b16 v[152:153], v173 offset:14400
  ds_read_b64_tr_b16 v[154:155], v173 offset:21568
L_csn_main:
  s_waitcnt vmcnt(4)
  s_waitcnt lgkmcnt(0)
  s_barrier
  s_add_u32 s75, s80, 2
  s_cmp_ge_u32 s75, s78
  s_addc_u32 s75, s75, 0
  s_cmp_ge_u32 s75, s79
  s_addc_u32 s75, s75, 0
  s_mul_i32 s32, s75, 16384
  s_add_u32 s32, s32, s72
  s_mul_i32 s33, s75, 458752
  s_add_u32 s33, s33, s73
  s_add_u32 m0, s35, s37
  s_nop 0
  buffer_load_dwordx4 v25, s[4:7], s32 offen offset:0 sc1 lds
  buffer_load_dwordx4 v25, s[4:7], s32 offen offset:1024 sc1 lds
  buffer_load_dwordx4 v25, s[4:7], s32 offen offset:2048 sc1 lds
  buffer_load_dwordx4 v25, s[4:7], s32 offen offset:3072 sc1 lds
  s_add_u32 s31, s35, s38
  s_add_u32 m0, s31, 0
  s_nop 0
  buffer_load_dwordx4 v26, s[8:11], s33 offen offset:0 lds
  buffer_load_dwordx4 v27, s[8:11], s33 offen offset:1024 lds
  buffer_load_dwordx4 v28, s[8:11], s33 offen offset:2048 lds
  buffer_load_dwordx4 v29, s[8:11], s33 offen offset:3072 lds
  s_add_u32 s31, s35, s38
  s_add_u32 m0, s31, 4096
  s_nop 0
  buffer_load_dwordx4 v30, s[8:11], s33 offen offset:0 lds
  buffer_load_dwordx4 v31, s[8:11], s33 offen offset:1024 lds
  buffer_load_dwordx4 v32, s[8:11], s33 offen offset:2048 lds
  s_add_u32 s35, s35, 45056
  s_cmp_eq_u32 s35, 135168
  s_cselect_b32 s35, 0, s35
  s_waitcnt vmcnt(11)
  s_waitcnt lgkmcnt(0)
  s_waitcnt lgkmcnt(0)
  s_barrier
  s_add_u32 s75, s80, 3
  s_cmp_ge_u32 s75, s78
  s_addc_u32 s75, s75, 0
  s_cmp_ge_u32 s75, s79
  s_addc_u32 s75, s75, 0
  s_mul_i32 s32, s75, 16384
  s_add_u32 s32, s32, s72
  s_mul_i32 s33, s75, 458752
  s_add_u32 s33, s33, s73
  s_add_u32 m0, s35, s37
  s_nop 0
  buffer_load_dwordx4 v25, s[4:7], s32 offen offset:0 sc1 lds
  buffer_load_dwordx4 v25, s[4:7], s32 offen offset:1024 sc1 lds
  buffer_load_dwordx4 v25, s[4:7], s32 offen offset:2048 sc1 lds
  buffer_load_dwordx4 v25, s[4:7], s32 offen offset:3072 sc1 lds
  s_add_u32 s31, s35, s38
  s_add_u32 m0, s31, 0
  s_nop 0
  buffer_load_dwordx4 v26, s[8:11], s33 offen offset:0 lds
  buffer_load_dwordx4 v27, s[8:11], s33 offen offset:1024 lds
  buffer_load_dwordx4 v28, s[8:11], s33 offen offset:2048 lds
  buffer_load_dwordx4 v29, s[8:11], s33 offen offset:3072 lds
  s_add_u32 s31, s35, s38
  s_add_u32 m0, s31, 4096
  s_nop 0
  buffer_load_dwordx4 v30, s[8:11], s33 offen offset:0 lds
  buffer_load_dwordx4 v31, s[8:11], s33 offen offset:1024 lds
  buffer_load_dwordx4 v32, s[8:11], s33 offen offset:2048 lds
  s_add_u32 s35, s35, 45056
  s_cmp_eq_u32 s35, 135168
  s_cselect_b32 s35, 0, s35
  v_mov_b32 v120, 0x3f803f80
  v_mov_b32 v121, 0x3f803f80
  v_mov_b32 v122, 0x3f803f80
  v_mov_b32 v123, 0x3f803f80
  s_lshl_b32 s31, s28, 4
  s_add_u32 s31, s31, s29
  s_mul_i32 s39, s31, 896
  s_lshl_b32 s31, s70, 8
  s_add_u32 s39, s39, s31
  s_add_u32 s39, s39, 38273024
  v_mfma_f32_16x16x32_bf16 v[156:159], v[120:123], v[124:127], 0
  v_mfma_f32_16x16x32_bf16 v[160:163], v[120:123], v[132:135], 0
  v_mfma_f32_16x16x32_bf16 v[164:167], v[120:123], v[140:143], 0
  v_mfma_f32_16x16x32_bf16 v[168:171], v[120:123], v[148:151], 0
  v_mfma_f32_16x16x32_bf16 v[156:159], v[120:123], v[128:131], v[156:159]
  v_mfma_f32_16x16x32_bf16 v[160:163], v[120:123], v[136:139], v[160:163]
  v_mfma_f32_16x16x32_bf16 v[164:167], v[120:123], v[144:147], v[164:167]
  v_mfma_f32_16x16x32_bf16 v[168:171], v[120:123], v[152:155], v[168:171]
  v_cmp_gt_u32 vcc, 16, v1
  s_nop 7
  s_and_saveexec_b64 s[62:63], vcc
  buffer_store_dword v156, v176, s[12:15], s39 offen offset:0 sc1
  buffer_store_dword v160, v176, s[12:15], s39 offen offset:64 sc1
  s_cmp_eq_u32 s70, 3
  s_cselect_b32 s39, 0x7fffeff0, s39
  buffer_store_dword v164, v176, s[12:15], s39 offen offset:128 sc1
  buffer_store_dword v168, v176, s[12:15], s39 offen offset:192 sc1
  s_mov_b64 exec, s[62:63]
  s_waitcnt vmcnt(15)
  s_waitcnt lgkmcnt(0)
  s_waitcnt lgkmcnt(0)
  s_barrier
  s_add_u32 s75, s80, 4
  s_cmp_ge_u32 s75, s78
  s_addc_u32 s75, s75, 0
  s_cmp_ge_u32 s75, s79
  s_addc_u32 s75, s75, 0
  s_mul_i32 s32, s75, 16384
  s_add_u32 s32, s32, s72
  s_mul_i32 s33, s75, 458752
  s_add_u32 s33, s33, s73
  s_add_u32 m0, s35, s37
  s_nop 0
  buffer_load_dwordx4 v25, s[4:7], s32 offen offset:0 sc1 lds
  buffer_load_dwordx4 v25, s[4:7], s32 offen offset:1024 sc1 lds
  buffer_load_dwordx4 v25, s[4:7], s32 offen offset:2048 sc1 lds
  buffer_load_dwordx4 v25, s[4:7], s32 offen offset:3072 sc1 lds
  s_add_u32 s31, s35, s38
  s_add_u32 m0, s31, 0
  s_nop 0
  buffer_load_dwordx4 v26, s[8:11], s33 offen offset:0 lds
  buffer_load_dwordx4 v27, s[8:11], s33 offen offset:1024 lds
  buffer_load_dwordx4 v28, s[8:11], s33 offen offset:2048 lds
  buffer_load_dwordx4 v29, s[8:11], s33 offen offset:3072 lds
  s_add_u32 s31, s35, s38
  s_add_u32 m0, s31, 4096
  s_nop 0
  buffer_load_dwordx4 v30, s[8:11], s33 offen offset:0 lds
  buffer_load_dwordx4 v31, s[8:11], s33 offen offset:1024 lds
  buffer_load_dwordx4 v32, s[8:11], s33 offen offset:2048 lds
  s_add_u32 s35, s35, 45056
  s_cmp_eq_u32 s35, 135168
  s_cselect_b32 s35, 0, s35
  s_waitcnt vmcnt(15)
  s_waitcnt lgkmcnt(0)
  s_waitcnt lgkmcnt(0)
  s_barrier
  s_add_u32 s75, s80, 5
  s_cmp_ge_u32 s75, s78
  s_addc_u32 s75, s75, 0
  s_cmp_ge_u32 s75, s79
  s_addc_u32 s75, s75, 0
  s_mul_i32 s32, s75, 16384
  s_add_u32 s32, s32, s72
  s_mul_i32 s33, s75, 458752
  s_add_u32 s33, s33, s73
  s_add_u32 m0, s35, s37
  s_nop 0
  buffer_load_dwordx4 v25, s[4:7], s32 offen offset:0 sc1 lds
  buffer_load_dwordx4 v25, s[4:7], s32 offen offset:1024 sc1 lds
  buffer_load_dwordx4 v25, s[4:7], s32 offen offset:2048 sc1 lds
  buffer_load_dwordx4 v25, s[4:7], s32 offen offset:3072 sc1 lds
  s_add_u32 s31, s35, s38
  s_add_u32 m0, s31, 0
  s_nop 0
  buffer_load_dwordx4 v26, s[8:11], s33 offen offset:0 lds
  buffer_load_dwordx4 v27, s[8:11], s33 offen offset:1024 lds
  buffer_load_dwordx4 v28, s[8:11], s33 offen offset:2048 lds
  buffer_load_dwordx4 v29, s[8:11], s33 offen offset:3072 lds
  s_add_u32 s31, s35, s38
  s_add_u32 m0, s31, 4096
  s_nop 0
  buffer_load_dwordx4 v30, s[8:11], s33 offen offset:0 lds
  buffer_load_dwordx4 v31, s[8:11], s33 offen offset:1024 lds
  buffer_load_dwordx4 v32, s[8:11], s33 offen offset:2048 lds
  s_add_u32 s35, s35, 45056
  s_cmp_eq_u32 s35, 135168
  s_cselect_b32 s35, 0, s35
  s_waitcnt vmcnt(11)
  s_waitcnt lgkmcnt(0)
  s_waitcnt lgkmcnt(0)
  s_barrier
  s_add_u32 s75, s80, 6
  s_cmp_ge_u32 s75, s78
  s_addc_u32 s75, s75, 0
  s_cmp_ge_u32 s75, s79
  s_addc_u32 s75, s75, 0
  s_mul_i32 s32, s75, 16384
  s_add_u32 s32, s32, s72
  s_mul_i32 s33, s75, 458752
  s_add_u32 s33, s33, s73
  s_add_u32 m0, s35, s37
  s_nop 0
  buffer_load_dwordx4 v25, s[4:7], s32 offen offset:0 sc1 lds
  buffer_load_dwordx4 v25, s[4:7], s32 offen offset:1024 sc1 lds
  buffer_load_dwordx4 v25, s[4:7], s32 offen offset:2048 sc1 lds
  buffer_load_dwordx4 v25, s[4:7], s32 offen offset:3072 sc1 lds
  s_add_u32 s31, s35, s38
  s_add_u32 m0, s31, 0
  s_nop 0
  buffer_load_dwordx4 v26, s[8:11], s33 offen offset:0 lds
  buffer_load_dwordx4 v27, s[8:11], s33 offen offset:1024 lds
  buffer_load_dwordx4 v28, s[8:11], s33 offen offset:2048 lds
  buffer_load_dwordx4 v29, s[8:11], s33 offen offset:3072 lds
  s_add_u32 s31, s35, s38
  s_add_u32 m0, s31, 4096
  s_nop 0
  buffer_load_dwordx4 v30, s[8:11], s33 offen offset:0 lds
  buffer_load_dwordx4 v31, s[8:11], s33 offen offset:1024 lds
  buffer_load_dwordx4 v32, s[8:11], s33 offen offset:2048 lds
  s_add_u32 s35, s35, 45056
  s_cmp_eq_u32 s35, 135168
  s_cselect_b32 s35, 0, s35
  s_lshl_b32 s31, s29, 4
  s_add_u32 s31, s31, s28
  s_lshl_b32 s31, s31, 7
  s_add_u32 s31, s31, 54722560
  s_cmp_eq_u32 s70, 0
  s_cselect_b32 s31, s31, 0x7ffffff0
  v_mov_b32 v53, 0x7ffffff0
  v_writelane_b32 v53, s31, 0
  v_mov_b32 v52, s1
  buffer_store_dword v52, v53, s[12:15], 0 offen sc1
  s_waitcnt vmcnt(12)
  s_waitcnt lgkmcnt(0)
  s_waitcnt lgkmcnt(0)
  s_barrier
  s_add_u32 s75, s80, 7
  s_cmp_ge_u32 s75, s78
  s_addc_u32 s75, s75, 0
  s_cmp_ge_u32 s75, s79
  s_addc_u32 s75, s75, 0
  s_mul_i32 s32, s75, 16384
  s_add_u32 s32, s32, s72
  s_mul_i32 s33, s75, 458752
  s_add_u32 s33, s33, s73
  s_add_u32 m0, s35, s37
  s_nop 0
  buffer_load_dwordx4 v25, s[4:7], s32 offen offset:0 sc1 lds
  buffer_load_dwordx4 v25, s[4:7], s32 offen offset:1024 sc1 lds
  buffer_load_dwordx4 v25, s[4:7], s32 offen offset:2048 sc1 lds
  buffer_load_dwordx4 v25, s[4:7], s32 offen offset:3072 sc1 lds
  s_add_u32 s31, s35, s38
  s_add_u32 m0, s31, 0
  s_nop 0
  buffer_load_dwordx4 v26, s[8:11], s33 offen offset:0 lds
  buffer_load_dwordx4 v27, s[8:11], s33 offen offset:1024 lds
  buffer_load_dwordx4 v28, s[8:11], s33 offen offset:2048 lds
  buffer_load_dwordx4 v29, s[8:11], s33 offen offset:3072 lds
  s_add_u32 s31, s35, s38
  s_add_u32 m0, s31, 4096
  s_nop 0
  buffer_load_dwordx4 v30, s[8:11], s33 offen offset:0 lds
  buffer_load_dwordx4 v31, s[8:11], s33 offen offset:1024 lds
  buffer_load_dwordx4 v32, s[8:11], s33 offen offset:2048 lds
  s_add_u32 s35, s35, 45056
  s_cmp_eq_u32 s35, 135168
  s_cselect_b32 s35, 0, s35
  s_waitcnt vmcnt(12)
  s_waitcnt lgkmcnt(0)
  s_waitcnt lgkmcnt(0)
  s_barrier
  s_add_u32 s75, s80, 8
  s_cmp_ge_u32 s75, s78
  s_addc_u32 s75, s75, 0
  s_cmp_ge_u32 s75, s79
  s_addc_u32 s75, s75, 0
  s_mul_i32 s32, s75, 16384
  s_add_u32 s32, s32, s72
  s_mul_i32 s33, s75, 458752
  s_add_u32 s33, s33, s73
  s_add_u32 m0, s35, s37
  s_nop 0
  buffer_load_dwordx4 v25, s[4:7], s32 offen offset:0 sc1 lds
  buffer_load_dwordx4 v25, s[4:7], s32 offen offset:1024 sc1 lds
  buffer_load_dwordx4 v25, s[4:7], s32 offen offset:2048 sc1 lds
  buffer_load_dwordx4 v25, s[4:7], s32 offen offset:3072 sc1 lds
  s_add_u32 s31, s35, s38
  s_add_u32 m0, s31, 0
  s_nop 0
  buffer_load_dwordx4 v26, s[8:11], s33 offen offset:0 lds
  buffer_load_dwordx4 v27, s[8:11], s33 offen offset:1024 lds
  buffer_load_dwordx4 v28, s[8:11], s33 offen offset:2048 lds
  buffer_load_dwordx4 v29, s[8:11], s33 offen offset:3072 lds
  s_add_u32 s31, s35, s38
  s_add_u32 m0, s31, 4096
  s_nop 0
  buffer_load_dwordx4 v30, s[8:11], s33 offen offset:0 lds
  buffer_load_dwordx4 v31, s[8:11], s33 offen offset:1024 lds
  buffer_load_dwordx4 v32, s[8:11], s33 offen offset:2048 lds
  s_add_u32 s35, s35, 45056
  s_cmp_eq_u32 s35, 135168
  s_cselect_b32 s35, 0, s35
  s_lshl_b32 s31, s28, 11
  s_add_u32 s31, s31, 54624256
  v_and_b32 v56, 15, v1
  v_lshlrev_b32 v56, 7, v56
  v_add_u32 v56, s31, v56
  buffer_load_dword v57, v56, s[12:15], 0 offen sc1
  s_waitcnt vmcnt(12)
  s_waitcnt lgkmcnt(0)
  s_waitcnt lgkmcnt(0)
  s_barrier
  s_add_u32 s75, s80, 9
  s_cmp_ge_u32 s75, s78
  s_addc_u32 s75, s75, 0
  s_cmp_ge_u32 s75, s79
  s_addc_u32 s75, s75, 0
  s_mul_i32 s32, s75, 16384
  s_add_u32 s32, s32, s72
  s_mul_i32 s33, s75, 458752
  s_add_u32 s33, s33, s73
  s_add_u32 m0, s35, s37
  s_nop 0
  buffer_load_dwordx4 v25, s[4:7], s32 offen offset:0 sc1 lds
  buffer_load_dwordx4 v25, s[4:7], s32 offen offset:1024 sc1 lds
  buffer_load_dwordx4 v25, s[4:7], s32 offen offset:2048 sc1 lds
  buffer_load_dwordx4 v25, s[4:7], s32 offen offset:3072 sc1 lds
  s_add_u32 s31, s35, s38
  s_add_u32 m0, s31, 0
  s_nop 0
  buffer_load_dwordx4 v26, s[8:11], s33 offen offset:0 lds
  buffer_load_dwordx4 v27, s[8:11], s33 offen offset:1024 lds
  buffer_load_dwordx4 v28, s[8:11], s33 offen offset:2048 lds
  buffer_load_dwordx4 v29, s[8:11], s33 offen offset:3072 lds
  s_add_u32 s31, s35, s38
  s_add_u32 m0, s31, 4096
  s_nop 0
  buffer_load_dwordx4 v30, s[8:11], s33 offen offset:0 lds
  buffer_load_dwordx4 v31, s[8:11], s33 offen offset:1024 lds
  buffer_load_dwordx4 v32, s[8:11], s33 offen offset:2048 lds
  s_add_u32 s35, s35, 45056
  s_cmp_eq_u32 s35, 135168
  s_cselect_b32 s35, 0, s35
  s_lshl_b32 s31, s29, 11
  s_add_u32 s31, s31, 54722560
  v_and_b32 v52, 15, v1
  v_lshlrev_b32 v52, 7, v52
  v_add_u32 v52, s31, v52
  buffer_load_dword v53, v52, s[12:15], 0 offen sc1
  s_waitcnt vmcnt(13)
  s_waitcnt lgkmcnt(0)
  s_waitcnt lgkmcnt(0)
  s_barrier
  s_add_u32 s75, s80, 10
  s_cmp_ge_u32 s75, s78
  s_addc_u32 s75, s75, 0
  s_cmp_ge_u32 s75, s79
  s_addc_u32 s75, s75, 0
  s_mul_i32 s32, s75, 16384
  s_add_u32 s32, s32, s72
  s_mul_i32 s33, s75, 458752
  s_add_u32 s33, s33, s73
  s_add_u32 m0, s35, s37
  s_nop 0
  buffer_load_dwordx4 v25, s[4:7], s32 offen offset:0 sc1 lds
  buffer_load_dwordx4 v25, s[4:7], s32 offen offset:1024 sc1 lds
  buffer_load_dwordx4 v25, s[4:7], s32 offen offset:2048 sc1 lds
  buffer_load_dwordx4 v25, s[4:7], s32 offen offset:3072 sc1 lds
  s_add_u32 s31, s35, s38
  s_add_u32 m0, s31, 0
  s_nop 0
  buffer_load_dwordx4 v26, s[8:11], s33 offen offset:0 lds
  buffer_load_dwordx4 v27, s[8:11], s33 offen offset:1024 lds
  buffer_load_dwordx4 v28, s[8:11], s33 offen offset:2048 lds
  buffer_load_dwordx4 v29, s[8:11], s33 offen offset:3072 lds
  s_add_u32 s31, s35, s38
  s_add_u32 m0, s31, 4096
  s_nop 0
  buffer_load_dwordx4 v30, s[8:11], s33 offen offset:0 lds
  buffer_load_dwordx4 v31, s[8:11], s33 offen offset:1024 lds
  buffer_load_dwordx4 v32, s[8:11], s33 offen offset:2048 lds
  s_add_u32 s35, s35, 45056
  s_cmp_eq_u32 s35, 135168
  s_cselect_b32 s35, 0, s35
  s_waitcnt vmcnt(23)
  v_cmp_eq_u32 vcc, s1, v57
  s_nop 4
  s_cmp_eq_u64 vcc, exec
  s_cbranch_scc1 L_s2ready
  s_mov_b32 s36, 400000
L_poll_s2:
  buffer_load_dword v57, v56, s[12:15], 0 offen sc1
  s_waitcnt vmcnt(0)
  v_cmp_eq_u32 vcc, s1, v57
  s_nop 4
  s_cmp_eq_u64 vcc, exec
  s_cbranch_scc1 L_polldone_s2
  s_sleep 4
  s_sub_u32 s36, s36, 1
  s_cmp_lg_u32 s36, 0
  s_cbranch_scc1 L_poll_s2
L_polldone_s2:
L_s2ready:
  v_and_b32 v2, 15, v1
  v_lshlrev_b32 v2, 4, v2
  v_lshrrev_b32 v3, 4, v1
  v_lshlrev_b32 v3, 14, v3
  v_add_u32 v54, v2, v3
  s_lshl_b32 s39, s28, 7
  s_lshl_b32 s40, s70, 5
  s_add_u32 s39, s39, s40
  s_lshl_b32 s39, s39, 3
  s_add_u32 s39, s39, 38797312
  buffer_load_dwordx4 v[64:67], v54, s[12:15], s39 offen sc1
  s_add_u32 s39, s39, 65536
  buffer_load_dwordx4 v[68:71], v54, s[12:15], s39 offen sc1
  s_add_u32 s39, s39, 65536
  buffer_load_dwordx4 v[72:75], v54, s[12:15], s39 offen sc1
  s_add_u32 s39, s39, 65536
  buffer_load_dwordx4 v[76:79], v54, s[12:15], s39 offen sc1
  s_add_u32 s39, s39, 65536
  buffer_load_dwordx4 v[80:83], v54, s[12:15], s39 offen sc1
  s_add_u32 s39, s39, 65536
  buffer_load_dwordx4 v[84:87], v54, s[12:15], s39 offen sc1
  s_add_u32 s39, s39, 65536
  buffer_load_dwordx4 v[88:91], v54, s[12:15], s39 offen sc1
  s_add_u32 s39, s39, 65536
  buffer_load_dwordx4 v[92:95], v54, s[12:15], s39 offen sc1
  s_add_u32 s39, s39, 65536
  s_waitcnt vmcnt(20)
  s_waitcnt lgkmcnt(0)
  s_waitcnt lgkmcnt(0)
  s_barrier
  s_add_u32 s75, s80, 11
  s_cmp_ge_u32 s75, s78
  s_addc_u32 s75, s75, 0
  s_cmp_ge_u32 s75, s79
  s_addc_u32 s75, s75, 0
  s_mul_i32 s32, s75, 16384
  s_add_u32 s32, s32, s72
  s_mul_i32 s33, s75, 458752
  s_add_u32 s33, s33, s73
  s_add_u32 m0, s35, s37
  s_nop 0
  buffer_load_dwordx4 v25, s[4:7], s32 offen offset:0 sc1 lds
  buffer_load_dwordx4 v25, s[4:7], s32 offen offset:1024 sc1 lds
  buffer_load_dwordx4 v25, s[4:7], s32 offen offset:2048 sc1 lds
  buffer_load_dwordx4 v25, s[4:7], s32 offen offset:3072 sc1 lds
  s_add_u32 s31, s35, s38
  s_add_u32 m0, s31, 0
  s_nop 0
  buffer_load_dwordx4 v26, s[8:11], s33 offen offset:0 lds
  buffer_load_dwordx4 v27, s[8:11], s33 offen offset:1024 lds
  buffer_load_dwordx4 v28, s[8:11], s33 offen offset:2048 lds
  buffer_load_dwordx4 v29, s[8:11], s33 offen offset:3072 lds
  s_add_u32 s31, s35, s38
  s_add_u32 m0, s31, 4096
  s_nop 0
  buffer_load_dwordx4 v30, s[8:11], s33 offen offset:0 lds
  buffer_load_dwordx4 v31, s[8:11], s33 offen offset:1024 lds
  buffer_load_dwordx4 v32, s[8:11], s33 offen offset:2048 lds
  s_add_u32 s35, s35, 45056
  s_cmp_eq_u32 s35, 135168
  s_cselect_b32 s35, 0, s35
  s_waitcnt vmcnt(30)
  v_cmp_eq_u32 vcc, s1, v53
  s_nop 4
  s_cmp_eq_u64 vcc, exec
  s_cbranch_scc1 L_cs1ready
  s_mov_b32 s36, 400000
L_poll_cs1:
  buffer_load_dword v53, v52, s[12:15], 0 offen sc1
  s_waitcnt vmcnt(0)
  v_cmp_eq_u32 vcc, s1, v53
  s_nop 4
  s_cmp_eq_u64 vcc, exec
  s_cbranch_scc1 L_polldone_cs1
  s_sleep 4
  s_sub_u32 s36, s36, 1
  s_cmp_lg_u32 s36, 0
  s_cbranch_scc1 L_poll_cs1
L_polldone_cs1:
L_cs1ready:
  s_mul_i32 s39, s29, 896
  s_mul_i32 s31, s70, 224
  s_add_u32 s39, s39, s31
  s_add_u32 s39, s39, 38273024
  v_lshrrev_b32 v55, 4, v1
  v_mul_u32_u24 v55, 14336, v55
  v_and_b32 v3, 15, v1
  v_cmp_gt_u32 vcc, 14, v3
  v_lshlrev_b32 v3, 4, v3
  v_add_u32 v55, v55, v3
  v_mov_b32 v3, 0x7ffffff0
  v_cndmask_b32 v55, v3, v55, vcc
  buffer_load_dwordx4 v[96:99], v55, s[12:15], s39 offen sc1
  s_add_u32 s39, s39, 57344
  buffer_load_dwordx4 v[100:103], v55, s[12:15], s39 offen sc1
  s_add_u32 s39, s39, 57344
  buffer_load_dwordx4 v[104:107], v55, s[12:15], s39 offen sc1
  s_add_u32 s39, s39, 57344
  buffer_load_dwordx4 v[108:111], v55, s[12:15], s39 offen sc1
  s_add_u32 s39, s39, 57344
  s_waitcnt vmcnt(23)
  s_waitcnt lgkmcnt(0)
  s_waitcnt lgkmcnt(0)
  s_barrier
  s_add_u32 s75, s80, 12
  s_cmp_ge_u32 s75, s78
  s_addc_u32 s75, s75, 0
  s_cmp_ge_u32 s75, s79
  s_addc_u32 s75, s75, 0
  s_mul_i32 s32, s75, 16384
  s_add_u32 s32, s32, s72
  s_mul_i32 s33, s75, 458752
  s_add_u32 s33, s33, s73
  s_add_u32 m0, s35, s37
  s_nop 0
  buffer_load_dwordx4 v25, s[4:7], s32 offen offset:0 sc1 lds
  buffer_load_dwordx4 v25, s[4:7], s32 offen offset:1024 sc1 lds
  buffer_load_dwordx4 v25, s[4:7], s32 offen offset:2048 sc1 lds
  buffer_load_dwordx4 v25, s[4:7], s32 offen offset:3072 sc1 lds
  s_add_u32 s31, s35, s38
  s_add_u32 m0, s31, 0
  s_nop 0
  buffer_load_dwordx4 v26, s[8:11], s33 offen offset:0 lds
  buffer_load_dwordx4 v27, s[8:11], s33 offen offset:1024 lds
  buffer_load_dwordx4 v28, s[8:11], s33 offen offset:2048 lds
  buffer_load_dwordx4 v29, s[8:11], s33 offen offset:3072 lds
  s_add_u32 s31, s35, s38
  s_add_u32 m0, s31, 4096
  s_nop 0
  buffer_load_dwordx4 v30, s[8:11], s33 offen offset:0 lds
  buffer_load_dwordx4 v31, s[8:11], s33 offen offset:1024 lds
  buffer_load_dwordx4 v32, s[8:11], s33 offen offset:2048 lds
  s_add_u32 s35, s35, 45056
  s_cmp_eq_u32 s35, 135168
  s_cselect_b32 s35, 0, s35
  s_waitcnt vmcnt(15)
  s_waitcnt lgkmcnt(0)
  s_waitcnt lgkmcnt(0)
  s_barrier
  s_add_u32 s75, s80, 13
  s_cmp_ge_u32 s75, s78
  s_addc_u32 s75, s75, 0
  s_cmp_ge_u32 s75, s79
  s_addc_u32 s75, s75, 0
  s_mul_i32 s32, s75, 16384
  s_add_u32 s32, s32, s72
  s_mul_i32 s33, s75, 458752
  s_add_u32 s33, s33, s73
  s_add_u32 m0, s35, s37
  s_nop 0
  buffer_load_dwordx4 v25, s[4:7], s32 offen offset:0 sc1 lds
  buffer_load_dwordx4 v25, s[4:7], s32 offen offset:1024 sc1 lds
  buffer_load_dwordx4 v25, s[4:7], s32 offen offset:2048 sc1 lds
  buffer_load_dwordx4 v25, s[4:7], s32 offen offset:3072 sc1 lds
  s_add_u32 s31, s35, s38
  s_add_u32 m0, s31, 0
  s_nop 0
  buffer_load_dwordx4 v26, s[8:11], s33 offen offset:0 lds
  buffer_load_dwordx4 v27, s[8:11], s33 offen offset:1024 lds
  buffer_load_dwordx4 v28, s[8:11], s33 offen offset:2048 lds
  buffer_load_dwordx4 v29, s[8:11], s33 offen offset:3072 lds
  s_add_u32 s31, s35, s38
  s_add_u32 m0, s31, 4096
  s_nop 0
  buffer_load_dwordx4 v30, s[8:11], s33 offen offset:0 lds
  buffer_load_dwordx4 v31, s[8:11], s33 offen offset:1024 lds
  buffer_load_dwordx4 v32, s[8:11], s33 offen offset:2048 lds
  s_add_u32 s35, s35, 45056
  s_cmp_eq_u32 s35, 135168
  s_cselect_b32 s35, 0, s35
  v_add_f32 v112, v64, v68
  v_add_f32 v113, v66, v70
  v_add_f32 v112, v112, v72
  v_add_f32 v113, v113, v74
  v_add_f32 v112, v112, v76
  v_add_f32 v113, v113, v78
  v_add_f32 v112, v112, v80
  v_add_f32 v113, v113, v82
  v_add_f32 v112, v112, v84
  v_add_f32 v113, v113, v86
  v_add_f32 v112, v112, v88
  v_add_f32 v113, v113, v90
  v_add_f32 v112, v112, v92
  v_add_f32 v113, v113, v94
  v_mov_b32 v118, v112
  v_mov_b32 v119, v113
  s_nop 1
  v_permlane16_swap_b32 v118, v112
  v_permlane16_swap_b32 v119, v113
  s_nop 1
  v_add_f32 v112, v112, v118
  v_add_f32 v113, v113, v119
  v_mov_b32 v118, v112
  v_mov_b32 v119, v113
  s_nop 1
  v_permlane32_swap_b32 v118, v112
  v_permlane32_swap_b32 v119, v113
  s_nop 1
  v_add_f32 v112, v112, v118
  v_add_f32 v113, v113, v119
  v_mul_f32 v112, 0x3a800000, v112
  v_mov_b32 v114, 0
  v_mul_f32 v113, 0x3a800000, v113
  v_mov_b32 v115, 0
  v_mov_b32 v116, 0x3d000000
  v_mov_b32 v117, 0x42000000
  s_waitcnt vmcnt(11)
  s_waitcnt lgkmcnt(0)
  s_waitcnt lgkmcnt(0)
  s_barrier
  v_fma_f32 v3, v64, v116, -v112
  v_fma_f32 v4, v66, v116, -v113
  v_mul_f32 v3, v3, v3
  v_mul_f32 v4, v4, v4
  v_fma_f32 v3, v3, v117, v65
  v_fma_f32 v4, v4, v117, v67
  v_add_f32 v114, v114, v3
  v_add_f32 v115, v115, v4
  v_fma_f32 v3, v68, v116, -v112
  v_fma_f32 v4, v70, v116, -v113
  v_mul_f32 v3, v3, v3
  v_mul_f32 v4, v4, v4
  v_fma_f32 v3, v3, v117, v69
  v_fma_f32 v4, v4, v117, v71
  v_add_f32 v114, v114, v3
  v_add_f32 v115, v115, v4
  v_fma_f32 v3, v72, v116, -v112
  v_fma_f32 v4, v74, v116, -v113
  v_mul_f32 v3, v3, v3
  v_mul_f32 v4, v4, v4
  v_fma_f32 v3, v3, v117, v73
  v_fma_f32 v4, v4, v117, v75
  v_add_f32 v114, v114, v3
  v_add_f32 v115, v115, v4
  v_fma_f32 v3, v76, v116, -v112
  v_fma_f32 v4, v78, v116, -v113
  v_mul_f32 v3, v3, v3
  v_mul_f32 v4, v4, v4
  v_fma_f32 v3, v3, v117, v77
  v_fma_f32 v4, v4, v117, v79
  v_add_f32 v114, v114, v3
  v_add_f32 v115, v115, v4
  v_fma_f32 v3, v80, v116, -v112
  v_fma_f32 v4, v82, v116, -v113
  v_mul_f32 v3, v3, v3
  v_mul_f32 v4, v4, v4
  v_fma_f32 v3, v3, v117, v81
  v_fma_f32 v4, v4, v117, v83
  v_add_f32 v114, v114, v3
  v_add_f32 v115, v115, v4
  v_fma_f32 v3, v84, v116, -v112
  v_fma_f32 v4, v86, v116, -v113
  v_mul_f32 v3, v3, v3
  v_mul_f32 v4, v4, v4
  v_fma_f32 v3, v3, v117, v85
  v_fma_f32 v4, v4, v117, v87
  v_add_f32 v114, v114, v3
  v_add_f32 v115, v115, v4
  v_fma_f32 v3, v88, v116, -v112
  v_fma_f32 v4, v90, v116, -v113
  v_mul_f32 v3, v3, v3
  v_mul_f32 v4, v4, v4
  v_fma_f32 v3, v3, v117, v89
  v_fma_f32 v4, v4, v117, v91
  v_add_f32 v114, v114, v3
  v_add_f32 v115, v115, v4
  v_fma_f32 v3, v92, v116, -v112
  v_fma_f32 v4, v94, v116, -v113
  v_mul_f32 v3, v3, v3
  v_mul_f32 v4, v4, v4
  v_fma_f32 v3, v3, v117, v93
  v_fma_f32 v4, v4, v117, v95
  v_add_f32 v114, v114, v3
  v_add_f32 v115, v115, v4
  v_mov_b32 v118, v114
  v_mov_b32 v119, v115
  s_nop 1
  v_permlane16_swap_b32 v118, v114
  v_permlane16_swap_b32 v119, v115
  s_nop 1
  v_add_f32 v114, v114, v118
  v_add_f32 v115, v115, v119
  v_mov_b32 v118, v114
  v_mov_b32 v119, v115
  s_nop 1
  v_permlane32_swap_b32 v118, v114
  v_permlane32_swap_b32 v119, v115
  s_nop 1
  v_add_f32 v114, v114, v118
  v_add_f32 v115, v115, v119
  v_mul_f32 v114, 0x3a800000, v114
  v_add_f32 v114, 0x3727c5ac, v114
  v_mul_f32 v115, 0x3a800000, v115
  v_add_f32 v115, 0x3727c5ac, v115
  v_rsq_f32 v114, v114
  v_rsq_f32 v115, v115
  v_and_b32 v2, 15, v1
  v_lshlrev_b32 v2, 3, v2
  s_lshl_b32 s31, s70, 7
  s_add_u32 s31, s31, 161792
  v_add_u32 v2, s31, v2
  v_cmp_gt_u32 vcc, 16, v1
  s_and_saveexec_b64 s[62:63], vcc
  ds_write_b64 v2, v[112:113]
  ds_write_b64 v2, v[114:115] offset:512
  s_mov_b64 exec, s[62:63]
  s_waitcnt vmcnt(0)
  s_waitcnt lgkmcnt(0)
  s_waitcnt lgkmcnt(0)
  s_barrier
  v_add_f32 v96, v96, v100
  v_add_f32 v104, v104, v108
  v_add_f32 v97, v97, v101
  v_add_f32 v105, v105, v109
  v_add_f32 v98, v98, v102
  v_add_f32 v106, v106, v110
  v_add_f32 v99, v99, v103
  v_add_f32 v107, v107, v111
  v_add_f32 v96, v96, v104
  v_add_f32 v97, v97, v105
  v_add_f32 v98, v98, v106
  v_add_f32 v99, v99, v107
  v_mov_b32 v118, v96
  v_mov_b32 v119, v97
  v_mov_b32 v120, v98
  v_mov_b32 v121, v99
  s_nop 1
  v_permlane16_swap_b32 v118, v96
  v_permlane16_swap_b32 v119, v97
  v_permlane16_swap_b32 v120, v98
  v_permlane16_swap_b32 v121, v99
  s_nop 1
  v_add_f32 v96, v96, v118
  v_add_f32 v97, v97, v119
  v_add_f32 v98, v98, v120
  v_add_f32 v99, v99, v121
  v_mov_b32 v118, v96
  v_mov_b32 v119, v97
  v_mov_b32 v120, v98
  v_mov_b32 v121, v99
  s_nop 1
  v_permlane32_swap_b32 v118, v96
  v_permlane32_swap_b32 v119, v97
  v_permlane32_swap_b32 v120, v98
  v_permlane32_swap_b32 v121, v99
  s_nop 1
  v_add_f32 v96, v96, v118
  v_add_f32 v97, v97, v119
  v_add_f32 v98, v98, v120
  v_add_f32 v99, v99, v121
  s_mul_i32 s31, s70, 224
  s_add_u32 s31, s31, 162816
  v_lshlrev_b32 v2, 4, v1
  v_add_u32 v2, s31, v2
  v_cmp_gt_u32 vcc, 14, v1
  s_and_saveexec_b64 s[62:63], vcc
  ds_write_b128 v2, v[96:99]
  s_mov_b64 exec, s[62:63]
  s_waitcnt lgkmcnt(0)
  s_waitcnt lgkmcnt(0)
  s_barrier
  s_mov_b32 s8, s54
  s_mov_b32 s9, s55
  s_mov_b32 s10, 7340032
  s_mov_b32 s11, 0x20000
  s_lshl_b32 s69, s70, 8
  v_add_u32 v9, s69, v1
  v_mul_u32_u24 v8, 0x1001, v9
  v_lshrrev_b32 v8, 16, v8
  v_lshlrev_b32 v7, 4, v8
  v_sub_u32 v9, v9, v7
  v_and_b32 v7, 7, v8
  v_lshlrev_b32 v7, 1, v7
  v_xor_b32 v9, v9, v7
  v_lshlrev_b32 v34, 11, v8
  v_lshlrev_b32 v7, 4, v9
  v_add_u32 v34, v34, v7
  s_lshl_b32 s68, s70, 8
  s_add_u32 s69, s68, 64
  v_add_u32 v9, s69, v1
  v_mul_u32_u24 v8, 0x1001, v9
  v_lshrrev_b32 v8, 16, v8
  v_lshlrev_b32 v7, 4, v8
  v_sub_u32 v9, v9, v7
  v_and_b32 v7, 7, v8
  v_lshlrev_b32 v7, 1, v7
  v_xor_b32 v9, v9, v7
  v_lshlrev_b32 v35, 11, v8
  v_lshlrev_b32 v7, 4, v9
  v_add_u32 v35, v35, v7
  v_subrev_u32 v35, 0x400, v35
  s_lshl_b32 s68, s70, 8
  s_add_u32 s69, s68, 0x80
  v_add_u32 v9, s69, v1
  v_mul_u32_u24 v8, 0x1001, v9
  v_lshrrev_b32 v8, 16, v8
  v_lshlrev_b32 v7, 4, v8
  v_sub_u32 v9, v9, v7
  v_and_b32 v7, 7, v8
  v_lshlrev_b32 v7, 1, v7
  v_xor_b32 v9, v9, v7
  v_lshlrev_b32 v36, 11, v8
  v_lshlrev_b32 v7, 4, v9
  v_add_u32 v36, v36, v7
  v_subrev_u32 v36, 0x800, v36
  s_lshl_b32 s68, s70, 8
  s_add_u32 s69, s68, 0xc0
  v_add_u32 v9, s69, v1
  v_mul_u32_u24 v8, 0x1001, v9
  v_lshrrev_b32 v8, 16, v8
  v_lshlrev_b32 v7, 4, v8
  v_sub_u32 v9, v9, v7
  v_and_b32 v7, 7, v8
  v_lshlrev_b32 v7, 1, v7
  v_xor_b32 v9, v9, v7
  v_lshlrev_b32 v37, 11, v8
  v_lshlrev_b32 v7, 4, v9
  v_add_u32 v37, v37, v7
  v_subrev_u32 v37, 0xc00, v37
  s_lshl_b32 s69, s70, 12
  v_lshlrev_b32 v33, 4, v1
  v_add_u32 v33, s69, v33
  s_and_b32 s31, s29, 7
  s_lshl_b32 s33, s31, 8
  s_lshr_b32 s31, s29, 3
  s_mul_i32 s31, s31, 3670016
  s_add_u32 s33, s33, s31
  s_mul_i32 s32, s28, 917504
  s_add_u32 s32, s32, 20971520
  s_lshr_b32 s31, s29, 3
  s_mul_i32 s31, s31, 458752
  s_add_u32 s32, s32, s31
  s_lshl_b32 s37, s70, 12
  s_mul_i32 s38, s70, 4096
  s_add_u32 s38, s38, 16384
  s_mul_i32 s76, s29, 7
  s_add_u32 s76, s76, 1
  s_lshr_b32 s76, s76, 1
  s_lshr_b32 s31, s29, 3
  s_mul_i32 s31, s31, 28
  s_sub_u32 s76, s76, s31
  s_mov_b32 s72, s32
  s_mov_b32 s73, s33
  s_mul_i32 s33, s76, 131072
  s_add_u32 s33, s33, s73
  s_mov_b32 s35, 0
  s_add_u32 s31, s35, s38
  s_add_u32 m0, s31, 0
  s_nop 0
  buffer_load_dwordx4 v34, s[8:11], s33 offen offset:0 lds
  buffer_load_dwordx4 v35, s[8:11], s33 offen offset:1024 lds
  buffer_load_dwordx4 v36, s[8:11], s33 offen offset:2048 lds
  buffer_load_dwordx4 v37, s[8:11], s33 offen offset:3072 lds
  s_add_u32 s33, s33, 131072
  s_add_u32 s35, s35, 32768
  s_add_u32 s31, s35, s38
  s_add_u32 m0, s31, 0
  s_nop 0
  buffer_load_dwordx4 v34, s[8:11], s33 offen offset:0 lds
  buffer_load_dwordx4 v35, s[8:11], s33 offen offset:1024 lds
  buffer_load_dwordx4 v36, s[8:11], s33 offen offset:2048 lds
  buffer_load_dwordx4 v37, s[8:11], s33 offen offset:3072 lds
  s_add_u32 s33, s33, 131072
  s_add_u32 s35, s35, 32768
  s_add_u32 s31, s35, s38
  s_add_u32 m0, s31, 0
  s_nop 0
  buffer_load_dwordx4 v34, s[8:11], s33 offen offset:0 lds
  buffer_load_dwordx4 v35, s[8:11], s33 offen offset:1024 lds
  buffer_load_dwordx4 v36, s[8:11], s33 offen offset:2048 lds
  buffer_load_dwordx4 v37, s[8:11], s33 offen offset:3072 lds
  s_add_u32 s33, s33, 131072
  s_add_u32 s35, s35, 32768
  s_waitcnt vmcnt(8)
  s_barrier
  s_waitcnt vmcnt(4)
  s_barrier
  s_waitcnt vmcnt(0)
  s_barrier
  s_barrier
  s_mov_b32 s35, 0
  s_mov_b32 s75, 0
  s_cmp_ge_u32 s75, s76
  s_cselect_b32 s32, 3, 0
  s_add_u32 s75, s75, s32
  s_mul_i32 s32, s75, 16384
  s_add_u32 s32, s32, s72
  s_mul_i32 s33, s75, 131072
  s_add_u32 s33, s33, s73
  s_add_u32 s31, s35, s38
  s_add_u32 m0, s31, 0
  s_nop 0
  buffer_load_dwordx4 v34, s[8:11], s33 offen offset:0 lds
  buffer_load_dwordx4 v35, s[8:11], s33 offen offset:1024 lds
  buffer_load_dwordx4 v36, s[8:11], s33 offen offset:2048 lds
  buffer_load_dwordx4 v37, s[8:11], s33 offen offset:3072 lds
  s_add_u32 s35, s35, 32768
  s_mov_b32 s75, 1
  s_cmp_ge_u32 s75, s76
  s_cselect_b32 s32, 3, 0
  s_add_u32 s75, s75, s32
  s_mul_i32 s32, s75, 16384
  s_add_u32 s32, s32, s72
  s_mul_i32 s33, s75, 131072
  s_add_u32 s33, s33, s73
  s_add_u32 s31, s35, s38
  s_add_u32 m0, s31, 0
  s_nop 0
  buffer_load_dwordx4 v34, s[8:11], s33 offen offset:0 lds
  buffer_load_dwordx4 v35, s[8:11], s33 offen offset:1024 lds
  buffer_load_dwordx4 v36, s[8:11], s33 offen offset:2048 lds
  buffer_load_dwordx4 v37, s[8:11], s33 offen offset:3072 lds
  s_add_u32 s35, s35, 32768
  s_mov_b32 s75, 2
  s_cmp_ge_u32 s75, s76
  s_cselect_b32 s32, 3, 0
  s_add_u32 s75, s75, s32
  s_mul_i32 s32, s75, 16384
  s_add_u32 s32, s32, s72
  s_mul_i32 s33, s75, 131072
  s_add_u32 s33, s33, s73
  s_add_u32 s31, s35, s38
  s_add_u32 m0, s31, 0
  s_nop 0
  buffer_load_dwordx4 v34, s[8:11], s33 offen offset:0 lds
  buffer_load_dwordx4 v35, s[8:11], s33 offen offset:1024 lds
  buffer_load_dwordx4 v36, s[8:11], s33 offen offset:2048 lds
  buffer_load_dwordx4 v37, s[8:11], s33 offen offset:3072 lds
  s_add_u32 s35, s35, 32768
  s_mov_b32 s75, 3
  s_cmp_ge_u32 s75, s76
  s_cselect_b32 s32, 3, 0
  s_add_u32 s75, s75, s32
  s_mul_i32 s32, s75, 16384
  s_add_u32 s32, s32, s72
  s_mul_i32 s33, s75, 131072
  s_add_u32 s33, s33, s73
  s_add_u32 s31, s35, s38
  s_add_u32 m0, s31, 0
  s_nop 0
  buffer_load_dwordx4 v34, s[8:11], s33 offen offset:0 lds
  buffer_load_dwordx4 v35, s[8:11], s33 offen offset:1024 lds
  buffer_load_dwordx4 v36, s[8:11], s33 offen offset:2048 lds
  buffer_load_dwordx4 v37, s[8:11], s33 offen offset:3072 lds
  s_add_u32 s35, s35, 32768
  s_mov_b32 s4, s60
  s_mov_b32 s5, s61
  s_mov_b32 s6, 58720256
  s_mov_b32 s7, 0x20000
  s_barrier
  s_mov_b32 s35, 0
  s_mov_b32 s75, 0
  s_cmp_ge_u32 s75, s76
  s_cselect_b32 s32, 3, 0
  s_add_u32 s75, s75, s32
  s_mul_i32 s32, s75, 16384
  s_add_u32 s32, s32, s72
  s_mul_i32 s33, s75, 131072
  s_add_u32 s33, s33, s73
  s_add_u32 m0, s35, s37
  s_nop 0
  buffer_load_dwordx4 v33, s[4:7], s32 offen offset:0 sc1 lds
  buffer_load_dwordx4 v33, s[4:7], s32 offen offset:1024 sc1 lds
  buffer_load_dwordx4 v33, s[4:7], s32 offen offset:2048 sc1 lds
  buffer_load_dwordx4 v33, s[4:7], s32 offen offset:3072 sc1 lds
  s_add_u32 s35, s35, 32768
  s_mov_b32 s75, 1
  s_cmp_ge_u32 s75, s76
  s_cselect_b32 s32, 3, 0
  s_add_u32 s75, s75, s32
  s_mul_i32 s32, s75, 16384
  s_add_u32 s32, s32, s72
  s_mul_i32 s33, s75, 131072
  s_add_u32 s33, s33, s73
  s_add_u32 m0, s35, s37
  s_nop 0
  buffer_load_dwordx4 v33, s[4:7], s32 offen offset:0 sc1 lds
  buffer_load_dwordx4 v33, s[4:7], s32 offen offset:1024 sc1 lds
  buffer_load_dwordx4 v33, s[4:7], s32 offen offset:2048 sc1 lds
  buffer_load_dwordx4 v33, s[4:7], s32 offen offset:3072 sc1 lds
  s_add_u32 s35, s35, 32768
  s_mov_b32 s75, 2
  s_cmp_ge_u32 s75, s76
  s_cselect_b32 s32, 3, 0
  s_add_u32 s75, s75, s32
  s_mul_i32 s32, s75, 16384
  s_add_u32 s32, s32, s72
  s_mul_i32 s33, s75, 131072
  s_add_u32 s33, s33, s73
  s_add_u32 m0, s35, s37
  s_nop 0
  buffer_load_dwordx4 v33, s[4:7], s32 offen offset:0 sc1 lds
  buffer_load_dwordx4 v33, s[4:7], s32 offen offset:1024 sc1 lds
  buffer_load_dwordx4 v33, s[4:7], s32 offen offset:2048 sc1 lds
  buffer_load_dwordx4 v33, s[4:7], s32 offen offset:3072 sc1 lds
  s_add_u32 s35, s35, 32768
  s_mov_b32 s75, 3
  s_cmp_ge_u32 s75, s76
  s_cselect_b32 s32, 3, 0
  s_add_u32 s75, s75, s32
  s_mul_i32 s32, s75, 16384
  s_add_u32 s32, s32, s72
  s_mul_i32 s33, s75, 131072
  s_add_u32 s33, s33, s73
  s_add_u32 m0, s35, s37
  s_nop 0
  buffer_load_dwordx4 v33, s[4:7], s32 offen offset:0 sc1 lds
  buffer_load_dwordx4 v33, s[4:7], s32 offen offset:1024 sc1 lds
  buffer_load_dwordx4 v33, s[4:7], s32 offen offset:2048 sc1 lds
  buffer_load_dwordx4 v33, s[4:7], s32 offen offset:3072 sc1 lds
  s_add_u32 s35, s35, 32768
  s_mov_b32 s35, 0
  s_waitcnt vmcnt(12)
  s_waitcnt lgkmcnt(0)
  s_barrier
  s_waitcnt vmcnt(8)
  s_waitcnt lgkmcnt(0)
  s_barrier
  s_mov_b32 s75, 4
  s_cmp_ge_u32 s75, s76
  s_cselect_b32 s32, 3, 0
  s_add_u32 s75, s75, s32
  s_mul_i32 s32, s75, 16384
  s_add_u32 s32, s32, s72
  s_mul_i32 s33, s75, 131072
  s_add_u32 s33, s33, s73
  s_add_u32 m0, s35, s37
  s_nop 0
  buffer_load_dwordx4 v33, s[4:7], s32 offen offset:0 sc1 lds
  buffer_load_dwordx4 v33, s[4:7], s32 offen offset:1024 sc1 lds
  buffer_load_dwordx4 v33, s[4:7], s32 offen offset:2048 sc1 lds
  buffer_load_dwordx4 v33, s[4:7], s32 offen offset:3072 sc1 lds
  s_add_u32 s31, s35, s38
  s_add_u32 m0, s31, 0
  s_nop 0
  buffer_load_dwordx4 v34, s[8:11], s33 offen offset:0 lds
  buffer_load_dwordx4 v35, s[8:11], s33 offen offset:1024 lds
  buffer_load_dwordx4 v36, s[8:11], s33 offen offset:2048 lds
  buffer_load_dwordx4 v37, s[8:11], s33 offen offset:3072 lds
  s_add_u32 s35, s35, 32768
  s_cmp_eq_u32 s35, 131072
  s_cselect_b32 s35, 0, s35
  s_waitcnt vmcnt(12)
  s_waitcnt lgkmcnt(0)
  s_waitcnt lgkmcnt(0)
  s_barrier
  s_mov_b32 s75, 5
  s_cmp_ge_u32 s75, s76
  s_cselect_b32 s32, 3, 0
  s_add_u32 s75, s75, s32
  s_mul_i32 s32, s75, 16384
  s_add_u32 s32, s32, s72
  s_mul_i32 s33, s75, 131072
  s_add_u32 s33, s33, s73
  s_add_u32 m0, s35, s37
  s_nop 0
  buffer_load_dwordx4 v33, s[4:7], s32 offen offset:0 sc1 lds
  buffer_load_dwordx4 v33, s[4:7], s32 offen offset:1024 sc1 lds
  buffer_load_dwordx4 v33, s[4:7], s32 offen offset:2048 sc1 lds
  buffer_load_dwordx4 v33, s[4:7], s32 offen offset:3072 sc1 lds
  s_add_u32 s31, s35, s38
  s_add_u32 m0, s31, 0
  s_nop 0
  buffer_load_dwordx4 v34, s[8:11], s33 offen offset:0 lds
  buffer_load_dwordx4 v35, s[8:11], s33 offen offset:1024 lds
  buffer_load_dwordx4 v36, s[8:11], s33 offen offset:2048 lds
  buffer_load_dwordx4 v37, s[8:11], s33 offen offset:3072 lds
  s_add_u32 s35, s35, 32768
  s_cmp_eq_u32 s35, 131072
  s_cselect_b32 s35, 0, s35
  s_waitcnt vmcnt(16)
  s_waitcnt lgkmcnt(0)
  s_waitcnt lgkmcnt(0)
  s_barrier
  s_mov_b32 s74, 5
  s_mov_b32 s36, 19
L_lloop_f2:
  s_add_u32 s74, s74, 1
  s_cmp_ge_u32 s74, s76
  s_cselect_b32 s32, 3, 0
  s_add_u32 s75, s74, s32
  s_mul_i32 s32, s75, 16384
  s_add_u32 s32, s32, s72
  s_mul_i32 s33, s75, 131072
  s_add_u32 s33, s33, s73
  s_add_u32 m0, s35, s37
  s_nop 0
  buffer_load_dwordx4 v33, s[4:7], s32 offen offset:0 sc1 lds
  buffer_load_dwordx4 v33, s[4:7], s32 offen offset:1024 sc1 lds
  buffer_load_dwordx4 v33, s[4:7], s32 offen offset:2048 sc1 lds
  buffer_load_dwordx4 v33, s[4:7], s32 offen offset:3072 sc1 lds
  s_add_u32 s31, s35, s38
  s_add_u32 m0, s31, 0
  s_nop 0
  buffer_load_dwordx4 v34, s[8:11], s33 offen offset:0 lds
  buffer_load_dwordx4 v35, s[8:11], s33 offen offset:1024 lds
  buffer_load_dwordx4 v36, s[8:11], s33 offen offset:2048 lds
  buffer_load_dwordx4 v37, s[8:11], s33 offen offset:3072 lds
  s_add_u32 s35, s35, 32768
  s_cmp_eq_u32 s35, 131072
  s_cselect_b32 s35, 0, s35
  s_waitcnt vmcnt(16)
  s_barrier
  s_sub_u32 s36, s36, 1
  s_cmp_lg_u32 s36, 0
  s_cbranch_scc1 L_lloop_f2
  s_waitcnt vmcnt(8)
  s_waitcnt lgkmcnt(0)
  s_waitcnt lgkmcnt(0)
  s_barrier
  s_waitcnt vmcnt(0)
  s_waitcnt lgkmcnt(0)
  s_waitcnt lgkmcnt(0)
  s_barrier
  s_waitcnt lgkmcnt(0)
  s_waitcnt lgkmcnt(0)
  s_barrier
  s_branch L_end
L_attn:
  s_setprio 3
  s_and_b32 s40, s30, 1
  s_lshr_b32 s41, s30, 1
  s_lshl_b32 s71, s28, 2
  s_add_u32 s71, s71, s41
  s_lshl_b32 s68, s40, 13
  s_lshl_b32 s67, s41, 11
  s_add_u32 s69, s68, s67
  v_lshrrev_b32 v236, 4, v1
  v_and_b32 v236, 1, v236
  v_lshlrev_b32 v236, 10, v236
  v_add_u32 v236, s69, v236
  v_lshrrev_b32 v7, 5, v1
  v_lshlrev_b32 v7, 4, v7
  v_and_b32 v6, 15, v1
  v_add_u32 v7, v7, v6
  v_lshlrev_b32 v7, 4, v7
  v_add_u32 v236, v236, v7
  v_add_u32 v236, 0x18000, v236
  s_mul_i32 s67, s40, 0xc000
  s_lshl_b32 s68, s41, 11
  s_add_u32 s69, s67, s68
  v_lshrrev_b32 v237, 3, v1
  v_and_b32 v237, 1, v237
  v_lshlrev_b32 v237, 10, v237
  v_add_u32 v237, s69, v237
  v_lshrrev_b32 v7, 5, v1
  v_lshlrev_b32 v7, 4, v7
  v_and_b32 v6, 7, v1
  v_add_u32 v7, v7, v6
  v_lshrrev_b32 v6, 4, v1
  v_and_b32 v6, 1, v6
  v_lshlrev_b32 v6, 3, v6
  v_add_u32 v7, v7, v6
  v_lshlrev_b32 v7, 4, v7
  v_add_u32 v237, v237, v7
  s_mul_i32 s68, s40, 0xc000
  s_lshl_b32 s67, s41, 11
  s_add_u32 s69, s68, s67
  v_lshrrev_b32 v238, 4, v1
  v_and_b32 v238, 1, v238
  v_lshlrev_b32 v238, 10, v238
  v_add_u32 v238, s69, v238
  v_lshrrev_b32 v7, 5, v1
  v_lshlrev_b32 v7, 4, v7
  v_and_b32 v6, 15, v1
  v_add_u32 v7, v7, v6
  v_lshlrev_b32 v7, 4, v7
  v_add_u32 v238, v238, v7
  v_add_u32 v238, 0x6000, v238
  s_lshl_b32 s31, s2, 3
  s_add_u32 s31, s31, s30
  s_mul_i32 s31, s31, 28
  v_min_u32 v241, 27, v1
  v_add_u32 v241, s31, v241
  v_lshlrev_b32 v241, 7, v241
  s_mov_b32 s76, 0xffffffff
  s_mov_b32 s77, 0xfffffff0
  s_mov_b32 s78, 0xfffffffe
  s_mov_b32 s79, 0xffffffe0
  s_mov_b32 s80, 0xfffffffc
  s_mov_b32 s81, 0xffffffc0
  s_mov_b32 s82, 0xfffffff8
  s_mov_b32 s83, 0xffffff80
  s_mov_b32 s84, 0xffff0000
  s_mov_b32 s85, 0xfff00000
  s_mov_b32 s86, 0xfffe0000
  s_mov_b32 s87, 0xffe00000
  s_mov_b32 s90, 0xfffc0000
  s_mov_b32 s91, 0xffc00000
  s_mov_b32 s92, 0xfff80000
  s_mov_b32 s93, 0xff800000
  s_mov_b32 s94, 0xffffff00
  s_mov_b32 s95, 0xfffff000
  s_mov_b32 s96, 0xfffffe00
  s_mov_b32 s97, 0xffffe000
  s_mov_b32 s98, 0xfffffc00
  s_mov_b32 s99, 0xffffc000
  s_mov_b32 s100, 0xfffff800
  s_mov_b32 s101, 0xffff8000
  s_mov_b32 s4, 0xff000000
  s_mov_b32 s5, 0xf0000000
  s_mov_b32 s6, 0xfe000000
  s_mov_b32 s7, 0xe0000000
  s_mov_b32 s24, 0xfc000000
  s_mov_b32 s25, 0xc0000000
  s_mov_b32 s26, 0xf8000000
  s_mov_b32 s27, 0x80000000
  v_mov_b32 v152, 0xf149f2ca
  v_mov_b32 v153, 0xf149f2ca
  v_mov_b32 v154, 0xf149f2ca
  v_mov_b32 v155, 0xf149f2ca
  v_mov_b32 v156, 0xf149f2ca
  v_mov_b32 v157, 0xf149f2ca
  v_mov_b32 v158, 0xf149f2ca
  v_mov_b32 v159, 0xf149f2ca
  v_mov_b32 v160, 0xf149f2ca
  v_mov_b32 v161, 0xf149f2ca
  v_mov_b32 v162, 0xf149f2ca
  v_mov_b32 v163, 0xf149f2ca
  v_mov_b32 v164, 0xf149f2ca
  v_mov_b32 v165, 0xf149f2ca
  v_mov_b32 v166, 0xf149f2ca
  v_mov_b32 v167, 0xf149f2ca
  v_mov_b32 v239, 0xf149f2ca
  v_mov_b32 v232, 0x3f803f80
  v_mov_b32 v233, 0x3f803f80
  v_mov_b32 v234, 0x3f803f80
  v_mov_b32 v235, 0x3f803f80
  s_cmp_eq_u32 s0, 1
  s_cbranch_scc1 L_kvstage
L_attn_go:
  s_barrier
  ds_read_b128 v[64:67], v236 offset:0
  ds_read_b128 v[68:71], v236 offset:512
  ds_read_b128 v[72:75], v237 offset:0
  ds_read_b128 v[76:79], v237 offset:512
  ds_read_b128 v[80:83], v237 offset:16384
  ds_read_b128 v[84:87], v237 offset:16896
  global_load_dword v254, v241, s[52:53]
  global_load_dword v254, v241, s[54:55]
  s_waitcnt lgkmcnt(3)
  s_cmp_ge_u32 s71, 8
  s_cbranch_scc0 L_inv_a_0
  v_mfma_f32_32x32x16_bf16 v[88:103], v[72:75], v[64:67], 0
L_invb_a_0:
  s_waitcnt lgkmcnt(2)
  v_mfma_f32_32x32x16_bf16 v[88:103], v[76:79], v[68:71], v[88:103]
  ds_read_b128 v[72:75], v237 offset:2048
  ds_read_b128 v[76:79], v237 offset:2560
  s_waitcnt lgkmcnt(3)
  v_mfma_f32_32x32x16_bf16 v[104:119], v[80:83], v[64:67], 0
  s_waitcnt lgkmcnt(2)
  v_mfma_f32_32x32x16_bf16 v[104:119], v[84:87], v[68:71], v[104:119]
  ds_read_b128 v[80:83], v237 offset:4096
  ds_read_b128 v[84:87], v237 offset:4608
  s_waitcnt lgkmcnt(3)
  s_cmp_ge_u32 s71, 7
  s_cbranch_scc0 L_inv_a_1
  v_mfma_f32_32x32x16_bf16 v[120:135], v[72:75], v[64:67], 0
L_invb_a_1:
  s_waitcnt lgkmcnt(2)
  v_mfma_f32_32x32x16_bf16 v[120:135], v[76:79], v[68:71], v[120:135]
  ds_read_b128 v[72:75], v237 offset:6144
  ds_read_b128 v[76:79], v237 offset:6656
  s_nop 1
  v_cndmask_b32 v88, v88, v104, s[76:77]
  v_cndmask_b32 v89, v89, v105, s[78:79]
  v_cndmask_b32 v90, v90, v106, s[80:81]
  v_cndmask_b32 v91, v91, v107, s[82:83]
  v_cndmask_b32 v92, v92, v108, s[84:85]
  v_cndmask_b32 v93, v93, v109, s[86:87]
  v_cndmask_b32 v94, v94, v110, s[90:91]
  v_cndmask_b32 v95, v95, v111, s[92:93]
  v_cndmask_b32 v96, v96, v112, s[94:95]
  v_cndmask_b32 v97, v97, v113, s[96:97]
  v_cndmask_b32 v98, v98, v114, s[98:99]
  v_cndmask_b32 v99, v99, v115, s[100:101]
  v_cndmask_b32 v100, v100, v116, s[4:5]
  v_cndmask_b32 v101, v101, v117, s[6:7]
  v_cndmask_b32 v102, v102, v118, s[24:25]
  v_cndmask_b32 v103, v103, v119, s[26:27]
  v_max3_f32 v239, v239, v88, v89
  v_max3_f32 v239, v239, v90, v91
  v_max3_f32 v239, v239, v92, v93
  v_max3_f32 v239, v239, v94, v95
  v_max3_f32 v239, v239, v96, v97
  v_max3_f32 v239, v239, v98, v99
  v_max3_f32 v239, v239, v100, v101
  v_max3_f32 v239, v239, v102, v103
  s_waitcnt lgkmcnt(3)
  s_cmp_ge_u32 s71, 6
  s_cbranch_scc0 L_inv_a_2
  v_mfma_f32_32x32x16_bf16 v[88:103], v[80:83], v[64:67], 0
L_invb_a_2:
  s_waitcnt lgkmcnt(2)
  v_mfma_f32_32x32x16_bf16 v[88:103], v[84:87], v[68:71], v[88:103]
  ds_read_b128 v[80:83], v237 offset:8192
  ds_read_b128 v[84:87], v237 offset:8704
  v_max3_f32 v239, v239, v120, v121
  v_max3_f32 v239, v239, v122, v123
  v_max3_f32 v239, v239, v124, v125
  v_max3_f32 v239, v239, v126, v127
  v_max3_f32 v239, v239, v128, v129
  v_max3_f32 v239, v239, v130, v131
  v_max3_f32 v239, v239, v132, v133
  v_max3_f32 v239, v239, v134, v135
  s_waitcnt lgkmcnt(3)
  s_cmp_ge_u32 s71, 5
  s_cbranch_scc0 L_inv_a_3
  v_mfma_f32_32x32x16_bf16 v[104:119], v[72:75], v[64:67], 0
L_invb_a_3:
  s_waitcnt lgkmcnt(2)
  v_mfma_f32_32x32x16_bf16 v[104:119], v[76:79], v[68:71], v[104:119]
  ds_read_b128 v[72:75], v237 offset:10240
  ds_read_b128 v[76:79], v237 offset:10752
  v_max3_f32 v239, v239, v88, v89
  v_max3_f32 v239, v239, v90, v91
  v_max3_f32 v239, v239, v92, v93
  v_max3_f32 v239, v239, v94, v95
  v_max3_f32 v239, v239, v96, v97
  v_max3_f32 v239, v239, v98, v99
  v_max3_f32 v239, v239, v100, v101
  v_max3_f32 v239, v239, v102, v103
  s_waitcnt lgkmcnt(3)
  s_cmp_ge_u32 s71, 4
  s_cbranch_scc0 L_inv_a_4
  v_mfma_f32_32x32x16_bf16 v[120:135], v[80:83], v[64:67], 0
L_invb_a_4:
  s_waitcnt lgkmcnt(2)
  v_mfma_f32_32x32x16_bf16 v[120:135], v[84:87], v[68:71], v[120:135]
  ds_read_b128 v[80:83], v237 offset:12288
  ds_read_b128 v[84:87], v237 offset:12800
  v_max3_f32 v239, v239, v104, v105
  v_max3_f32 v239, v239, v106, v107
  v_max3_f32 v239, v239, v108, v109
  v_max3_f32 v239, v239, v110, v111
  v_max3_f32 v239, v239, v112, v113
  v_max3_f32 v239, v239, v114, v115
  v_max3_f32 v239, v239, v116, v117
  v_max3_f32 v239, v239, v118, v119
  s_waitcnt lgkmcnt(3)
  s_cmp_ge_u32 s71, 3
  s_cbranch_scc0 L_inv_a_5
  v_mfma_f32_32x32x16_bf16 v[88:103], v[72:75], v[64:67], 0
L_invb_a_5:
  s_waitcnt lgkmcnt(2)
  v_mfma_f32_32x32x16_bf16 v[88:103], v[76:79], v[68:71], v[88:103]
  ds_read_b128 v[72:75], v237 offset:14336
  ds_read_b128 v[76:79], v237 offset:14848
  v_max3_f32 v239, v239, v120, v121
  v_max3_f32 v239, v239, v122, v123
  v_max3_f32 v239, v239, v124, v125
  v_max3_f32 v239, v239, v126, v127
  v_max3_f32 v239, v239, v128, v129
  v_max3_f32 v239, v239, v130, v131
  v_max3_f32 v239, v239, v132, v133
  v_max3_f32 v239, v239, v134, v135
  s_waitcnt lgkmcnt(3)
  s_cmp_ge_u32 s71, 2
  s_cbranch_scc0 L_inv_a_6
  v_mfma_f32_32x32x16_bf16 v[104:119], v[80:83], v[64:67], 0
L_invb_a_6:
  s_waitcnt lgkmcnt(2)
  v_mfma_f32_32x32x16_bf16 v[104:119], v[84:87], v[68:71], v[104:119]
  v_max3_f32 v239, v239, v88, v89
  v_max3_f32 v239, v239, v90, v91
  v_max3_f32 v239, v239, v92, v93
  v_max3_f32 v239, v239, v94, v95
  v_max3_f32 v239, v239, v96, v97
  v_max3_f32 v239, v239, v98, v99
  v_max3_f32 v239, v239, v100, v101
  v_max3_f32 v239, v239, v102, v103
  s_waitcnt lgkmcnt(1)
  s_cmp_ge_u32 s71, 1
  s_cbranch_scc0 L_inv_a_7
  v_mfma_f32_32x32x16_bf16 v[120:135], v[72:75], v[64:67], 0
L_invb_a_7:
  s_waitcnt lgkmcnt(0)
  v_mfma_f32_32x32x16_bf16 v[120:135], v[76:79], v[68:71], v[120:135]
  v_max3_f32 v239, v239, v104, v105
  v_max3_f32 v239, v239, v106, v107
  v_max3_f32 v239, v239, v108, v109
  v_max3_f32 v239, v239, v110, v111
  v_max3_f32 v239, v239, v112, v113
  v_max3_f32 v239, v239, v114, v115
  v_max3_f32 v239, v239, v116, v117
  v_max3_f32 v239, v239, v118, v119
  ds_read_b128 v[72:75], v237 offset:0
  ds_read_b128 v[76:79], v237 offset:512
  s_nop 1
  v_max3_f32 v239, v239, v120, v121
  v_max3_f32 v239, v239, v122, v123
  v_max3_f32 v239, v239, v124, v125
  v_max3_f32 v239, v239, v126, v127
  v_max3_f32 v239, v239, v128, v129
  v_max3_f32 v239, v239, v130, v131
  v_max3_f32 v239, v239, v132, v133
  v_max3_f32 v239, v239, v134, v135
  s_cmp_eq_u32 s0, 1
  s_cbranch_scc0 L_att_nov
  s_waitcnt vmcnt(2)
L_att_nov:
  s_waitcnt lgkmcnt(0)
  s_barrier
  ds_read_b128 v[80:83], v237 offset:16384
  ds_read_b128 v[84:87], v237 offset:16896
  ds_read_b128 v[200:203], v238 offset:16384
  ds_read_b128 v[204:207], v238 offset:16896
  ds_read_b128 v[208:211], v238 offset:0
  ds_read_b128 v[212:215], v238 offset:512
  v_mov_b32 v240, v239
  s_nop 1
  v_permlane32_swap_b32 v240, v239
  v_max_f32 v239, v239, v240
  v_sub_f32 v136, 0, v239
  v_sub_f32 v137, 0, v239
  v_sub_f32 v138, 0, v239
  v_sub_f32 v139, 0, v239
  v_sub_f32 v140, 0, v239
  v_sub_f32 v141, 0, v239
  v_sub_f32 v142, 0, v239
  v_sub_f32 v143, 0, v239
  v_sub_f32 v144, 0, v239
  v_sub_f32 v145, 0, v239
  v_sub_f32 v146, 0, v239
  v_sub_f32 v147, 0, v239
  v_sub_f32 v148, 0, v239
  v_sub_f32 v149, 0, v239
  v_sub_f32 v150, 0, v239
  v_sub_f32 v151, 0, v239
  s_setprio 2
  s_cmp_ge_u32 s71, 8
  s_cbranch_scc0 L_inv_b_0
  v_mfma_f32_32x32x16_bf16 v[88:103], v[72:75], v[64:67], v[136:151]
L_invb_b_0:
  v_mfma_f32_32x32x16_bf16 v[88:103], v[76:79], v[68:71], v[88:103]
  ds_read_b128 v[72:75], v237 offset:2048
  ds_read_b128 v[76:79], v237 offset:2560
  s_waitcnt lgkmcnt(7)
  v_mfma_f32_32x32x16_bf16 v[104:119], v[80:83], v[64:67], v[136:151]
  s_waitcnt lgkmcnt(6)
  v_mfma_f32_32x32x16_bf16 v[104:119], v[84:87], v[68:71], v[104:119]
  ds_read_b128 v[80:83], v237 offset:4096
  ds_read_b128 v[84:87], v237 offset:4608
  s_waitcnt lgkmcnt(3)
  s_cmp_ge_u32 s71, 7
  s_cbranch_scc0 L_inv_b_1
  v_mfma_f32_32x32x16_bf16 v[120:135], v[72:75], v[64:67], v[136:151]
L_invb_b_1:
  s_waitcnt lgkmcnt(2)
  v_mfma_f32_32x32x16_bf16 v[120:135], v[76:79], v[68:71], v[120:135]
  ds_read_b128 v[72:75], v237 offset:6144
  ds_read_b128 v[76:79], v237 offset:6656
  s_nop 1
  v_cndmask_b32 v88, v88, v104, s[76:77]
  v_cndmask_b32 v89, v89, v105, s[78:79]
  v_cndmask_b32 v90, v90, v106, s[80:81]
  v_cndmask_b32 v91, v91, v107, s[82:83]
  v_cndmask_b32 v92, v92, v108, s[84:85]
  v_cndmask_b32 v93, v93, v109, s[86:87]
  v_cndmask_b32 v94, v94, v110, s[90:91]
  v_cndmask_b32 v95, v95, v111, s[92:93]
  v_cndmask_b32 v96, v96, v112, s[94:95]
  v_cndmask_b32 v97, v97, v113, s[96:97]
  v_cndmask_b32 v98, v98, v114, s[98:99]
  v_cndmask_b32 v99, v99, v115, s[100:101]
  v_cndmask_b32 v100, v100, v116, s[4:5]
  v_cndmask_b32 v101, v101, v117, s[6:7]
  v_cndmask_b32 v102, v102, v118, s[24:25]
  v_cndmask_b32 v103, v103, v119, s[26:27]
  v_exp_f32 v88, v88
  v_exp_f32 v89, v89
  v_exp_f32 v90, v90
  v_exp_f32 v91, v91
  v_exp_f32 v92, v92
  v_exp_f32 v93, v93
  v_exp_f32 v94, v94
  v_exp_f32 v95, v95
  v_exp_f32 v96, v96
  v_exp_f32 v97, v97
  v_exp_f32 v98, v98
  v_exp_f32 v99, v99
  v_exp_f32 v100, v100
  v_exp_f32 v101, v101
  v_exp_f32 v102, v102
  v_exp_f32 v103, v103
  v_cndmask_b32 v104, 0, v88, s[76:77]
  v_cndmask_b32 v105, 0, v89, s[78:79]
  v_cndmask_b32 v106, 0, v90, s[80:81]
  v_cndmask_b32 v107, 0, v91, s[82:83]
  v_cndmask_b32 v108, 0, v92, s[84:85]
  v_cndmask_b32 v109, 0, v93, s[86:87]
  v_cndmask_b32 v110, 0, v94, s[90:91]
  v_cndmask_b32 v111, 0, v95, s[92:93]
  v_cndmask_b32 v112, 0, v96, s[94:95]
  v_cndmask_b32 v113, 0, v97, s[96:97]
  v_cndmask_b32 v114, 0, v98, s[98:99]
  v_cndmask_b32 v115, 0, v99, s[100:101]
  v_cndmask_b32 v116, 0, v100, s[4:5]
  v_cndmask_b32 v117, 0, v101, s[6:7]
  v_cndmask_b32 v118, 0, v102, s[24:25]
  v_cndmask_b32 v119, 0, v103, s[26:27]
  v_sub_f32 v88, v88, v104
  v_sub_f32 v89, v89, v105
  v_sub_f32 v90, v90, v106
  v_sub_f32 v91, v91, v107
  v_sub_f32 v92, v92, v108
  v_sub_f32 v93, v93, v109
  v_sub_f32 v94, v94, v110
  v_sub_f32 v95, v95, v111
  v_sub_f32 v96, v96, v112
  v_sub_f32 v97, v97, v113
  v_sub_f32 v98, v98, v114
  v_sub_f32 v99, v99, v115
  v_sub_f32 v100, v100, v116
  v_sub_f32 v101, v101, v117
  v_sub_f32 v102, v102, v118
  v_sub_f32 v103, v103, v119
  v_cvt_pk_bf16_f32 v216, v104, v105
  v_cvt_pk_bf16_f32 v217, v106, v107
  v_cvt_pk_bf16_f32 v218, v108, v109
  v_cvt_pk_bf16_f32 v219, v110, v111
  v_cvt_pk_bf16_f32 v220, v112, v113
  v_cvt_pk_bf16_f32 v221, v114, v115
  v_cvt_pk_bf16_f32 v222, v116, v117
  v_cvt_pk_bf16_f32 v223, v118, v119
  v_cvt_pk_bf16_f32 v224, v88, v89
  v_cvt_pk_bf16_f32 v225, v90, v91
  v_cvt_pk_bf16_f32 v226, v92, v93
  v_cvt_pk_bf16_f32 v227, v94, v95
  v_cvt_pk_bf16_f32 v228, v96, v97
  v_cvt_pk_bf16_f32 v229, v98, v99
  v_cvt_pk_bf16_f32 v230, v100, v101
  v_cvt_pk_bf16_f32 v231, v102, v103
  v_mfma_f32_32x32x16_bf16 v[168:183], v[200:203], v[216:219], 0
  v_mfma_f32_32x32x16_bf16 v[184:199], v[232:235], v[216:219], 0
  v_mfma_f32_32x32x16_bf16 v[168:183], v[204:207], v[220:223], v[168:183]
  v_mfma_f32_32x32x16_bf16 v[184:199], v[232:235], v[220:223], v[184:199]
  ds_read_b128 v[200:203], v238 offset:2048
  ds_read_b128 v[204:207], v238 offset:2560
  v_mfma_f32_32x32x16_bf16 v[168:183], v[208:211], v[224:227], v[168:183]
  v_mfma_f32_32x32x16_bf16 v[184:199], v[232:235], v[224:227], v[184:199]
  v_mfma_f32_32x32x16_bf16 v[168:183], v[212:215], v[228:231], v[168:183]
  v_mfma_f32_32x32x16_bf16 v[184:199], v[232:235], v[228:231], v[184:199]
  ds_read_b128 v[208:211], v238 offset:4096
  ds_read_b128 v[212:215], v238 offset:4608
  s_waitcnt lgkmcnt(7)
  s_cmp_ge_u32 s71, 6
  s_cbranch_scc0 L_inv_b_2
  v_mfma_f32_32x32x16_bf16 v[88:103], v[80:83], v[64:67], v[136:151]
L_invb_b_2:
  s_waitcnt lgkmcnt(6)
  v_mfma_f32_32x32x16_bf16 v[88:103], v[84:87], v[68:71], v[88:103]
  ds_read_b128 v[80:83], v237 offset:8192
  ds_read_b128 v[84:87], v237 offset:8704
  v_exp_f32 v120, v120
  v_exp_f32 v121, v121
  v_exp_f32 v122, v122
  v_exp_f32 v123, v123
  v_exp_f32 v124, v124
  v_exp_f32 v125, v125
  v_exp_f32 v126, v126
  v_exp_f32 v127, v127
  v_exp_f32 v128, v128
  v_exp_f32 v129, v129
  v_exp_f32 v130, v130
  v_exp_f32 v131, v131
  v_exp_f32 v132, v132
  v_exp_f32 v133, v133
  v_exp_f32 v134, v134
  v_exp_f32 v135, v135
  v_cvt_pk_bf16_f32 v224, v120, v121
  v_cvt_pk_bf16_f32 v225, v122, v123
  v_cvt_pk_bf16_f32 v226, v124, v125
  v_cvt_pk_bf16_f32 v227, v126, v127
  v_cvt_pk_bf16_f32 v228, v128, v129
  v_cvt_pk_bf16_f32 v229, v130, v131
  v_cvt_pk_bf16_f32 v230, v132, v133
  v_cvt_pk_bf16_f32 v231, v134, v135
  s_waitcnt lgkmcnt(4)
  v_mfma_f32_32x32x16_bf16 v[168:183], v[200:203], v[224:227], v[168:183]
  v_mfma_f32_32x32x16_bf16 v[184:199], v[232:235], v[224:227], v[184:199]
  v_mfma_f32_32x32x16_bf16 v[168:183], v[204:207], v[228:231], v[168:183]
  v_mfma_f32_32x32x16_bf16 v[184:199], v[232:235], v[228:231], v[184:199]
  ds_read_b128 v[200:203], v238 offset:6144
  ds_read_b128 v[204:207], v238 offset:6656
  s_cmp_ge_u32 s71, 5
  s_cbranch_scc0 L_inv_b_3
  v_mfma_f32_32x32x16_bf16 v[104:119], v[72:75], v[64:67], v[136:151]
L_invb_b_3:
  v_mfma_f32_32x32x16_bf16 v[104:119], v[76:79], v[68:71], v[104:119]
  ds_read_b128 v[72:75], v237 offset:10240
  ds_read_b128 v[76:79], v237 offset:10752
  v_exp_f32 v88, v88
  v_exp_f32 v89, v89
  v_exp_f32 v90, v90
  v_exp_f32 v91, v91
  v_exp_f32 v92, v92
  v_exp_f32 v93, v93
  v_exp_f32 v94, v94
  v_exp_f32 v95, v95
  v_exp_f32 v96, v96
  v_exp_f32 v97, v97
  v_exp_f32 v98, v98
  v_exp_f32 v99, v99
  v_exp_f32 v100, v100
  v_exp_f32 v101, v101
  v_exp_f32 v102, v102
  v_exp_f32 v103, v103
  v_cvt_pk_bf16_f32 v216, v88, v89
  v_cvt_pk_bf16_f32 v217, v90, v91
  v_cvt_pk_bf16_f32 v218, v92, v93
  v_cvt_pk_bf16_f32 v219, v94, v95
  v_cvt_pk_bf16_f32 v220, v96, v97
  v_cvt_pk_bf16_f32 v221, v98, v99
  v_cvt_pk_bf16_f32 v222, v100, v101
  v_cvt_pk_bf16_f32 v223, v102, v103
  s_waitcnt lgkmcnt(6)
  v_mfma_f32_32x32x16_bf16 v[168:183], v[208:211], v[216:219], v[168:183]
  v_mfma_f32_32x32x16_bf16 v[184:199], v[232:235], v[216:219], v[184:199]
  v_mfma_f32_32x32x16_bf16 v[168:183], v[212:215], v[220:223], v[168:183]
  v_mfma_f32_32x32x16_bf16 v[184:199], v[232:235], v[220:223], v[184:199]
  ds_read_b128 v[208:211], v238 offset:8192
  ds_read_b128 v[212:215], v238 offset:8704
  s_waitcnt lgkmcnt(7)
  s_cmp_ge_u32 s71, 4
  s_cbranch_scc0 L_inv_b_4
  v_mfma_f32_32x32x16_bf16 v[120:135], v[80:83], v[64:67], v[136:151]
L_invb_b_4:
  s_waitcnt lgkmcnt(6)
  v_mfma_f32_32x32x16_bf16 v[120:135], v[84:87], v[68:71], v[120:135]
  ds_read_b128 v[80:83], v237 offset:12288
  ds_read_b128 v[84:87], v237 offset:12800
  s_setprio 1
  v_exp_f32 v104, v104
  v_exp_f32 v105, v105
  v_exp_f32 v106, v106
  v_exp_f32 v107, v107
  v_exp_f32 v108, v108
  v_exp_f32 v109, v109
  v_exp_f32 v110, v110
  v_exp_f32 v111, v111
  v_exp_f32 v112, v112
  v_exp_f32 v113, v113
  v_exp_f32 v114, v114
  v_exp_f32 v115, v115
  v_exp_f32 v116, v116
  v_exp_f32 v117, v117
  v_exp_f32 v118, v118
  v_exp_f32 v119, v119
  v_cvt_pk_bf16_f32 v224, v104, v105
  v_cvt_pk_bf16_f32 v225, v106, v107
  v_cvt_pk_bf16_f32 v226, v108, v109
  v_cvt_pk_bf16_f32 v227, v110, v111
  v_cvt_pk_bf16_f32 v228, v112, v113
  v_cvt_pk_bf16_f32 v229, v114, v115
  v_cvt_pk_bf16_f32 v230, v116, v117
  v_cvt_pk_bf16_f32 v231, v118, v119
  s_waitcnt lgkmcnt(6)
  v_mfma_f32_32x32x16_bf16 v[168:183], v[200:203], v[224:227], v[168:183]
  v_mfma_f32_32x32x16_bf16 v[184:199], v[232:235], v[224:227], v[184:199]
  v_mfma_f32_32x32x16_bf16 v[168:183], v[204:207], v[228:231], v[168:183]
  v_mfma_f32_32x32x16_bf16 v[184:199], v[232:235], v[228:231], v[184:199]
  ds_read_b128 v[200:203], v238 offset:10240
  ds_read_b128 v[204:207], v238 offset:10752
  s_waitcnt lgkmcnt(7)
  s_cmp_ge_u32 s71, 3
  s_cbranch_scc0 L_inv_b_5
  v_mfma_f32_32x32x16_bf16 v[88:103], v[72:75], v[64:67], v[136:151]
L_invb_b_5:
  s_waitcnt lgkmcnt(6)
  v_mfma_f32_32x32x16_bf16 v[88:103], v[76:79], v[68:71], v[88:103]
  ds_read_b128 v[72:75], v237 offset:14336
  ds_read_b128 v[76:79], v237 offset:14848
  v_exp_f32 v120, v120
  v_exp_f32 v121, v121
  v_exp_f32 v122, v122
  v_exp_f32 v123, v123
  v_exp_f32 v124, v124
  v_exp_f32 v125, v125
  v_exp_f32 v126, v126
  v_exp_f32 v127, v127
  v_exp_f32 v128, v128
  v_exp_f32 v129, v129
  v_exp_f32 v130, v130
  v_exp_f32 v131, v131
  v_exp_f32 v132, v132
  v_exp_f32 v133, v133
  v_exp_f32 v134, v134
  v_exp_f32 v135, v135
  v_cvt_pk_bf16_f32 v216, v120, v121
  v_cvt_pk_bf16_f32 v217, v122, v123
  v_cvt_pk_bf16_f32 v218, v124, v125
  v_cvt_pk_bf16_f32 v219, v126, v127
  v_cvt_pk_bf16_f32 v220, v128, v129
  v_cvt_pk_bf16_f32 v221, v130, v131
  v_cvt_pk_bf16_f32 v222, v132, v133
  v_cvt_pk_bf16_f32 v223, v134, v135
  s_waitcnt lgkmcnt(6)
  v_mfma_f32_32x32x16_bf16 v[168:183], v[208:211], v[216:219], v[168:183]
  v_mfma_f32_32x32x16_bf16 v[184:199], v[232:235], v[216:219], v[184:199]
  v_mfma_f32_32x32x16_bf16 v[168:183], v[212:215], v[220:223], v[168:183]
  v_mfma_f32_32x32x16_bf16 v[184:199], v[232:235], v[220:223], v[184:199]
  ds_read_b128 v[208:211], v238 offset:12288
  ds_read_b128 v[212:215], v238 offset:12800
  s_waitcnt lgkmcnt(7)
  s_cmp_ge_u32 s71, 2
  s_cbranch_scc0 L_inv_b_6
  v_mfma_f32_32x32x16_bf16 v[104:119], v[80:83], v[64:67], v[136:151]
L_invb_b_6:
  s_waitcnt lgkmcnt(6)
  v_mfma_f32_32x32x16_bf16 v[104:119], v[84:87], v[68:71], v[104:119]
  v_exp_f32 v88, v88
  v_exp_f32 v89, v89
  v_exp_f32 v90, v90
  v_exp_f32 v91, v91
  v_exp_f32 v92, v92
  v_exp_f32 v93, v93
  v_exp_f32 v94, v94
  v_exp_f32 v95, v95
  v_exp_f32 v96, v96
  v_exp_f32 v97, v97
  v_exp_f32 v98, v98
  v_exp_f32 v99, v99
  v_exp_f32 v100, v100
  v_exp_f32 v101, v101
  v_exp_f32 v102, v102
  v_exp_f32 v103, v103
  v_cvt_pk_bf16_f32 v224, v88, v89
  v_cvt_pk_bf16_f32 v225, v90, v91
  v_cvt_pk_bf16_f32 v226, v92, v93
  v_cvt_pk_bf16_f32 v227, v94, v95
  v_cvt_pk_bf16_f32 v228, v96, v97
  v_cvt_pk_bf16_f32 v229, v98, v99
  v_cvt_pk_bf16_f32 v230, v100, v101
  v_cvt_pk_bf16_f32 v231, v102, v103
  s_waitcnt lgkmcnt(4)
  v_mfma_f32_32x32x16_bf16 v[168:183], v[200:203], v[224:227], v[168:183]
  v_mfma_f32_32x32x16_bf16 v[184:199], v[232:235], v[224:227], v[184:199]
  v_mfma_f32_32x32x16_bf16 v[168:183], v[204:207], v[228:231], v[168:183]
  v_mfma_f32_32x32x16_bf16 v[184:199], v[232:235], v[228:231], v[184:199]
  ds_read_b128 v[200:203], v238 offset:14336
  ds_read_b128 v[204:207], v238 offset:14848
  s_waitcnt lgkmcnt(5)
  s_cmp_ge_u32 s71, 1
  s_cbranch_scc0 L_inv_b_7
  v_mfma_f32_32x32x16_bf16 v[120:135], v[72:75], v[64:67], v[136:151]
L_invb_b_7:
  s_waitcnt lgkmcnt(4)
  v_mfma_f32_32x32x16_bf16 v[120:135], v[76:79], v[68:71], v[120:135]
  s_setprio 0
  v_exp_f32 v104, v104
  v_exp_f32 v105, v105
  v_exp_f32 v106, v106
  v_exp_f32 v107, v107
  v_exp_f32 v108, v108
  v_exp_f32 v109, v109
  v_exp_f32 v110, v110
  v_exp_f32 v111, v111
  v_exp_f32 v112, v112
  v_exp_f32 v113, v113
  v_exp_f32 v114, v114
  v_exp_f32 v115, v115
  v_exp_f32 v116, v116
  v_exp_f32 v117, v117
  v_exp_f32 v118, v118
  v_exp_f32 v119, v119
  v_cvt_pk_bf16_f32 v216, v104, v105
  v_cvt_pk_bf16_f32 v217, v106, v107
  v_cvt_pk_bf16_f32 v218, v108, v109
  v_cvt_pk_bf16_f32 v219, v110, v111
  v_cvt_pk_bf16_f32 v220, v112, v113
  v_cvt_pk_bf16_f32 v221, v114, v115
  v_cvt_pk_bf16_f32 v222, v116, v117
  v_cvt_pk_bf16_f32 v223, v118, v119
  s_waitcnt lgkmcnt(2)
  v_mfma_f32_32x32x16_bf16 v[168:183], v[208:211], v[216:219], v[168:183]
  v_mfma_f32_32x32x16_bf16 v[184:199], v[232:235], v[216:219], v[184:199]
  v_mfma_f32_32x32x16_bf16 v[168:183], v[212:215], v[220:223], v[168:183]
  v_mfma_f32_32x32x16_bf16 v[184:199], v[232:235], v[220:223], v[184:199]
  v_exp_f32 v120, v120
  v_exp_f32 v121, v121
  v_exp_f32 v122, v122
  v_exp_f32 v123, v123
  v_exp_f32 v124, v124
  v_exp_f32 v125, v125
  v_exp_f32 v126, v126
  v_exp_f32 v127, v127
  v_exp_f32 v128, v128
  v_exp_f32 v129, v129
  v_exp_f32 v130, v130
  v_exp_f32 v131, v131
  v_exp_f32 v132, v132
  v_exp_f32 v133, v133
  v_exp_f32 v134, v134
  v_exp_f32 v135, v135
  v_cvt_pk_bf16_f32 v224, v120, v121
  v_cvt_pk_bf16_f32 v225, v122, v123
  v_cvt_pk_bf16_f32 v226, v124, v125
  v_cvt_pk_bf16_f32 v227, v126, v127
  v_cvt_pk_bf16_f32 v228, v128, v129
  v_cvt_pk_bf16_f32 v229, v130, v131
  v_cvt_pk_bf16_f32 v230, v132, v133
  v_cvt_pk_bf16_f32 v231, v134, v135
  s_waitcnt lgkmcnt(0)
  v_mfma_f32_32x32x16_bf16 v[168:183], v[200:203], v[224:227], v[168:183]
  v_mfma_f32_32x32x16_bf16 v[184:199], v[232:235], v[224:227], v[184:199]
  v_mfma_f32_32x32x16_bf16 v[168:183], v[204:207], v[228:231], v[168:183]
  v_mfma_f32_32x32x16_bf16 v[184:199], v[232:235], v[228:231], v[184:199]
  s_mov_b32 s12, s60
  s_mov_b32 s13, s61
  s_mov_b32 s14, 58720256
  s_mov_b32 s15, 0x20000
  s_lshl_b32 s69, s40, 10
  s_lshl_b32 s67, s41, 1
  v_lshrrev_b32 v236, 4, v1
  v_and_b32 v236, 1, v236
  v_add_u32 v236, s67, v236
  v_lshlrev_b32 v236, 11, v236
  v_add_u32 v236, s69, v236
  v_and_b32 v7, 15, v1
  v_lshrrev_b32 v6, 5, v1
  v_lshlrev_b32 v6, 4, v6
  v_add_u32 v7, v7, v6
  v_lshlrev_b32 v7, 4, v7
  v_add_u32 v236, v236, v7
  s_lshl_b32 s31, s28, 4
  s_add_u32 s31, s31, s29
  s_lshl_b32 s31, s31, 14
  s_add_u32 s31, s31, 12582912
  s_nop 7
  s_nop 3
  v_rcp_f32 v240, v184
  s_nop 0
  v_mul_f32 v168, v240, v168
  v_mul_f32 v169, v240, v169
  v_mul_f32 v170, v240, v170
  v_mul_f32 v171, v240, v171
  v_mul_f32 v172, v240, v172
  v_mul_f32 v173, v240, v173
  v_mul_f32 v174, v240, v174
  v_mul_f32 v175, v240, v175
  v_mul_f32 v176, v240, v176
  v_mul_f32 v177, v240, v177
  v_mul_f32 v178, v240, v178
  v_mul_f32 v179, v240, v179
  v_mul_f32 v180, v240, v180
  v_mul_f32 v181, v240, v181
  v_mul_f32 v182, v240, v182
  v_mul_f32 v183, v240, v183
  v_cvt_pk_bf16_f32 v216, v168, v169
  v_cvt_pk_bf16_f32 v217, v170, v171
  v_cvt_pk_bf16_f32 v218, v172, v173
  v_cvt_pk_bf16_f32 v219, v174, v175
  buffer_store_dwordx4 v[216:219], v236, s[12:15], s31 offen offset:0 sc1
  v_cvt_pk_bf16_f32 v224, v176, v177
  v_cvt_pk_bf16_f32 v225, v178, v179
  v_cvt_pk_bf16_f32 v226, v180, v181
  v_cvt_pk_bf16_f32 v227, v182, v183
  buffer_store_dwordx4 v[224:227], v236, s[12:15], s31 offen offset:512 sc1
  s_waitcnt vmcnt(0)
  v_mov_b32 v237, 163716
  v_mov_b32 v238, 1
  s_mov_b64 exec, 1
  ds_add_rtn_u32 v237, v237, v238
  s_lshl_b32 s31, s28, 4
  s_add_u32 s31, s31, s29
  s_lshl_b32 s31, s31, 7
  s_add_u32 s31, s31, 54591488
  s_waitcnt lgkmcnt(0)
  v_readfirstlane_b32 s39, v237
  v_mov_b32 v237, 0
  v_mov_b32 v238, s1
  s_nop 1
  s_cmp_eq_u32 s39, 7
  s_cbranch_scc0 L_notlast_o
  buffer_store_dword v238, v237, s[12:15], s31 offen sc1
L_notlast_o:
  s_mov_b64 exec, -1
  s_cmp_eq_u32 s0, 1
  s_cbranch_scc1 L_attn_back_l
  s_branch L_attn_back_c
L_hk_q_s71:
  global_load_dword v254, v197, s[48:49]
  s_branch L_hkb_q_s71
L_inv_a_0:
  v_mfma_f32_32x32x16_bf16 v[88:103], v[72:75], v[64:67], v[152:167]
  s_branch L_invb_a_0
L_inv_a_1:
  v_mfma_f32_32x32x16_bf16 v[120:135], v[72:75], v[64:67], v[152:167]
  s_branch L_invb_a_1
L_inv_a_2:
  v_mfma_f32_32x32x16_bf16 v[88:103], v[80:83], v[64:67], v[152:167]
  s_branch L_invb_a_2
L_inv_a_3:
  v_mfma_f32_32x32x16_bf16 v[104:119], v[72:75], v[64:67], v[152:167]
  s_branch L_invb_a_3
L_inv_a_4:
  v_mfma_f32_32x32x16_bf16 v[120:135], v[80:83], v[64:67], v[152:167]
  s_branch L_invb_a_4
L_inv_a_5:
  v_mfma_f32_32x32x16_bf16 v[88:103], v[72:75], v[64:67], v[152:167]
  s_branch L_invb_a_5
L_inv_a_6:
  v_mfma_f32_32x32x16_bf16 v[104:119], v[80:83], v[64:67], v[152:167]
  s_branch L_invb_a_6
L_inv_a_7:
  v_mfma_f32_32x32x16_bf16 v[120:135], v[72:75], v[64:67], v[152:167]
  s_branch L_invb_a_7
L_inv_b_0:
  v_mfma_f32_32x32x16_bf16 v[88:103], v[72:75], v[64:67], v[152:167]
  s_branch L_invb_b_0
L_inv_b_1:
  v_mfma_f32_32x32x16_bf16 v[120:135], v[72:75], v[64:67], v[152:167]
  s_branch L_invb_b_1
L_inv_b_2:
  v_mfma_f32_32x32x16_bf16 v[88:103], v[80:83], v[64:67], v[152:167]
  s_branch L_invb_b_2
L_inv_b_3:
  v_mfma_f32_32x32x16_bf16 v[104:119], v[72:75], v[64:67], v[152:167]
  s_branch L_invb_b_3
L_inv_b_4:
  v_mfma_f32_32x32x16_bf16 v[120:135], v[80:83], v[64:67], v[152:167]
  s_branch L_invb_b_4
L_inv_b_5:
  v_mfma_f32_32x32x16_bf16 v[88:103], v[72:75], v[64:67], v[152:167]
  s_branch L_invb_b_5
L_inv_b_6:
  v_mfma_f32_32x32x16_bf16 v[104:119], v[80:83], v[64:67], v[152:167]
  s_branch L_invb_b_6
L_inv_b_7:
  v_mfma_f32_32x32x16_bf16 v[120:135], v[72:75], v[64:67], v[152:167]
  s_branch L_invb_b_7
L_hk_o_13:
  s_cmp_lg_u32 s70, 0
  s_cbranch_scc1 L_ores1
  s_lshl_b32 s31, s28, 1
  s_add_u32 s31, s31, s42
  s_lshl_b32 s31, s31, 17
  s_lshl_b32 s39, s29, 7
  s_add_u32 s31, s31, s39
  s_lshl_b32 s39, s43, 6
  s_add_u32 s31, s31, s39
  buffer_load_dwordx2 v[100:101], v116, s[4:7], s31 offen offset:0
  buffer_load_dwordx2 v[102:103], v116, s[4:7], s31 offen offset:32
  s_add_u32 s31, s31, 32768
  buffer_load_dwordx2 v[104:105], v116, s[4:7], s31 offen offset:0
  buffer_load_dwordx2 v[106:107], v116, s[4:7], s31 offen offset:32
  s_add_u32 s31, s31, 32768
  buffer_load_dwordx2 v[108:109], v116, s[4:7], s31 offen offset:0
  buffer_load_dwordx2 v[110:111], v116, s[4:7], s31 offen offset:32
  s_add_u32 s31, s31, 32768
  buffer_load_dwordx2 v[112:113], v116, s[4:7], s31 offen offset:0
  buffer_load_dwordx2 v[114:115], v116, s[4:7], s31 offen offset:32
L_ores1:
  s_branch L_hkb_o_13
L_end:
  s_endpgm

.section .rodata,"a"
.p2align 6
.amdhsa_kernel sequential_preLN__sliding_block__dense_activation_relu__prompt_kernel
  .amdhsa_next_free_vgpr 256
  .amdhsa_next_free_sgpr 102
  .amdhsa_accum_offset 256
  .amdhsa_group_segment_fixed_size 0
  .amdhsa_kernarg_size 72
  .amdhsa_user_sgpr_count 2
  .amdhsa_user_sgpr_kernarg_segment_ptr 1
  .amdhsa_system_sgpr_workgroup_id_x 1
  .amdhsa_float_denorm_mode_32 3
.end_amdhsa_kernel
.text
```
